```python
import torch

def _softmax(x, axis=-1):
    return torch.softmax(x, dim=axis)
def _gelu(x):
    return torch.nn.functional.gelu(x, approximate="tanh")
def _silu(x):
    return torch.nn.functional.silu(x)
def _sigmoid(x):
    return torch.sigmoid(x)
def _layernorm(x, axis=-1, eps=1e-5):
    m = x.mean(dim=axis, keepdim=True)
    v = x.var(dim=axis, keepdim=True, unbiased=False)
    return (x - m) / torch.sqrt(v + eps)
def _scatter_add(tgt, idx, src, axis=0):
    return tgt.clone().index_add_(axis, idx, src)
def _segment_sum(src, seg, n):
    out = torch.zeros((n,) + src.shape[1:], dtype=src.dtype)
    return out.index_add_(0, seg, src)
def _pad(x, pw):
    flat = tuple(v for pair in reversed(pw) for v in pair)
    return torch.nn.functional.pad(x, flat)

kernel_name = 'gated_mix__ssm_conv_h3__compressed_kv_cla__prompt'

def setup_inputs():

    _w = (lambda a: (lambda t: t.to(torch.bfloat16) if t.is_floating_point() else t)(torch.as_tensor(a)))
    def _A_setup():
        B, S, D = 1, 2048, 640
        ks = 4
        return {
            "q": _w((lambda *s: torch.randn(*s, dtype=torch.bfloat16) * 0.05)(B, S, D)),
            "k": _w((lambda *s: torch.randn(*s, dtype=torch.bfloat16) * 0.4)(B, S, D)),
            "v": _w((lambda *s: torch.randn(*s, dtype=torch.bfloat16) * 0.4)(B, S, D)),
            "shift_k": _w((lambda *s: torch.randn(*s, dtype=torch.bfloat16) * 0.4)(D, ks) * 0.5),
            "ssm_k": _w((lambda *s: torch.randn(*s, dtype=torch.bfloat16) * 0.8)(D, S) * (1.0 / S ** 0.5)),
            "ssm_D": _w((lambda *s: torch.randn(*s, dtype=torch.bfloat16) * 0.4)(D)),
        }
    _A_in = _A_setup()

    def _B_setup():
        B, H, Sq, Sk, D, M = 1, 32, 2048, 2048, 128, 640
        Dc = 4 * D
        return {
            "x": _w((lambda *s: torch.randn(*s, dtype=torch.bfloat16) * 0.05)(B, Sq, M)),
            "c_kv": _w((lambda *s: torch.randn(*s, dtype=torch.bfloat16) * 0.4)(B, Sk, Dc)),
            "w_q": _w((lambda *s: torch.randn(*s, dtype=torch.bfloat16) * 6.4)(M, H, D) * (M ** -0.5)),
            "w_uk": _w((lambda *s: torch.randn(*s, dtype=torch.bfloat16) * 6.4)(Dc, H, D) * (Dc ** -0.5)),
            "w_uv": _w((lambda *s: torch.randn(*s, dtype=torch.bfloat16) * 0.4)(Dc, H, D) * (Dc ** -0.5)),
            "w_o": _w((lambda *s: torch.randn(*s, dtype=torch.bfloat16) * 0.4)(H, D, M) * ((H * D) ** -0.5)),
        }
    _B_in = _B_setup()

    return {
        "A_q": _A_in["q"],
        "A_k": _A_in["k"],
        "A_v": _A_in["v"],
        "A_shift_k": _A_in["shift_k"],
        "A_ssm_k": _A_in["ssm_k"],
        "A_ssm_D": _A_in["ssm_D"],
        "B_x": _B_in["x"],
        "B_c_kv": _B_in["c_kv"],
        "B_w_q": _B_in["w_q"],
        "B_w_uk": _B_in["w_uk"],
        "B_w_uv": _B_in["w_uv"],
        "B_w_o": _B_in["w_o"],
        "gate_w": _w((lambda *s: torch.randn(*s, dtype=torch.bfloat16) * 0.05)(640) * 16.0),
    }

def reference(A_q, A_k, A_v, A_shift_k, A_ssm_k, A_ssm_D, B_x, B_c_kv, B_w_q, B_w_uk, B_w_uv, B_w_o, gate_w):
    def _A_ref(q, k, v, shift_k, ssm_k, ssm_D):
        B, S, D = q.shape
        ks = shift_k.shape[-1]
        k_pad = _pad(k, ((0, 0), (ks - 1, 0), (0, 0)))
        k_shift = torch.zeros_like(k)
        for t in range(ks):
            k_shift = k_shift + k_pad[:, t:t + S, :] * shift_k[:, ks - 1 - t][None, None, :]
        kv = k_shift * v
        L = 2 * S
        kv_pad = _pad(kv, ((0, 0), (0, S), (0, 0)))
        kf_pad = _pad(ssm_k, ((0, 0), (0, S)))
        kv_f = (lambda x, axes=(-2,-1): torch.fft.rfft2(x.float(), dim=axes))(kv_pad[:, None, :, :], axes=(1, 2))
        kf_f = (lambda x, axes=(-2,-1): torch.fft.rfft2(x.float(), dim=axes))(kf_pad[:, None, :], axes=(1, 2))
        kf_f = (lambda x, *d: x.permute(*d))(kf_f, 1, 2, 0)
        y_f = kv_f * kf_f[None, :, :, :]
        y = (lambda x, s, axes=(-2,-1): torch.fft.irfft2(x, s=s, dim=axes).to(torch.bfloat16))(y_f, (1, L), axes=(1, 2))[:, 0, :S, :]
        y = y + kv * ssm_D[None, None, :]
        return q * y

    def _B_ref(x, c_kv, w_q, w_uk, w_uv, w_o):
        B, Sq, M = x.shape[0], x.shape[1], x.shape[2]
        Sk = c_kv.shape[1]
        H, D = w_q.shape[1], w_q.shape[2]
        q = torch.einsum("bqm,mhd->bhqd", x, w_q)
        k = torch.einsum("bkc,chd->bhkd", c_kv, w_uk)
        v = torch.einsum("bkc,chd->bhkd", c_kv, w_uv)
        scores = torch.einsum("bhqd,bhkd->bhqk", q, k) * (D ** -0.5)
        off = Sk - Sq
        qi = torch.arange(Sq)[:, None]
        kj = torch.arange(Sk)[None, :]
        cmask = kj <= (qi + off)
        scores = torch.where(cmask[None, None], scores, -1e9)
        p = _softmax(scores, axis=-1)
        ctx = torch.einsum("bhqk,bhkd->bhqd", p, v)
        return torch.einsum("bhqd,hdm->bqm", ctx, w_o)

    x = A_q
    g = _sigmoid((x * gate_w).sum(-1, keepdims=True))
    a = _A_ref(x, A_k, A_v, A_shift_k, A_ssm_k, A_ssm_D)
    b = _B_ref(x, B_c_kv, B_w_q, B_w_uk, B_w_uv, B_w_o)
    return g * a + (1 - g) * b
```

```asm
; @launch grid=(256,1,1) block=(512,1,1) lds=163840
.amdgcn_target "amdgcn-amd-amdhsa--gfx950"
.text
.globl gated_mix__ssm_conv_h3__compressed_kv_cla__prompt_kernel
.p2align 8
.type gated_mix__ssm_conv_h3__compressed_kv_cla__prompt_kernel,@function
gated_mix__ssm_conv_h3__compressed_kv_cla__prompt_kernel:
    s_cmp_ge_u32 s2, 256
    s_cbranch_scc1 L_mn_end
    s_load_dwordx2 s[64:65], s[0:1], 56
    s_load_dwordx2 s[66:67], s[0:1], 72
    s_load_dwordx2 s[68:69], s[0:1], 80
    s_load_dwordx2 s[70:71], s[0:1], 88
    v_lshrrev_b32 v8, 6, v0
    v_and_b32 v1, 63, v0
    v_readfirstlane_b32 s32, v8
    s_and_b32 s33, s2, 7
    s_lshl_b32 s33, s33, 2
    s_bfe_u32 s36, s2, 0x20003
    s_add_u32 s33, s33, s36
    s_lshr_b32 s34, s2, 5
    s_lshl_b32 s38, s32, 12
    v_lshrrev_b32 v8, 4, v1
    v_and_b32 v9, 7, v1
    v_xor_b32 v8, v8, v9
    v_lshlrev_b32 v8, 4, v8
    v_xor_b32 v10, 64, v8
    v_lshrrev_b32 v9, 3, v1
    v_lshl_add_u32 v26, v9, 10, v8
    v_lshl_add_u32 v27, v9, 10, v10
    v_add_u32 v28, 14336, v26
    v_add_u32 v29, 21504, v27
    v_add_u32 v27, 7168, v27
    v_mul_u32_u24 v9, 1280, v9
    v_add_u32 v30, v9, v8
    v_add_u32 v31, v9, v10
    v_add_u32 v32, 18432, v30
    v_add_u32 v33, 27648, v31
    v_add_u32 v31, 9216, v31
    v_lshrrev_b32 v8, 4, v1
    v_lshlrev_b32 v9, 2, v8
    v_and_b32 v10, 15, v1
    v_xor_b32 v9, v9, v10
    v_lshlrev_b32 v9, 4, v9
    v_lshl_add_u32 v34, v8, 13, v9
    v_add_u32 v35, 31744, v34
    v_add_u32 v36, 63488, v34
    v_add_u32 v37, 95232, v34
    s_and_b32 s40, s32, 3
    s_lshl_b32 s40, s40, 17
    s_lshl_b32 s41, s32, 17
    s_cmp_ge_u32 s34, 5
    s_cselect_b32 s63, 5, 0
    s_sub_u32 s63, s34, s63
    s_waitcnt lgkmcnt(0)
    s_lshl_b32 s36, s34, 3
    s_add_u32 s36, s36, s32
    s_lshl_b32 s36, s36, 15
    s_add_u32 s4, s64, s36
    s_addc_u32 s5, s65, 0
    s_and_b32 s5, s5, 0xffff
    s_mov_b32 s6, 32768
    s_mov_b32 s7, 0x00020000
    s_cmp_lt_u32 s32, 4
    s_cselect_b32 s66, s66, s68
    s_cselect_b32 s67, s67, s69
    s_lshl_b32 s36, s33, 8
    s_add_u32 s8, s66, s36
    s_addc_u32 s9, s67, 0
    s_and_b32 s9, s9, 0xffff
    s_mov_b32 s10, 4186368
    s_mov_b32 s11, 0x00020000
    s_mov_b32 s39, 0
    s_add_u32 m0, s38, 0
    s_nop 0
    buffer_load_dwordx4 v26, s[4:7], s39 offen offset:0 lds
    buffer_load_dwordx4 v27, s[4:7], s39 offen offset:1024 lds
    buffer_load_dwordx4 v28, s[4:7], s39 offen offset:2048 lds
    buffer_load_dwordx4 v29, s[4:7], s39 offen offset:3072 lds
    s_add_u32 s39, s40, 0
    s_add_u32 m0, s38, 32768
    s_nop 0
    buffer_load_dwordx4 v34, s[8:11], s39 offen offset:0 lds
    buffer_load_dwordx4 v35, s[8:11], s39 offen offset:1024 lds
    buffer_load_dwordx4 v36, s[8:11], s39 offen offset:2048 lds
    buffer_load_dwordx4 v37, s[8:11], s39 offen offset:3072 lds
    s_lshl_b32 s36, s34, 5
    s_add_u32 s36, s36, s33
    s_lshr_b32 s51, s36, 1
    s_and_b32 s52, s36, 1
    s_mul_i32 s52, s52, 5
    s_add_u32 s52, s52, s32
    s_mul_i32 s36, s51, 40960
    s_lshl_b32 s37, s52, 7
    s_add_u32 s36, s36, s37
    s_add_u32 s56, s70, s36
    s_addc_u32 s57, s71, 0
    s_and_b32 s57, s57, 0xffff
    s_mov_b32 s58, 39808
    s_mov_b32 s59, 0x00020000
    s_cmp_lt_u32 s32, 5
    s_cselect_b32 s58, s58, 0
    s_mul_i32 s60, s51, 5120
    s_lshl_b32 s61, s52, 2
    s_load_dwordx2 s[64:65], s[0:1], 0
    s_load_dwordx2 s[66:67], s[0:1], 64
    s_load_dwordx2 s[68:69], s[0:1], 120
    s_load_dwordx2 s[70:71], s[0:1], 112
    s_load_dwordx4 s[44:47], s[0:1], 8
    s_load_dwordx2 s[48:49], s[0:1], 24
    s_lshl_b32 s36, s34, 2
    s_sub_u32 s37, s32, s36
    s_add_u32 s35, s37, 60
    s_sub_u32 s37, 7, s37
    s_cmp_lt_u32 s32, 4
    s_cselect_b32 s35, s35, s37
    v_lshlrev_b32 v4, 4, v1
    v_and_b32 v8, 31, v1
    v_bfe_u32 v9, v1, 1, 3
    v_lshrrev_b32 v10, 5, v1
    v_xor_b32 v9, v9, v10
    v_lshlrev_b32 v8, 7, v8
    s_and_b32 s36, s32, 1
    s_lshl_b32 s36, s36, 14
    v_add_u32 v8, s36, v8
    v_xor_b32 v10, 0, v9
    v_lshl_add_u32 v38, v10, 4, v8
    v_xor_b32 v10, 2, v9
    v_lshl_add_u32 v39, v10, 4, v8
    v_xor_b32 v10, 4, v9
    v_lshl_add_u32 v40, v10, 4, v8
    v_xor_b32 v10, 6, v9
    v_lshl_add_u32 v41, v10, 4, v8
    s_sub_u32 s42, s38, s36
    v_bfe_u32 v8, v1, 2, 2
    v_lshrrev_b32 v9, 5, v1
    v_lshl_add_u32 v9, v9, 3, v8
    v_lshlrev_b32 v9, 8, v9
    v_bfe_u32 v10, v1, 4, 1
    v_lshl_add_u32 v9, v10, 5, v9
    v_and_b32 v10, 3, v1
    v_lshl_add_u32 v9, v10, 3, v9
    v_xor_b32 v10, 0, v8
    v_lshl_add_u32 v43, v10, 6, v9
    v_xor_b32 v10, 1, v8
    v_lshl_add_u32 v44, v10, 6, v9
    v_xor_b32 v10, 2, v8
    v_lshl_add_u32 v45, v10, 6, v9
    v_xor_b32 v10, 3, v8
    v_lshl_add_u32 v46, v10, 6, v9
    s_lshr_b32 s36, s32, 1
    v_xor_b32 v10, s36, v8
    v_lshl_add_u32 v42, v10, 6, v9
    v_and_b32 v8, 31, v1
    v_lshrrev_b32 v9, 5, v1
    v_lshlrev_b32 v9, 2, v9
    v_sub_u32 v8, v8, v9
    v_cvt_f32_i32 v8, v8
    v_add_f32 v8, 0.5, v8
    v_mul_f32 v6, 0x71800000, v8
    s_lshl_b32 s36, s32, 8
    v_lshlrev_b32 v8, 2, v1
    v_add_u32 v14, s36, v8
    v_and_b32 v8, 7, v1
    v_mul_u32_u24 v15, 260, v8
    v_and_b32 v8, 3, v1
    v_mul_u32_u24 v13, 260, v8
    s_lshl_b32 s36, s33, 3
    v_mov_b32 v19, s36
    s_waitcnt lgkmcnt(0)
    s_mul_i32 s36, s35, 40960
    s_add_u32 s12, s64, s36
    s_addc_u32 s13, s65, 0
    s_and_b32 s13, s13, 0xffff
    s_mov_b32 s14, 40960
    s_mov_b32 s15, 0x00020000
    s_lshl_b32 s36, s33, 8
    s_add_u32 s16, s66, s36
    s_addc_u32 s17, s67, 0
    s_and_b32 s17, s17, 0xffff
    s_mov_b32 s18, 5234944
    s_mov_b32 s19, 0x00020000
    s_mul_i32 s36, s33, 1056768
    s_add_u32 s20, s68, s36
    s_addc_u32 s21, s69, 0
    s_and_b32 s21, s21, 0xffff
    s_mov_b32 s22, 1056768
    s_mov_b32 s23, 0x00020000
    s_add_u32 s24, s68, 58720256
    s_addc_u32 s25, s69, 0
    s_and_b32 s25, s25, 0xffff
    s_mov_b32 s26, 5242880
    s_mov_b32 s27, 0x00020000
    s_cmp_lt_u32 s32, 5
    s_cselect_b32 s26, s26, 0
    v_bfe_u32 v8, v1, 2, 3
    v_lshrrev_b32 v9, 5, v1
    v_lshlrev_b32 v9, 11, v9
    v_lshl_add_u32 v9, v8, 7, v9
    v_lshrrev_b32 v8, 1, v8
    v_bfe_u32 v10, v1, 1, 1
    v_xor_b32 v8, v8, v10
    v_lshl_add_u32 v9, v8, 4, v9
    v_and_b32 v8, 1, v1
    v_lshl_add_u32 v9, v8, 3, v9
    s_min_u32 s36, s38, 16384
    s_add_u32 s36, s36, 12288
    v_add_u32 v21, s36, v9
    s_mov_b32 s28, s70
    s_and_b32 s29, s71, 0xffff
    s_mov_b32 s30, 256
    s_mov_b32 s31, 0x00020000
    s_add_u32 s96, s68, 68157440
    s_addc_u32 s97, s69, 0
    s_and_b32 s97, s97, 0xffff
    s_mov_b32 s98, 40960
    s_mov_b32 s99, 0x00020000
    s_lshr_b32 s53, s35, 1
    s_lshl_b32 s53, s53, 9
    s_and_b32 s36, s35, 1
    s_add_u32 s53, s53, s36
    s_and_b32 s36, s33, 3
    s_lshl_b32 s36, s36, 7
    s_add_u32 s53, s53, s36
    s_lshr_b32 s36, s33, 2
    s_lshl_b32 s36, s36, 1
    s_add_u32 s53, s53, s36
    s_lshl_b32 s36, s34, 5
    s_add_u32 s36, s36, s33
    s_sub_u32 s37, s32, 4
    s_lshl_b32 s55, s36, 2
    s_add_u32 s55, s55, s32
    s_sub_u32 s55, s55, 384
    s_and_b32 s55, s55, 1023
    s_xor_b32 s37, s55, 3
    s_sub_u32 s37, 639, s37
    s_cmp_lt_u32 s55, 640
    s_cselect_b32 s55, s37, s55
    s_sub_u32 s37, s32, 4
    s_cmp_lt_u32 s32, 4
    s_cselect_b32 s55, s55, 0x1000
    s_lshl_b32 s101, s36, 1
    s_add_u32 s101, s101, s37
    s_sub_u32 s101, s101, 0
    s_min_u32 s101, s101, 511
    s_cmp_lt_u32 s37, 2
    s_cselect_b32 s101, s101, 511
    s_lshr_b32 s54, s101, 3
    s_mul_i32 s54, s54, 120
    s_add_u32 s54, s54, s101
    s_add_u32 s54, s54, 16384
    s_cmp_lt_u32 s101, 320
    s_cselect_b32 s54, s54, 0x100000
    s_lshr_b32 s100, s55, 3
    s_mul_i32 s100, s100, 120
    s_add_u32 s100, s100, s55
    s_add_u32 s100, s100, 24576
    s_cmp_lt_u32 s55, 1024
    s_cselect_b32 s100, s100, 0x100000
    s_lshl_b32 s36, s34, 5
    s_add_u32 s36, s36, s33
    s_lshr_b32 s37, s36, 2
    s_and_b32 s36, s36, 3
    s_mul_i32 s36, s36, 5
    s_add_u32 s36, s36, s32
    s_lshl_b32 s36, s36, 4
    v_and_b32 v8, 15, v1
    v_add_u32 v8, s36, v8
    v_lshrrev_b32 v9, 4, v1
    v_lshlrev_b32 v253, 13, v8
    v_lshl_add_u32 v253, v9, 10, v253
    s_lshl_b32 s36, s37, 4
    s_sub_u32 s36, 1008, s36
    v_add_u32 v253, s36, v253
    s_lshl_b32 s37, s37, 5
    v_add_u32 v9, s37, v9
    v_mul_u32_u24 v252, 1280, v9
    v_lshl_add_u32 v252, v8, 2, v252
    v_add_u32 v16, 1280, v252
    v_lshlrev_b32 v2, 4, v8
    s_cmp_lt_u32 s32, 5
    s_cselect_b32 s36, 2621440, 0
    s_mov_b32 s64, s44
    s_and_b32 s65, s45, 0xffff
    s_mov_b32 s66, s36
    s_mov_b32 s67, 0x00020000
    s_mov_b32 s68, s48
    s_and_b32 s69, s49, 0xffff
    s_mov_b32 s70, 5120
    s_mov_b32 s71, 0x00020000
    s_mov_b32 s43, s36
    s_lshl_b32 s36, s34, 1
    s_and_b32 s37, s32, 1
    s_add_u32 s36, s36, s37
    s_lshl_b32 s36, s36, 16
    s_lshr_b32 s37, s32, 1
    s_lshl_b32 s51, s37, 11
    s_add_u32 s51, s51, s36
    s_lshl_b32 s52, s37, 10
    s_add_u32 s52, s52, s36
    v_bfe_u32 v8, v1, 1, 4
    v_and_b32 v9, 1, v1
    v_lshlrev_b32 v9, 7, v9
    v_lshl_add_u32 v20, v8, 13, v9
    v_and_b32 v8, 7, v8
    s_and_b32 s36, s33, 3
    s_lshl_b32 s36, s36, 3
    v_add_u32 v8, s36, v8
    v_mul_u32_u24 v8, 1280, v8
    v_add_u32 v22, v8, v9
    s_mov_b32 s47, 0x41400000
    s_waitcnt vmcnt(0)
    s_barrier
    ds_read_b64_tr_b16 v[192:193], v42 offset:32768
    ds_read_b64_tr_b16 v[194:195], v42 offset:33792
    ds_read_b128 v[176:179], v38 offset:0
    ds_read_b64_tr_b16 v[196:197], v42 offset:49152
    ds_read_b64_tr_b16 v[198:199], v42 offset:50176
    ds_read_b128 v[180:183], v38 offset:4096
    ds_read_b128 v[184:187], v38 offset:8192
    ds_read_b128 v[188:191], v38 offset:12288
    s_waitcnt lgkmcnt(5)
    v_mfma_f32_32x32x16_bf16 v[48:63], v[192:195], v[176:179], 0
    ds_read_b64_tr_b16 v[216:217], v42 offset:36864
    s_mov_b32 s39, 128
    s_add_u32 m0, s38, 65536
    s_nop 0
    buffer_load_dwordx4 v26, s[4:7], s39 offen offset:0 lds
    s_waitcnt lgkmcnt(4)
    v_mfma_f32_32x32x16_bf16 v[64:79], v[176:179], v[196:199], 0
    ds_read_b64_tr_b16 v[218:219], v42 offset:37888
    buffer_load_dwordx4 v27, s[4:7], s39 offen offset:1024 lds
    s_waitcnt lgkmcnt(4)
    v_mfma_f32_32x32x16_bf16 v[80:95], v[192:195], v[180:183], 0
    ds_read_b128 v[200:203], v39 offset:0
    buffer_load_dwordx4 v28, s[4:7], s39 offen offset:2048 lds
    v_mfma_f32_32x32x16_bf16 v[96:111], v[180:183], v[196:199], 0
    ds_read_b64_tr_b16 v[220:221], v42 offset:53248
    buffer_load_dwordx4 v29, s[4:7], s39 offen offset:3072 lds
    s_waitcnt lgkmcnt(5)
    v_mfma_f32_32x32x16_bf16 v[112:127], v[192:195], v[184:187], 0
    ds_read_b64_tr_b16 v[222:223], v42 offset:54272
    s_add_u32 s39, s40, 524288
    s_add_u32 m0, s38, 98304
    s_nop 0
    buffer_load_dwordx4 v34, s[8:11], s39 offen offset:0 lds
    v_mfma_f32_32x32x16_bf16 v[128:143], v[184:187], v[196:199], 0
    ds_read_b128 v[204:207], v39 offset:4096
    buffer_load_dwordx4 v35, s[8:11], s39 offen offset:1024 lds
    s_waitcnt lgkmcnt(6)
    v_mfma_f32_32x32x16_bf16 v[144:159], v[192:195], v[188:191], 0
    ds_read_b128 v[208:211], v39 offset:8192
    buffer_load_dwordx4 v36, s[8:11], s39 offen offset:2048 lds
    v_mfma_f32_32x32x16_bf16 v[160:175], v[188:191], v[196:199], 0
    ds_read_b128 v[212:215], v39 offset:12288
    buffer_load_dwordx4 v37, s[8:11], s39 offen offset:3072 lds
    s_waitcnt lgkmcnt(5)
    v_mfma_f32_32x32x16_bf16 v[48:63], v[216:219], v[200:203], v[48:63]
    ds_read_b64_tr_b16 v[192:193], v42 offset:40960
    s_waitcnt lgkmcnt(4)
    v_mfma_f32_32x32x16_bf16 v[64:79], v[200:203], v[220:223], v[64:79]
    ds_read_b64_tr_b16 v[194:195], v42 offset:41984
    v_and_b32 v8, 7, v1
    v_lshlrev_b32 v8, 7, v8
    s_lshl_b32 s36, s33, 10
    buffer_load_dword v24, v8, s[4:7], s36 offen sc1
    s_waitcnt lgkmcnt(4)
    v_mfma_f32_32x32x16_bf16 v[80:95], v[216:219], v[204:207], v[80:95]
    ds_read_b128 v[176:179], v40 offset:0
    v_mfma_f32_32x32x16_bf16 v[96:111], v[204:207], v[220:223], v[96:111]
    ds_read_b64_tr_b16 v[196:197], v42 offset:57344
    s_lshl_b32 s36, s34, 19
    s_add_u32 s36, s36, s40
    buffer_load_dword v24, v20, s[8:11], s36 offen sc1
    s_waitcnt lgkmcnt(5)
    v_mfma_f32_32x32x16_bf16 v[112:127], v[216:219], v[208:211], v[112:127]
    ds_read_b64_tr_b16 v[198:199], v42 offset:58368
    v_mfma_f32_32x32x16_bf16 v[128:143], v[208:211], v[220:223], v[128:143]
    ds_read_b128 v[180:183], v40 offset:4096
    s_mov_b32 s39, 256
    s_add_u32 m0, s38, 131072
    s_nop 0
    buffer_load_dwordx4 v26, s[4:7], s39 offen offset:0 lds
    s_waitcnt lgkmcnt(6)
    v_mfma_f32_32x32x16_bf16 v[144:159], v[216:219], v[212:215], v[144:159]
    ds_read_b128 v[184:187], v40 offset:8192
    v_mfma_f32_32x32x16_bf16 v[160:175], v[212:215], v[220:223], v[160:175]
    ds_read_b128 v[188:191], v40 offset:12288
    buffer_load_dwordx4 v27, s[4:7], s39 offen offset:1024 lds
    s_waitcnt lgkmcnt(5)
    v_mfma_f32_32x32x16_bf16 v[48:63], v[192:195], v[176:179], v[48:63]
    ds_read_b64_tr_b16 v[216:217], v42 offset:45056
    ds_read_b64_tr_b16 v[218:219], v42 offset:46080
    s_waitcnt lgkmcnt(5)
    v_mfma_f32_32x32x16_bf16 v[64:79], v[176:179], v[196:199], v[64:79]
    ds_read_b128 v[200:203], v41 offset:0
    ds_read_b64_tr_b16 v[220:221], v42 offset:61440
    buffer_load_dwordx4 v28, s[4:7], s39 offen offset:2048 lds
    s_waitcnt lgkmcnt(6)
    v_mfma_f32_32x32x16_bf16 v[80:95], v[192:195], v[180:183], v[80:95]
    ds_read_b64_tr_b16 v[222:223], v42 offset:62464
    ds_read_b128 v[204:207], v41 offset:4096
    v_mfma_f32_32x32x16_bf16 v[96:111], v[180:183], v[196:199], v[96:111]
    ds_read_b128 v[208:211], v41 offset:8192
    ds_read_b128 v[212:215], v41 offset:12288
    buffer_load_dwordx4 v29, s[4:7], s39 offen offset:3072 lds
    s_waitcnt lgkmcnt(9)
    v_mfma_f32_32x32x16_bf16 v[112:127], v[192:195], v[184:187], v[112:127]
    v_mfma_f32_32x32x16_bf16 v[128:143], v[184:187], v[196:199], v[128:143]
    s_waitcnt lgkmcnt(8)
    v_mfma_f32_32x32x16_bf16 v[144:159], v[192:195], v[188:191], v[144:159]
    v_mfma_f32_32x32x16_bf16 v[160:175], v[188:191], v[196:199], v[160:175]
    s_waitcnt vmcnt(6) lgkmcnt(0)
    s_barrier
    v_mfma_f32_32x32x16_bf16 v[48:63], v[216:219], v[200:203], v[48:63]
    v_add_u32 v42, 98304, v42
    ds_read_b64_tr_b16 v[192:193], v42 offset:0
    v_mfma_f32_32x32x16_bf16 v[64:79], v[200:203], v[220:223], v[64:79]
    ds_read_b64_tr_b16 v[194:195], v42 offset:1024
    s_add_u32 s39, s40, 1048576
    s_add_u32 m0, s38, 0
    s_nop 0
    buffer_load_dwordx4 v34, s[8:11], s39 offen offset:0 lds
    v_mfma_f32_32x32x16_bf16 v[80:95], v[216:219], v[204:207], v[80:95]
    v_add_u32 v38, 65536, v38
    ds_read_b128 v[176:179], v38 offset:0
    v_mfma_f32_32x32x16_bf16 v[96:111], v[204:207], v[220:223], v[96:111]
    ds_read_b64_tr_b16 v[196:197], v42 offset:16384
    buffer_load_dwordx4 v35, s[8:11], s39 offen offset:1024 lds
    v_mfma_f32_32x32x16_bf16 v[112:127], v[216:219], v[208:211], v[112:127]
    ds_read_b64_tr_b16 v[198:199], v42 offset:17408
    v_mfma_f32_32x32x16_bf16 v[128:143], v[208:211], v[220:223], v[128:143]
    ds_read_b128 v[180:183], v38 offset:4096
    buffer_load_dwordx4 v36, s[8:11], s39 offen offset:2048 lds
    v_mfma_f32_32x32x16_bf16 v[144:159], v[216:219], v[212:215], v[144:159]
    ds_read_b128 v[184:187], v38 offset:8192
    v_mfma_f32_32x32x16_bf16 v[160:175], v[212:215], v[220:223], v[160:175]
    ds_read_b128 v[188:191], v38 offset:12288
    buffer_load_dwordx4 v37, s[8:11], s39 offen offset:3072 lds
    s_waitcnt lgkmcnt(5)
    v_mfma_f32_32x32x16_bf16 v[48:63], v[192:195], v[176:179], v[48:63]
    ds_read_b64_tr_b16 v[216:217], v42 offset:4096
    s_waitcnt lgkmcnt(4)
    v_mfma_f32_32x32x16_bf16 v[64:79], v[176:179], v[196:199], v[64:79]
    ds_read_b64_tr_b16 v[218:219], v42 offset:5120
    s_mov_b32 s39, 384
    s_add_u32 m0, s38, 32768
    s_nop 0
    buffer_load_dwordx4 v26, s[4:7], s39 offen offset:0 lds
    s_waitcnt lgkmcnt(4)
    v_mfma_f32_32x32x16_bf16 v[80:95], v[192:195], v[180:183], v[80:95]
    v_add_u32 v39, 65536, v39
    ds_read_b128 v[200:203], v39 offset:0
    v_mfma_f32_32x32x16_bf16 v[96:111], v[180:183], v[196:199], v[96:111]
    ds_read_b64_tr_b16 v[220:221], v42 offset:20480
    buffer_load_dwordx4 v27, s[4:7], s39 offen offset:1024 lds
    s_waitcnt lgkmcnt(5)
    v_mfma_f32_32x32x16_bf16 v[112:127], v[192:195], v[184:187], v[112:127]
    ds_read_b64_tr_b16 v[222:223], v42 offset:21504
    v_mfma_f32_32x32x16_bf16 v[128:143], v[184:187], v[196:199], v[128:143]
    ds_read_b128 v[204:207], v39 offset:4096
    buffer_load_dwordx4 v28, s[4:7], s39 offen offset:2048 lds
    s_waitcnt lgkmcnt(6)
    v_mfma_f32_32x32x16_bf16 v[144:159], v[192:195], v[188:191], v[144:159]
    ds_read_b128 v[208:211], v39 offset:8192
    v_mfma_f32_32x32x16_bf16 v[160:175], v[188:191], v[196:199], v[160:175]
    ds_read_b128 v[212:215], v39 offset:12288
    buffer_load_dwordx4 v29, s[4:7], s39 offen offset:3072 lds
    s_waitcnt lgkmcnt(5)
    v_mfma_f32_32x32x16_bf16 v[48:63], v[216:219], v[200:203], v[48:63]
    ds_read_b64_tr_b16 v[192:193], v42 offset:8192
    s_waitcnt lgkmcnt(4)
    v_mfma_f32_32x32x16_bf16 v[64:79], v[200:203], v[220:223], v[64:79]
    ds_read_b64_tr_b16 v[194:195], v42 offset:9216
    s_waitcnt lgkmcnt(4)
    v_mfma_f32_32x32x16_bf16 v[80:95], v[216:219], v[204:207], v[80:95]
    v_add_u32 v40, 65536, v40
    ds_read_b128 v[176:179], v40 offset:0
    v_mfma_f32_32x32x16_bf16 v[96:111], v[204:207], v[220:223], v[96:111]
    ds_read_b64_tr_b16 v[196:197], v42 offset:24576
    s_waitcnt lgkmcnt(5)
    v_mfma_f32_32x32x16_bf16 v[112:127], v[216:219], v[208:211], v[112:127]
    ds_read_b64_tr_b16 v[198:199], v42 offset:25600
    v_mfma_f32_32x32x16_bf16 v[128:143], v[208:211], v[220:223], v[128:143]
    ds_read_b128 v[180:183], v40 offset:4096
    s_waitcnt lgkmcnt(6)
    v_mfma_f32_32x32x16_bf16 v[144:159], v[216:219], v[212:215], v[144:159]
    ds_read_b128 v[184:187], v40 offset:8192
    v_mfma_f32_32x32x16_bf16 v[160:175], v[212:215], v[220:223], v[160:175]
    ds_read_b128 v[188:191], v40 offset:12288
    s_waitcnt lgkmcnt(5)
    v_mfma_f32_32x32x16_bf16 v[48:63], v[192:195], v[176:179], v[48:63]
    ds_read_b64_tr_b16 v[216:217], v42 offset:12288
    ds_read_b64_tr_b16 v[218:219], v42 offset:13312
    s_waitcnt lgkmcnt(5)
    v_mfma_f32_32x32x16_bf16 v[64:79], v[176:179], v[196:199], v[64:79]
    v_add_u32 v41, 65536, v41
    ds_read_b128 v[200:203], v41 offset:0
    ds_read_b64_tr_b16 v[220:221], v42 offset:28672
    s_waitcnt lgkmcnt(6)
    v_mfma_f32_32x32x16_bf16 v[80:95], v[192:195], v[180:183], v[80:95]
    ds_read_b64_tr_b16 v[222:223], v42 offset:29696
    ds_read_b128 v[204:207], v41 offset:4096
    v_mfma_f32_32x32x16_bf16 v[96:111], v[180:183], v[196:199], v[96:111]
    ds_read_b128 v[208:211], v41 offset:8192
    ds_read_b128 v[212:215], v41 offset:12288
    s_waitcnt lgkmcnt(9)
    v_mfma_f32_32x32x16_bf16 v[112:127], v[192:195], v[184:187], v[112:127]
    v_mfma_f32_32x32x16_bf16 v[128:143], v[184:187], v[196:199], v[128:143]
    s_waitcnt lgkmcnt(8)
    v_mfma_f32_32x32x16_bf16 v[144:159], v[192:195], v[188:191], v[144:159]
    v_mfma_f32_32x32x16_bf16 v[160:175], v[188:191], v[196:199], v[160:175]
    s_waitcnt vmcnt(4) lgkmcnt(0)
    s_barrier
    v_mfma_f32_32x32x16_bf16 v[48:63], v[216:219], v[200:203], v[48:63]
    v_subrev_u32 v42, 98304, v42
    ds_read_b64_tr_b16 v[192:193], v42 offset:0
    v_mfma_f32_32x32x16_bf16 v[64:79], v[200:203], v[220:223], v[64:79]
    ds_read_b64_tr_b16 v[194:195], v42 offset:1024
    s_add_u32 s39, s40, 1572864
    s_add_u32 m0, s38, 65536
    s_nop 0
    buffer_load_dwordx4 v34, s[8:11], s39 offen offset:0 lds
    v_mfma_f32_32x32x16_bf16 v[80:95], v[216:219], v[204:207], v[80:95]
    v_add_u32 v38, 65536, v38
    ds_read_b128 v[176:179], v38 offset:0
    v_mfma_f32_32x32x16_bf16 v[96:111], v[204:207], v[220:223], v[96:111]
    ds_read_b64_tr_b16 v[196:197], v42 offset:16384
    buffer_load_dwordx4 v35, s[8:11], s39 offen offset:1024 lds
    v_mfma_f32_32x32x16_bf16 v[112:127], v[216:219], v[208:211], v[112:127]
    ds_read_b64_tr_b16 v[198:199], v42 offset:17408
    v_mfma_f32_32x32x16_bf16 v[128:143], v[208:211], v[220:223], v[128:143]
    ds_read_b128 v[180:183], v38 offset:4096
    buffer_load_dwordx4 v36, s[8:11], s39 offen offset:2048 lds
    v_mfma_f32_32x32x16_bf16 v[144:159], v[216:219], v[212:215], v[144:159]
    ds_read_b128 v[184:187], v38 offset:8192
    v_mfma_f32_32x32x16_bf16 v[160:175], v[212:215], v[220:223], v[160:175]
    ds_read_b128 v[188:191], v38 offset:12288
    buffer_load_dwordx4 v37, s[8:11], s39 offen offset:3072 lds
    s_waitcnt lgkmcnt(5)
    v_mfma_f32_32x32x16_bf16 v[48:63], v[192:195], v[176:179], v[48:63]
    ds_read_b64_tr_b16 v[216:217], v42 offset:4096
    s_waitcnt lgkmcnt(4)
    v_mfma_f32_32x32x16_bf16 v[64:79], v[176:179], v[196:199], v[64:79]
    ds_read_b64_tr_b16 v[218:219], v42 offset:5120
    v_min_u32 v8, 9, v1
    v_lshlrev_b32 v8, 7, v8
    s_mul_i32 s36, s33, 1280
    buffer_load_dword v24, v8, s[12:15], s36 offen sc1
    s_waitcnt lgkmcnt(4)
    v_mfma_f32_32x32x16_bf16 v[80:95], v[192:195], v[180:183], v[80:95]
    v_add_u32 v39, 65536, v39
    ds_read_b128 v[200:203], v39 offset:0
    v_mfma_f32_32x32x16_bf16 v[96:111], v[180:183], v[196:199], v[96:111]
    ds_read_b64_tr_b16 v[220:221], v42 offset:20480
    s_mov_b32 s39, 512
    s_add_u32 m0, s38, 98304
    s_nop 0
    buffer_load_dwordx4 v26, s[4:7], s39 offen offset:0 lds
    s_waitcnt lgkmcnt(5)
    v_mfma_f32_32x32x16_bf16 v[112:127], v[192:195], v[184:187], v[112:127]
    ds_read_b64_tr_b16 v[222:223], v42 offset:21504
    v_mfma_f32_32x32x16_bf16 v[128:143], v[184:187], v[196:199], v[128:143]
    ds_read_b128 v[204:207], v39 offset:4096
    buffer_load_dwordx4 v27, s[4:7], s39 offen offset:1024 lds
    s_waitcnt lgkmcnt(6)
    v_mfma_f32_32x32x16_bf16 v[144:159], v[192:195], v[188:191], v[144:159]
    ds_read_b128 v[208:211], v39 offset:8192
    v_mfma_f32_32x32x16_bf16 v[160:175], v[188:191], v[196:199], v[160:175]
    ds_read_b128 v[212:215], v39 offset:12288
    buffer_load_dwordx4 v28, s[4:7], s39 offen offset:2048 lds
    s_waitcnt lgkmcnt(5)
    v_mfma_f32_32x32x16_bf16 v[48:63], v[216:219], v[200:203], v[48:63]
    ds_read_b64_tr_b16 v[192:193], v42 offset:8192
    s_waitcnt lgkmcnt(4)
    v_mfma_f32_32x32x16_bf16 v[64:79], v[200:203], v[220:223], v[64:79]
    ds_read_b64_tr_b16 v[194:195], v42 offset:9216
    buffer_load_dwordx4 v29, s[4:7], s39 offen offset:3072 lds
    s_waitcnt lgkmcnt(4)
    v_mfma_f32_32x32x16_bf16 v[80:95], v[216:219], v[204:207], v[80:95]
    v_add_u32 v40, 65536, v40
    ds_read_b128 v[176:179], v40 offset:0
    v_mfma_f32_32x32x16_bf16 v[96:111], v[204:207], v[220:223], v[96:111]
    ds_read_b64_tr_b16 v[196:197], v42 offset:24576
    s_waitcnt lgkmcnt(5)
    v_mfma_f32_32x32x16_bf16 v[112:127], v[216:219], v[208:211], v[112:127]
    ds_read_b64_tr_b16 v[198:199], v42 offset:25600
    v_mfma_f32_32x32x16_bf16 v[128:143], v[208:211], v[220:223], v[128:143]
    ds_read_b128 v[180:183], v40 offset:4096
    s_waitcnt lgkmcnt(6)
    v_mfma_f32_32x32x16_bf16 v[144:159], v[216:219], v[212:215], v[144:159]
    ds_read_b128 v[184:187], v40 offset:8192
    v_mfma_f32_32x32x16_bf16 v[160:175], v[212:215], v[220:223], v[160:175]
    ds_read_b128 v[188:191], v40 offset:12288
    s_waitcnt lgkmcnt(5)
    v_mfma_f32_32x32x16_bf16 v[48:63], v[192:195], v[176:179], v[48:63]
    ds_read_b64_tr_b16 v[216:217], v42 offset:12288
    ds_read_b64_tr_b16 v[218:219], v42 offset:13312
    s_waitcnt lgkmcnt(5)
    v_mfma_f32_32x32x16_bf16 v[64:79], v[176:179], v[196:199], v[64:79]
    v_add_u32 v41, 65536, v41
    ds_read_b128 v[200:203], v41 offset:0
    ds_read_b64_tr_b16 v[220:221], v42 offset:28672
    s_waitcnt lgkmcnt(6)
    v_mfma_f32_32x32x16_bf16 v[80:95], v[192:195], v[180:183], v[80:95]
    ds_read_b64_tr_b16 v[222:223], v42 offset:29696
    ds_read_b128 v[204:207], v41 offset:4096
    v_mfma_f32_32x32x16_bf16 v[96:111], v[180:183], v[196:199], v[96:111]
    ds_read_b128 v[208:211], v41 offset:8192
    ds_read_b128 v[212:215], v41 offset:12288
    s_waitcnt lgkmcnt(9)
    v_mfma_f32_32x32x16_bf16 v[112:127], v[192:195], v[184:187], v[112:127]
    v_mfma_f32_32x32x16_bf16 v[128:143], v[184:187], v[196:199], v[128:143]
    s_waitcnt lgkmcnt(8)
    v_mfma_f32_32x32x16_bf16 v[144:159], v[192:195], v[188:191], v[144:159]
    v_mfma_f32_32x32x16_bf16 v[160:175], v[188:191], v[196:199], v[160:175]
    s_waitcnt vmcnt(5) lgkmcnt(0)
    s_barrier
    v_mfma_f32_32x32x16_bf16 v[48:63], v[216:219], v[200:203], v[48:63]
    v_add_u32 v42, 65536, v42
    ds_read_b64_tr_b16 v[192:193], v42 offset:0
    v_mfma_f32_32x32x16_bf16 v[64:79], v[200:203], v[220:223], v[64:79]
    ds_read_b64_tr_b16 v[194:195], v42 offset:1024
    s_add_u32 s39, s40, 2097152
    s_add_u32 m0, s38, 131072
    s_nop 0
    buffer_load_dwordx4 v34, s[8:11], s39 offen offset:0 lds
    v_mfma_f32_32x32x16_bf16 v[80:95], v[216:219], v[204:207], v[80:95]
    v_subrev_u32 v38, 98304, v38
    ds_read_b128 v[176:179], v38 offset:0
    v_mfma_f32_32x32x16_bf16 v[96:111], v[204:207], v[220:223], v[96:111]
    ds_read_b64_tr_b16 v[196:197], v42 offset:16384
    buffer_load_dwordx4 v35, s[8:11], s39 offen offset:1024 lds
    v_mfma_f32_32x32x16_bf16 v[112:127], v[216:219], v[208:211], v[112:127]
    ds_read_b64_tr_b16 v[198:199], v42 offset:17408
    v_mfma_f32_32x32x16_bf16 v[128:143], v[208:211], v[220:223], v[128:143]
    ds_read_b128 v[180:183], v38 offset:4096
    buffer_load_dwordx4 v36, s[8:11], s39 offen offset:2048 lds
    v_mfma_f32_32x32x16_bf16 v[144:159], v[216:219], v[212:215], v[144:159]
    ds_read_b128 v[184:187], v38 offset:8192
    v_mfma_f32_32x32x16_bf16 v[160:175], v[212:215], v[220:223], v[160:175]
    ds_read_b128 v[188:191], v38 offset:12288
    buffer_load_dwordx4 v37, s[8:11], s39 offen offset:3072 lds
    s_waitcnt lgkmcnt(5)
    v_mfma_f32_32x32x16_bf16 v[48:63], v[192:195], v[176:179], v[48:63]
    ds_read_b64_tr_b16 v[216:217], v42 offset:4096
    s_waitcnt lgkmcnt(4)
    v_mfma_f32_32x32x16_bf16 v[64:79], v[176:179], v[196:199], v[64:79]
    ds_read_b64_tr_b16 v[218:219], v42 offset:5120
    v_min_u32 v8, 73856, v20
    s_lshl_b32 s36, s34, 3
    s_add_u32 s36, s36, s32
    s_mul_i32 s36, s36, 81920
    buffer_load_dword v24, v8, s[16:19], s36 offen sc1
    s_waitcnt lgkmcnt(4)
    v_mfma_f32_32x32x16_bf16 v[80:95], v[192:195], v[180:183], v[80:95]
    v_subrev_u32 v39, 98304, v39
    ds_read_b128 v[200:203], v39 offset:0
    v_mfma_f32_32x32x16_bf16 v[96:111], v[180:183], v[196:199], v[96:111]
    ds_read_b64_tr_b16 v[220:221], v42 offset:20480
    s_mov_b32 s39, 640
    s_add_u32 m0, s38, 0
    s_nop 0
    buffer_load_dwordx4 v26, s[4:7], s39 offen offset:0 lds
    s_waitcnt lgkmcnt(5)
    v_mfma_f32_32x32x16_bf16 v[112:127], v[192:195], v[184:187], v[112:127]
    ds_read_b64_tr_b16 v[222:223], v42 offset:21504
    v_mfma_f32_32x32x16_bf16 v[128:143], v[184:187], v[196:199], v[128:143]
    ds_read_b128 v[204:207], v39 offset:4096
    buffer_load_dwordx4 v27, s[4:7], s39 offen offset:1024 lds
    s_waitcnt lgkmcnt(6)
    v_mfma_f32_32x32x16_bf16 v[144:159], v[192:195], v[188:191], v[144:159]
    ds_read_b128 v[208:211], v39 offset:8192
    v_mfma_f32_32x32x16_bf16 v[160:175], v[188:191], v[196:199], v[160:175]
    ds_read_b128 v[212:215], v39 offset:12288
    buffer_load_dwordx4 v28, s[4:7], s39 offen offset:2048 lds
    s_waitcnt lgkmcnt(5)
    v_mfma_f32_32x32x16_bf16 v[48:63], v[216:219], v[200:203], v[48:63]
    ds_read_b64_tr_b16 v[192:193], v42 offset:8192
    s_waitcnt lgkmcnt(4)
    v_mfma_f32_32x32x16_bf16 v[64:79], v[200:203], v[220:223], v[64:79]
    ds_read_b64_tr_b16 v[194:195], v42 offset:9216
    buffer_load_dwordx4 v29, s[4:7], s39 offen offset:3072 lds
    s_waitcnt lgkmcnt(4)
    v_mfma_f32_32x32x16_bf16 v[80:95], v[216:219], v[204:207], v[80:95]
    v_subrev_u32 v40, 98304, v40
    ds_read_b128 v[176:179], v40 offset:0
    v_mfma_f32_32x32x16_bf16 v[96:111], v[204:207], v[220:223], v[96:111]
    ds_read_b64_tr_b16 v[196:197], v42 offset:24576
    s_waitcnt lgkmcnt(5)
    v_mfma_f32_32x32x16_bf16 v[112:127], v[216:219], v[208:211], v[112:127]
    ds_read_b64_tr_b16 v[198:199], v42 offset:25600
    v_mfma_f32_32x32x16_bf16 v[128:143], v[208:211], v[220:223], v[128:143]
    ds_read_b128 v[180:183], v40 offset:4096
    s_waitcnt lgkmcnt(6)
    v_mfma_f32_32x32x16_bf16 v[144:159], v[216:219], v[212:215], v[144:159]
    ds_read_b128 v[184:187], v40 offset:8192
    v_mfma_f32_32x32x16_bf16 v[160:175], v[212:215], v[220:223], v[160:175]
    ds_read_b128 v[188:191], v40 offset:12288
    s_waitcnt lgkmcnt(5)
    v_mfma_f32_32x32x16_bf16 v[48:63], v[192:195], v[176:179], v[48:63]
    ds_read_b64_tr_b16 v[216:217], v42 offset:12288
    ds_read_b64_tr_b16 v[218:219], v42 offset:13312
    s_waitcnt lgkmcnt(5)
    v_mfma_f32_32x32x16_bf16 v[64:79], v[176:179], v[196:199], v[64:79]
    v_subrev_u32 v41, 98304, v41
    ds_read_b128 v[200:203], v41 offset:0
    ds_read_b64_tr_b16 v[220:221], v42 offset:28672
    s_waitcnt lgkmcnt(6)
    v_mfma_f32_32x32x16_bf16 v[80:95], v[192:195], v[180:183], v[80:95]
    ds_read_b64_tr_b16 v[222:223], v42 offset:29696
    ds_read_b128 v[204:207], v41 offset:4096
    v_mfma_f32_32x32x16_bf16 v[96:111], v[180:183], v[196:199], v[96:111]
    ds_read_b128 v[208:211], v41 offset:8192
    ds_read_b128 v[212:215], v41 offset:12288
    s_waitcnt lgkmcnt(9)
    v_mfma_f32_32x32x16_bf16 v[112:127], v[192:195], v[184:187], v[112:127]
    v_mfma_f32_32x32x16_bf16 v[128:143], v[184:187], v[196:199], v[128:143]
    s_waitcnt lgkmcnt(8)
    v_mfma_f32_32x32x16_bf16 v[144:159], v[192:195], v[188:191], v[144:159]
    v_mfma_f32_32x32x16_bf16 v[160:175], v[188:191], v[196:199], v[160:175]
    s_waitcnt vmcnt(5) lgkmcnt(0)
    s_barrier
    v_mfma_f32_32x32x16_bf16 v[48:63], v[216:219], v[200:203], v[48:63]
    v_add_u32 v42, 65536, v42
    ds_read_b64_tr_b16 v[192:193], v42 offset:0
    v_mfma_f32_32x32x16_bf16 v[64:79], v[200:203], v[220:223], v[64:79]
    ds_read_b64_tr_b16 v[194:195], v42 offset:1024
    s_add_u32 s39, s40, 2621440
    s_add_u32 m0, s38, 32768
    s_nop 0
    buffer_load_dwordx4 v34, s[8:11], s39 offen offset:0 lds
    v_mfma_f32_32x32x16_bf16 v[80:95], v[216:219], v[204:207], v[80:95]
    v_add_u32 v38, 65536, v38
    ds_read_b128 v[176:179], v38 offset:0
    v_mfma_f32_32x32x16_bf16 v[96:111], v[204:207], v[220:223], v[96:111]
    ds_read_b64_tr_b16 v[196:197], v42 offset:16384
    buffer_load_dwordx4 v35, s[8:11], s39 offen offset:1024 lds
    v_mfma_f32_32x32x16_bf16 v[112:127], v[216:219], v[208:211], v[112:127]
    ds_read_b64_tr_b16 v[198:199], v42 offset:17408
    v_mfma_f32_32x32x16_bf16 v[128:143], v[208:211], v[220:223], v[128:143]
    ds_read_b128 v[180:183], v38 offset:4096
    buffer_load_dwordx4 v36, s[8:11], s39 offen offset:2048 lds
    v_mfma_f32_32x32x16_bf16 v[144:159], v[216:219], v[212:215], v[144:159]
    ds_read_b128 v[184:187], v38 offset:8192
    v_mfma_f32_32x32x16_bf16 v[160:175], v[212:215], v[220:223], v[160:175]
    ds_read_b128 v[188:191], v38 offset:12288
    buffer_load_dwordx4 v37, s[8:11], s39 offen offset:3072 lds
    s_waitcnt lgkmcnt(5)
    v_mfma_f32_32x32x16_bf16 v[48:63], v[192:195], v[176:179], v[48:63]
    ds_read_b64_tr_b16 v[216:217], v42 offset:4096
    s_waitcnt lgkmcnt(4)
    v_mfma_f32_32x32x16_bf16 v[64:79], v[176:179], v[196:199], v[64:79]
    ds_read_b64_tr_b16 v[218:219], v42 offset:5120
    s_mov_b32 s39, 768
    s_add_u32 m0, s38, 65536
    s_nop 0
    buffer_load_dwordx4 v26, s[4:7], s39 offen offset:0 lds
    s_waitcnt lgkmcnt(4)
    v_mfma_f32_32x32x16_bf16 v[80:95], v[192:195], v[180:183], v[80:95]
    v_add_u32 v39, 65536, v39
    ds_read_b128 v[200:203], v39 offset:0
    v_mfma_f32_32x32x16_bf16 v[96:111], v[180:183], v[196:199], v[96:111]
    ds_read_b64_tr_b16 v[220:221], v42 offset:20480
    buffer_load_dwordx4 v27, s[4:7], s39 offen offset:1024 lds
    s_waitcnt lgkmcnt(5)
    v_mfma_f32_32x32x16_bf16 v[112:127], v[192:195], v[184:187], v[112:127]
    ds_read_b64_tr_b16 v[222:223], v42 offset:21504
    v_mfma_f32_32x32x16_bf16 v[128:143], v[184:187], v[196:199], v[128:143]
    ds_read_b128 v[204:207], v39 offset:4096
    buffer_load_dwordx4 v28, s[4:7], s39 offen offset:2048 lds
    s_waitcnt lgkmcnt(6)
    v_mfma_f32_32x32x16_bf16 v[144:159], v[192:195], v[188:191], v[144:159]
    ds_read_b128 v[208:211], v39 offset:8192
    v_mfma_f32_32x32x16_bf16 v[160:175], v[188:191], v[196:199], v[160:175]
    ds_read_b128 v[212:215], v39 offset:12288
    buffer_load_dwordx4 v29, s[4:7], s39 offen offset:3072 lds
    s_waitcnt lgkmcnt(5)
    v_mfma_f32_32x32x16_bf16 v[48:63], v[216:219], v[200:203], v[48:63]
    ds_read_b64_tr_b16 v[192:193], v42 offset:8192
    s_waitcnt lgkmcnt(4)
    v_mfma_f32_32x32x16_bf16 v[64:79], v[200:203], v[220:223], v[64:79]
    ds_read_b64_tr_b16 v[194:195], v42 offset:9216
    s_waitcnt lgkmcnt(4)
    v_mfma_f32_32x32x16_bf16 v[80:95], v[216:219], v[204:207], v[80:95]
    v_add_u32 v40, 65536, v40
    ds_read_b128 v[176:179], v40 offset:0
    v_mfma_f32_32x32x16_bf16 v[96:111], v[204:207], v[220:223], v[96:111]
    ds_read_b64_tr_b16 v[196:197], v42 offset:24576
    s_waitcnt lgkmcnt(5)
    v_mfma_f32_32x32x16_bf16 v[112:127], v[216:219], v[208:211], v[112:127]
    ds_read_b64_tr_b16 v[198:199], v42 offset:25600
    v_mfma_f32_32x32x16_bf16 v[128:143], v[208:211], v[220:223], v[128:143]
    ds_read_b128 v[180:183], v40 offset:4096
    s_waitcnt lgkmcnt(6)
    v_mfma_f32_32x32x16_bf16 v[144:159], v[216:219], v[212:215], v[144:159]
    ds_read_b128 v[184:187], v40 offset:8192
    v_mfma_f32_32x32x16_bf16 v[160:175], v[212:215], v[220:223], v[160:175]
    ds_read_b128 v[188:191], v40 offset:12288
    s_waitcnt lgkmcnt(5)
    v_mfma_f32_32x32x16_bf16 v[48:63], v[192:195], v[176:179], v[48:63]
    ds_read_b64_tr_b16 v[216:217], v42 offset:12288
    ds_read_b64_tr_b16 v[218:219], v42 offset:13312
    s_waitcnt lgkmcnt(5)
    v_mfma_f32_32x32x16_bf16 v[64:79], v[176:179], v[196:199], v[64:79]
    v_add_u32 v41, 65536, v41
    ds_read_b128 v[200:203], v41 offset:0
    ds_read_b64_tr_b16 v[220:221], v42 offset:28672
    s_waitcnt lgkmcnt(6)
    v_mfma_f32_32x32x16_bf16 v[80:95], v[192:195], v[180:183], v[80:95]
    ds_read_b64_tr_b16 v[222:223], v42 offset:29696
    ds_read_b128 v[204:207], v41 offset:4096
    v_mfma_f32_32x32x16_bf16 v[96:111], v[180:183], v[196:199], v[96:111]
    ds_read_b128 v[208:211], v41 offset:8192
    ds_read_b128 v[212:215], v41 offset:12288
    s_waitcnt lgkmcnt(9)
    v_mfma_f32_32x32x16_bf16 v[112:127], v[192:195], v[184:187], v[112:127]
    v_mfma_f32_32x32x16_bf16 v[128:143], v[184:187], v[196:199], v[128:143]
    s_waitcnt lgkmcnt(8)
    v_mfma_f32_32x32x16_bf16 v[144:159], v[192:195], v[188:191], v[144:159]
    v_mfma_f32_32x32x16_bf16 v[160:175], v[188:191], v[196:199], v[160:175]
    s_waitcnt vmcnt(4) lgkmcnt(0)
    s_barrier
    v_mfma_f32_32x32x16_bf16 v[48:63], v[216:219], v[200:203], v[48:63]
    v_subrev_u32 v42, 98304, v42
    ds_read_b64_tr_b16 v[192:193], v42 offset:0
    v_mfma_f32_32x32x16_bf16 v[64:79], v[200:203], v[220:223], v[64:79]
    ds_read_b64_tr_b16 v[194:195], v42 offset:1024
    s_add_u32 s39, s40, 3145728
    s_add_u32 m0, s38, 98304
    s_nop 0
    buffer_load_dwordx4 v34, s[8:11], s39 offen offset:0 lds
    v_mfma_f32_32x32x16_bf16 v[80:95], v[216:219], v[204:207], v[80:95]
    v_subrev_u32 v38, 98304, v38
    ds_read_b128 v[176:179], v38 offset:0
    v_mfma_f32_32x32x16_bf16 v[96:111], v[204:207], v[220:223], v[96:111]
    ds_read_b64_tr_b16 v[196:197], v42 offset:16384
    buffer_load_dwordx4 v35, s[8:11], s39 offen offset:1024 lds
    v_mfma_f32_32x32x16_bf16 v[112:127], v[216:219], v[208:211], v[112:127]
    ds_read_b64_tr_b16 v[198:199], v42 offset:17408
    v_mfma_f32_32x32x16_bf16 v[128:143], v[208:211], v[220:223], v[128:143]
    ds_read_b128 v[180:183], v38 offset:4096
    buffer_load_dwordx4 v36, s[8:11], s39 offen offset:2048 lds
    v_mfma_f32_32x32x16_bf16 v[144:159], v[216:219], v[212:215], v[144:159]
    ds_read_b128 v[184:187], v38 offset:8192
    v_mfma_f32_32x32x16_bf16 v[160:175], v[212:215], v[220:223], v[160:175]
    ds_read_b128 v[188:191], v38 offset:12288
    buffer_load_dwordx4 v37, s[8:11], s39 offen offset:3072 lds
    s_waitcnt lgkmcnt(5)
    v_mfma_f32_32x32x16_bf16 v[48:63], v[192:195], v[176:179], v[48:63]
    ds_read_b64_tr_b16 v[216:217], v42 offset:4096
    s_waitcnt lgkmcnt(4)
    v_mfma_f32_32x32x16_bf16 v[64:79], v[176:179], v[196:199], v[64:79]
    ds_read_b64_tr_b16 v[218:219], v42 offset:5120
    v_and_b32 v8, 31, v1
    v_mul_u32_u24 v8, 1280, v8
    buffer_load_dword v24, v8, s[56:59], 0 offen sc1
    s_waitcnt lgkmcnt(4)
    v_mfma_f32_32x32x16_bf16 v[80:95], v[192:195], v[180:183], v[80:95]
    v_subrev_u32 v39, 98304, v39
    ds_read_b128 v[200:203], v39 offset:0
    v_mfma_f32_32x32x16_bf16 v[96:111], v[180:183], v[196:199], v[96:111]
    ds_read_b64_tr_b16 v[220:221], v42 offset:20480
    s_mov_b32 s39, 896
    s_add_u32 m0, s38, 131072
    s_nop 0
    buffer_load_dwordx4 v26, s[4:7], s39 offen offset:0 lds
    s_waitcnt lgkmcnt(5)
    v_mfma_f32_32x32x16_bf16 v[112:127], v[192:195], v[184:187], v[112:127]
    ds_read_b64_tr_b16 v[222:223], v42 offset:21504
    v_mfma_f32_32x32x16_bf16 v[128:143], v[184:187], v[196:199], v[128:143]
    ds_read_b128 v[204:207], v39 offset:4096
    buffer_load_dwordx4 v27, s[4:7], s39 offen offset:1024 lds
    s_waitcnt lgkmcnt(6)
    v_mfma_f32_32x32x16_bf16 v[144:159], v[192:195], v[188:191], v[144:159]
    ds_read_b128 v[208:211], v39 offset:8192
    v_mfma_f32_32x32x16_bf16 v[160:175], v[188:191], v[196:199], v[160:175]
    ds_read_b128 v[212:215], v39 offset:12288
    buffer_load_dwordx4 v28, s[4:7], s39 offen offset:2048 lds
    s_waitcnt lgkmcnt(5)
    v_mfma_f32_32x32x16_bf16 v[48:63], v[216:219], v[200:203], v[48:63]
    ds_read_b64_tr_b16 v[192:193], v42 offset:8192
    s_waitcnt lgkmcnt(4)
    v_mfma_f32_32x32x16_bf16 v[64:79], v[200:203], v[220:223], v[64:79]
    ds_read_b64_tr_b16 v[194:195], v42 offset:9216
    buffer_load_dwordx4 v29, s[4:7], s39 offen offset:3072 lds
    s_waitcnt lgkmcnt(4)
    v_mfma_f32_32x32x16_bf16 v[80:95], v[216:219], v[204:207], v[80:95]
    v_subrev_u32 v40, 98304, v40
    ds_read_b128 v[176:179], v40 offset:0
    v_mfma_f32_32x32x16_bf16 v[96:111], v[204:207], v[220:223], v[96:111]
    ds_read_b64_tr_b16 v[196:197], v42 offset:24576
    s_waitcnt lgkmcnt(5)
    v_mfma_f32_32x32x16_bf16 v[112:127], v[216:219], v[208:211], v[112:127]
    ds_read_b64_tr_b16 v[198:199], v42 offset:25600
    v_mfma_f32_32x32x16_bf16 v[128:143], v[208:211], v[220:223], v[128:143]
    ds_read_b128 v[180:183], v40 offset:4096
    s_waitcnt lgkmcnt(6)
    v_mfma_f32_32x32x16_bf16 v[144:159], v[216:219], v[212:215], v[144:159]
    ds_read_b128 v[184:187], v40 offset:8192
    v_mfma_f32_32x32x16_bf16 v[160:175], v[212:215], v[220:223], v[160:175]
    ds_read_b128 v[188:191], v40 offset:12288
    s_waitcnt lgkmcnt(5)
    v_mfma_f32_32x32x16_bf16 v[48:63], v[192:195], v[176:179], v[48:63]
    ds_read_b64_tr_b16 v[216:217], v42 offset:12288
    ds_read_b64_tr_b16 v[218:219], v42 offset:13312
    s_waitcnt lgkmcnt(5)
    v_mfma_f32_32x32x16_bf16 v[64:79], v[176:179], v[196:199], v[64:79]
    v_subrev_u32 v41, 98304, v41
    ds_read_b128 v[200:203], v41 offset:0
    ds_read_b64_tr_b16 v[220:221], v42 offset:28672
    s_waitcnt lgkmcnt(6)
    v_mfma_f32_32x32x16_bf16 v[80:95], v[192:195], v[180:183], v[80:95]
    ds_read_b64_tr_b16 v[222:223], v42 offset:29696
    ds_read_b128 v[204:207], v41 offset:4096
    v_mfma_f32_32x32x16_bf16 v[96:111], v[180:183], v[196:199], v[96:111]
    ds_read_b128 v[208:211], v41 offset:8192
    ds_read_b128 v[212:215], v41 offset:12288
    s_waitcnt lgkmcnt(9)
    v_mfma_f32_32x32x16_bf16 v[112:127], v[192:195], v[184:187], v[112:127]
    v_mfma_f32_32x32x16_bf16 v[128:143], v[184:187], v[196:199], v[128:143]
    s_waitcnt lgkmcnt(8)
    v_mfma_f32_32x32x16_bf16 v[144:159], v[192:195], v[188:191], v[144:159]
    v_mfma_f32_32x32x16_bf16 v[160:175], v[188:191], v[196:199], v[160:175]
    s_waitcnt vmcnt(5) lgkmcnt(0)
    s_barrier
    v_mfma_f32_32x32x16_bf16 v[48:63], v[216:219], v[200:203], v[48:63]
    v_add_u32 v42, 65536, v42
    ds_read_b64_tr_b16 v[192:193], v42 offset:0
    v_mfma_f32_32x32x16_bf16 v[64:79], v[200:203], v[220:223], v[64:79]
    ds_read_b64_tr_b16 v[194:195], v42 offset:1024
    s_add_u32 s39, s40, 3670016
    s_add_u32 m0, s38, 0
    s_nop 0
    buffer_load_dwordx4 v34, s[8:11], s39 offen offset:0 lds
    v_mfma_f32_32x32x16_bf16 v[80:95], v[216:219], v[204:207], v[80:95]
    v_add_u32 v38, 65536, v38
    ds_read_b128 v[176:179], v38 offset:0
    v_mfma_f32_32x32x16_bf16 v[96:111], v[204:207], v[220:223], v[96:111]
    ds_read_b64_tr_b16 v[196:197], v42 offset:16384
    buffer_load_dwordx4 v35, s[8:11], s39 offen offset:1024 lds
    v_mfma_f32_32x32x16_bf16 v[112:127], v[216:219], v[208:211], v[112:127]
    ds_read_b64_tr_b16 v[198:199], v42 offset:17408
    v_mfma_f32_32x32x16_bf16 v[128:143], v[208:211], v[220:223], v[128:143]
    ds_read_b128 v[180:183], v38 offset:4096
    buffer_load_dwordx4 v36, s[8:11], s39 offen offset:2048 lds
    v_mfma_f32_32x32x16_bf16 v[144:159], v[216:219], v[212:215], v[144:159]
    ds_read_b128 v[184:187], v38 offset:8192
    v_mfma_f32_32x32x16_bf16 v[160:175], v[212:215], v[220:223], v[160:175]
    ds_read_b128 v[188:191], v38 offset:12288
    buffer_load_dwordx4 v37, s[8:11], s39 offen offset:3072 lds
    s_waitcnt lgkmcnt(5)
    v_mfma_f32_32x32x16_bf16 v[48:63], v[192:195], v[176:179], v[48:63]
    ds_read_b64_tr_b16 v[216:217], v42 offset:4096
    s_waitcnt lgkmcnt(4)
    v_mfma_f32_32x32x16_bf16 v[64:79], v[176:179], v[196:199], v[64:79]
    ds_read_b64_tr_b16 v[218:219], v42 offset:5120
    v_mov_b32 v8, 0
    s_mov_b64 exec, 1
    buffer_store_byte v8, v8, s[96:99], s53 offen sc1
    buffer_store_byte v8, v8, s[96:99], s54 offen sc1
    buffer_store_byte v8, v8, s[96:99], s100 offen sc1
    s_mov_b64 exec, -1
    s_waitcnt lgkmcnt(4)
    v_mfma_f32_32x32x16_bf16 v[80:95], v[192:195], v[180:183], v[80:95]
    v_add_u32 v39, 65536, v39
    ds_read_b128 v[200:203], v39 offset:0
    v_mfma_f32_32x32x16_bf16 v[96:111], v[180:183], v[196:199], v[96:111]
    ds_read_b64_tr_b16 v[220:221], v42 offset:20480
    s_add_u32 s39, s41, 0
    s_add_u32 m0, s38, 32768
    s_nop 0
    buffer_load_dwordx4 v34, s[16:19], s39 offen offset:0 lds
    s_waitcnt lgkmcnt(5)
    v_mfma_f32_32x32x16_bf16 v[112:127], v[192:195], v[184:187], v[112:127]
    ds_read_b64_tr_b16 v[222:223], v42 offset:21504
    v_mfma_f32_32x32x16_bf16 v[128:143], v[184:187], v[196:199], v[128:143]
    ds_read_b128 v[204:207], v39 offset:4096
    buffer_load_dwordx4 v35, s[16:19], s39 offen offset:1024 lds
    s_waitcnt lgkmcnt(6)
    v_mfma_f32_32x32x16_bf16 v[144:159], v[192:195], v[188:191], v[144:159]
    ds_read_b128 v[208:211], v39 offset:8192
    v_mfma_f32_32x32x16_bf16 v[160:175], v[188:191], v[196:199], v[160:175]
    ds_read_b128 v[212:215], v39 offset:12288
    buffer_load_dwordx4 v36, s[16:19], s39 offen offset:2048 lds
    s_waitcnt lgkmcnt(5)
    v_mfma_f32_32x32x16_bf16 v[48:63], v[216:219], v[200:203], v[48:63]
    ds_read_b64_tr_b16 v[192:193], v42 offset:8192
    s_waitcnt lgkmcnt(4)
    v_mfma_f32_32x32x16_bf16 v[64:79], v[200:203], v[220:223], v[64:79]
    ds_read_b64_tr_b16 v[194:195], v42 offset:9216
    buffer_load_dwordx4 v37, s[16:19], s39 offen offset:3072 lds
    s_waitcnt lgkmcnt(4)
    v_mfma_f32_32x32x16_bf16 v[80:95], v[216:219], v[204:207], v[80:95]
    v_add_u32 v40, 65536, v40
    ds_read_b128 v[176:179], v40 offset:0
    v_mfma_f32_32x32x16_bf16 v[96:111], v[204:207], v[220:223], v[96:111]
    ds_read_b64_tr_b16 v[196:197], v42 offset:24576
    s_waitcnt lgkmcnt(5)
    v_mfma_f32_32x32x16_bf16 v[112:127], v[216:219], v[208:211], v[112:127]
    ds_read_b64_tr_b16 v[198:199], v42 offset:25600
    v_mfma_f32_32x32x16_bf16 v[128:143], v[208:211], v[220:223], v[128:143]
    ds_read_b128 v[180:183], v40 offset:4096
    s_waitcnt lgkmcnt(6)
    v_mfma_f32_32x32x16_bf16 v[144:159], v[216:219], v[212:215], v[144:159]
    ds_read_b128 v[184:187], v40 offset:8192
    v_mfma_f32_32x32x16_bf16 v[160:175], v[212:215], v[220:223], v[160:175]
    ds_read_b128 v[188:191], v40 offset:12288
    s_waitcnt lgkmcnt(5)
    v_mfma_f32_32x32x16_bf16 v[48:63], v[192:195], v[176:179], v[48:63]
    ds_read_b64_tr_b16 v[216:217], v42 offset:12288
    ds_read_b64_tr_b16 v[218:219], v42 offset:13312
    s_waitcnt lgkmcnt(5)
    v_mfma_f32_32x32x16_bf16 v[64:79], v[176:179], v[196:199], v[64:79]
    v_add_u32 v41, 65536, v41
    ds_read_b128 v[200:203], v41 offset:0
    ds_read_b64_tr_b16 v[220:221], v42 offset:28672
    s_waitcnt lgkmcnt(6)
    v_mfma_f32_32x32x16_bf16 v[80:95], v[192:195], v[180:183], v[80:95]
    ds_read_b64_tr_b16 v[222:223], v42 offset:29696
    ds_read_b128 v[204:207], v41 offset:4096
    v_mfma_f32_32x32x16_bf16 v[96:111], v[180:183], v[196:199], v[96:111]
    ds_read_b128 v[208:211], v41 offset:8192
    ds_read_b128 v[212:215], v41 offset:12288
    s_waitcnt lgkmcnt(9)
    v_mfma_f32_32x32x16_bf16 v[112:127], v[192:195], v[184:187], v[112:127]
    v_mfma_f32_32x32x16_bf16 v[128:143], v[184:187], v[196:199], v[128:143]
    s_waitcnt lgkmcnt(8)
    v_mfma_f32_32x32x16_bf16 v[144:159], v[192:195], v[188:191], v[144:159]
    v_mfma_f32_32x32x16_bf16 v[160:175], v[188:191], v[196:199], v[160:175]
    s_waitcnt vmcnt(7) lgkmcnt(0)
    s_barrier
    v_mfma_f32_32x32x16_bf16 v[48:63], v[216:219], v[200:203], v[48:63]
    v_subrev_u32 v42, 98304, v42
    ds_read_b64_tr_b16 v[192:193], v42 offset:0
    v_mfma_f32_32x32x16_bf16 v[64:79], v[200:203], v[220:223], v[64:79]
    ds_read_b64_tr_b16 v[194:195], v42 offset:1024
    s_mov_b32 s39, 0
    s_add_u32 m0, s38, 65536
    s_nop 0
    buffer_load_dwordx4 v30, s[12:15], s39 offen offset:0 lds
    v_mfma_f32_32x32x16_bf16 v[80:95], v[216:219], v[204:207], v[80:95]
    v_add_u32 v38, 65536, v38
    ds_read_b128 v[176:179], v38 offset:0
    v_mfma_f32_32x32x16_bf16 v[96:111], v[204:207], v[220:223], v[96:111]
    ds_read_b64_tr_b16 v[196:197], v42 offset:16384
    buffer_load_dwordx4 v31, s[12:15], s39 offen offset:1024 lds
    v_mfma_f32_32x32x16_bf16 v[112:127], v[216:219], v[208:211], v[112:127]
    ds_read_b64_tr_b16 v[198:199], v42 offset:17408
    v_mfma_f32_32x32x16_bf16 v[128:143], v[208:211], v[220:223], v[128:143]
    ds_read_b128 v[180:183], v38 offset:4096
    buffer_load_dwordx4 v32, s[12:15], s39 offen offset:2048 lds
    v_mfma_f32_32x32x16_bf16 v[144:159], v[216:219], v[212:215], v[144:159]
    ds_read_b128 v[184:187], v38 offset:8192
    v_mfma_f32_32x32x16_bf16 v[160:175], v[212:215], v[220:223], v[160:175]
    ds_read_b128 v[188:191], v38 offset:12288
    buffer_load_dwordx4 v33, s[12:15], s39 offen offset:3072 lds
    s_waitcnt lgkmcnt(5)
    v_mfma_f32_32x32x16_bf16 v[48:63], v[192:195], v[176:179], v[48:63]
    ds_read_b64_tr_b16 v[216:217], v42 offset:4096
    s_mov_b32 s39, 128
    s_add_u32 m0, s38, 98304
    s_nop 0
    buffer_load_dwordx4 v30, s[12:15], s39 offen offset:0 lds
    s_waitcnt lgkmcnt(4)
    v_mfma_f32_32x32x16_bf16 v[64:79], v[176:179], v[196:199], v[64:79]
    ds_read_b64_tr_b16 v[218:219], v42 offset:5120
    buffer_load_dwordx4 v31, s[12:15], s39 offen offset:1024 lds
    s_waitcnt lgkmcnt(4)
    v_mfma_f32_32x32x16_bf16 v[80:95], v[192:195], v[180:183], v[80:95]
    v_add_u32 v39, 65536, v39
    ds_read_b128 v[200:203], v39 offset:0
    buffer_load_dwordx4 v32, s[12:15], s39 offen offset:2048 lds
    v_mfma_f32_32x32x16_bf16 v[96:111], v[180:183], v[196:199], v[96:111]
    ds_read_b64_tr_b16 v[220:221], v42 offset:20480
    buffer_load_dwordx4 v33, s[12:15], s39 offen offset:3072 lds
    s_waitcnt lgkmcnt(5)
    v_mfma_f32_32x32x16_bf16 v[112:127], v[192:195], v[184:187], v[112:127]
    ds_read_b64_tr_b16 v[222:223], v42 offset:21504
    v_mfma_f32_32x32x16_bf16 v[128:143], v[184:187], v[196:199], v[128:143]
    ds_read_b128 v[204:207], v39 offset:4096
    s_waitcnt lgkmcnt(6)
    v_mfma_f32_32x32x16_bf16 v[144:159], v[192:195], v[188:191], v[144:159]
    ds_read_b128 v[208:211], v39 offset:8192
    v_mfma_f32_32x32x16_bf16 v[160:175], v[188:191], v[196:199], v[160:175]
    ds_read_b128 v[212:215], v39 offset:12288
    s_waitcnt lgkmcnt(5)
    v_mfma_f32_32x32x16_bf16 v[48:63], v[216:219], v[200:203], v[48:63]
    ds_read_b64_tr_b16 v[192:193], v42 offset:8192
    s_waitcnt lgkmcnt(4)
    v_mfma_f32_32x32x16_bf16 v[64:79], v[200:203], v[220:223], v[64:79]
    ds_read_b64_tr_b16 v[194:195], v42 offset:9216
    s_waitcnt lgkmcnt(4)
    v_mfma_f32_32x32x16_bf16 v[80:95], v[216:219], v[204:207], v[80:95]
    v_add_u32 v40, 65536, v40
    ds_read_b128 v[176:179], v40 offset:0
    v_mfma_f32_32x32x16_bf16 v[96:111], v[204:207], v[220:223], v[96:111]
    ds_read_b64_tr_b16 v[196:197], v42 offset:24576
    s_waitcnt lgkmcnt(5)
    v_mfma_f32_32x32x16_bf16 v[112:127], v[216:219], v[208:211], v[112:127]
    ds_read_b64_tr_b16 v[198:199], v42 offset:25600
    v_mfma_f32_32x32x16_bf16 v[128:143], v[208:211], v[220:223], v[128:143]
    ds_read_b128 v[180:183], v40 offset:4096
    s_waitcnt lgkmcnt(6)
    v_mfma_f32_32x32x16_bf16 v[144:159], v[216:219], v[212:215], v[144:159]
    ds_read_b128 v[184:187], v40 offset:8192
    v_mfma_f32_32x32x16_bf16 v[160:175], v[212:215], v[220:223], v[160:175]
    ds_read_b128 v[188:191], v40 offset:12288
    s_waitcnt lgkmcnt(5)
    v_mfma_f32_32x32x16_bf16 v[48:63], v[192:195], v[176:179], v[48:63]
    ds_read_b64_tr_b16 v[216:217], v42 offset:12288
    ds_read_b64_tr_b16 v[218:219], v42 offset:13312
    s_waitcnt lgkmcnt(5)
    v_mfma_f32_32x32x16_bf16 v[64:79], v[176:179], v[196:199], v[64:79]
    v_add_u32 v41, 65536, v41
    ds_read_b128 v[200:203], v41 offset:0
    ds_read_b64_tr_b16 v[220:221], v42 offset:28672
    s_waitcnt lgkmcnt(6)
    v_mfma_f32_32x32x16_bf16 v[80:95], v[192:195], v[180:183], v[80:95]
    ds_read_b64_tr_b16 v[222:223], v42 offset:29696
    ds_read_b128 v[204:207], v41 offset:4096
    v_mfma_f32_32x32x16_bf16 v[96:111], v[180:183], v[196:199], v[96:111]
    ds_read_b128 v[208:211], v41 offset:8192
    ds_read_b128 v[212:215], v41 offset:12288
    s_waitcnt lgkmcnt(9)
    v_mfma_f32_32x32x16_bf16 v[112:127], v[192:195], v[184:187], v[112:127]
    v_mfma_f32_32x32x16_bf16 v[128:143], v[184:187], v[196:199], v[128:143]
    s_waitcnt lgkmcnt(8)
    v_mfma_f32_32x32x16_bf16 v[144:159], v[192:195], v[188:191], v[144:159]
    v_mfma_f32_32x32x16_bf16 v[160:175], v[188:191], v[196:199], v[160:175]
    s_waitcnt vmcnt(4) lgkmcnt(0)
    s_barrier
    v_add_u32 v38, s42, v38
    v_add_u32 v39, s42, v39
    v_add_u32 v40, s42, v40
    v_add_u32 v41, s42, v41
    v_mfma_f32_32x32x16_bf16 v[48:63], v[216:219], v[200:203], v[48:63]
    v_subrev_u32 v38, 65536, v38
    ds_read_b128 v[176:179], v38 offset:0
    s_mov_b32 s39, 256
    s_add_u32 m0, s38, 131072
    s_nop 0
    buffer_load_dwordx4 v30, s[12:15], s39 offen offset:0 lds
    v_mfma_f32_32x32x16_bf16 v[64:79], v[200:203], v[220:223], v[64:79]
    ds_read_b64_tr_b16 v[180:181], v43 offset:32768
    buffer_load_dwordx4 v31, s[12:15], s39 offen offset:1024 lds
    v_mfma_f32_32x32x16_bf16 v[80:95], v[216:219], v[204:207], v[80:95]
    ds_read_b64_tr_b16 v[182:183], v43 offset:33792
    buffer_load_dwordx4 v32, s[12:15], s39 offen offset:2048 lds
    v_mfma_f32_32x32x16_bf16 v[96:111], v[204:207], v[220:223], v[96:111]
    ds_read_b64_tr_b16 v[184:185], v44 offset:32768
    buffer_load_dwordx4 v33, s[12:15], s39 offen offset:3072 lds
    v_mfma_f32_32x32x16_bf16 v[112:127], v[216:219], v[208:211], v[112:127]
    ds_read_b64_tr_b16 v[186:187], v44 offset:33792
    s_add_u32 s39, s41, 1048576
    s_add_u32 m0, s38, 0
    s_nop 0
    buffer_load_dwordx4 v34, s[16:19], s39 offen offset:0 lds
    v_mfma_f32_32x32x16_bf16 v[128:143], v[208:211], v[220:223], v[128:143]
    ds_read_b64_tr_b16 v[188:189], v45 offset:32768
    buffer_load_dwordx4 v35, s[16:19], s39 offen offset:1024 lds
    v_mfma_f32_32x32x16_bf16 v[144:159], v[216:219], v[212:215], v[144:159]
    ds_read_b64_tr_b16 v[190:191], v45 offset:33792
    buffer_load_dwordx4 v36, s[16:19], s39 offen offset:2048 lds
    v_mfma_f32_32x32x16_bf16 v[160:175], v[212:215], v[220:223], v[160:175]
    ds_read_b64_tr_b16 v[192:193], v46 offset:32768
    ds_read_b64_tr_b16 v[194:195], v46 offset:33792
    buffer_load_dwordx4 v37, s[16:19], s39 offen offset:3072 lds
    v_subrev_u32 v39, 65536, v39
    ds_read_b128 v[196:199], v39 offset:0
    ds_read_b64_tr_b16 v[200:201], v43 offset:36864
    ds_read_b64_tr_b16 v[202:203], v43 offset:37888
    ds_read_b64_tr_b16 v[204:205], v44 offset:36864
    ds_read_b64_tr_b16 v[206:207], v44 offset:37888
    ds_read_b64_tr_b16 v[208:209], v45 offset:36864
    ds_read_b64_tr_b16 v[210:211], v45 offset:37888
    ds_read_b64_tr_b16 v[212:213], v46 offset:36864
    ds_read_b64_tr_b16 v[214:215], v46 offset:37888
    s_nop 3
    v_cvt_pk_bf16_f32 v48, v48, v49
    v_cvt_pk_bf16_f32 v49, v50, v51
    v_cvt_pk_bf16_f32 v50, v52, v53
    v_cvt_pk_bf16_f32 v51, v54, v55
    v_cvt_pk_bf16_f32 v52, v56, v57
    v_cvt_pk_bf16_f32 v53, v58, v59
    v_cvt_pk_bf16_f32 v54, v60, v61
    v_cvt_pk_bf16_f32 v55, v62, v63
    v_cvt_pk_bf16_f32 v56, v64, v65
    v_cvt_pk_bf16_f32 v57, v66, v67
    v_cvt_pk_bf16_f32 v58, v68, v69
    v_cvt_pk_bf16_f32 v59, v70, v71
    v_cvt_pk_bf16_f32 v60, v72, v73
    v_cvt_pk_bf16_f32 v61, v74, v75
    v_cvt_pk_bf16_f32 v62, v76, v77
    v_cvt_pk_bf16_f32 v63, v78, v79
    v_cvt_pk_bf16_f32 v64, v80, v81
    v_cvt_pk_bf16_f32 v65, v82, v83
    v_cvt_pk_bf16_f32 v66, v84, v85
    v_cvt_pk_bf16_f32 v67, v86, v87
    v_cvt_pk_bf16_f32 v68, v88, v89
    v_cvt_pk_bf16_f32 v69, v90, v91
    v_cvt_pk_bf16_f32 v70, v92, v93
    v_cvt_pk_bf16_f32 v71, v94, v95
    v_cvt_pk_bf16_f32 v72, v96, v97
    v_cvt_pk_bf16_f32 v73, v98, v99
    v_cvt_pk_bf16_f32 v74, v100, v101
    v_cvt_pk_bf16_f32 v75, v102, v103
    v_cvt_pk_bf16_f32 v76, v104, v105
    v_cvt_pk_bf16_f32 v77, v106, v107
    v_cvt_pk_bf16_f32 v78, v108, v109
    v_cvt_pk_bf16_f32 v79, v110, v111
    v_cvt_pk_bf16_f32 v80, v112, v113
    v_cvt_pk_bf16_f32 v81, v114, v115
    v_cvt_pk_bf16_f32 v82, v116, v117
    v_cvt_pk_bf16_f32 v83, v118, v119
    v_cvt_pk_bf16_f32 v84, v120, v121
    v_cvt_pk_bf16_f32 v85, v122, v123
    v_cvt_pk_bf16_f32 v86, v124, v125
    v_cvt_pk_bf16_f32 v87, v126, v127
    v_cvt_pk_bf16_f32 v88, v128, v129
    v_cvt_pk_bf16_f32 v89, v130, v131
    v_cvt_pk_bf16_f32 v90, v132, v133
    v_cvt_pk_bf16_f32 v91, v134, v135
    v_cvt_pk_bf16_f32 v92, v136, v137
    v_cvt_pk_bf16_f32 v93, v138, v139
    v_cvt_pk_bf16_f32 v94, v140, v141
    v_cvt_pk_bf16_f32 v95, v142, v143
    v_cvt_pk_bf16_f32 v96, v144, v145
    v_cvt_pk_bf16_f32 v97, v146, v147
    v_cvt_pk_bf16_f32 v98, v148, v149
    v_cvt_pk_bf16_f32 v99, v150, v151
    v_cvt_pk_bf16_f32 v100, v152, v153
    v_cvt_pk_bf16_f32 v101, v154, v155
    v_cvt_pk_bf16_f32 v102, v156, v157
    v_cvt_pk_bf16_f32 v103, v158, v159
    v_cvt_pk_bf16_f32 v104, v160, v161
    v_cvt_pk_bf16_f32 v105, v162, v163
    v_cvt_pk_bf16_f32 v106, v164, v165
    v_cvt_pk_bf16_f32 v107, v166, v167
    v_cvt_pk_bf16_f32 v108, v168, v169
    v_cvt_pk_bf16_f32 v109, v170, v171
    v_cvt_pk_bf16_f32 v110, v172, v173
    v_cvt_pk_bf16_f32 v111, v174, v175
    s_mov_b32 s62, 0x3e0293ee
    s_cmp_lt_u32 s34, 2
    s_cbranch_scc1 L_mn_b_e
    s_waitcnt lgkmcnt(15)
    v_mfma_f32_32x32x16_bf16 v[112:127], v[180:183], v[176:179], 0
    v_subrev_u32 v40, 65536, v40
    ds_read_b128 v[216:219], v40 offset:0
    ds_read_b64_tr_b16 v[220:221], v43 offset:40960
    ds_read_b64_tr_b16 v[222:223], v43 offset:41984
    s_waitcnt lgkmcnt(15)
    v_mfma_f32_32x32x16_bf16 v[128:143], v[184:187], v[176:179], 0
    ds_read_b64_tr_b16 v[224:225], v44 offset:40960
    ds_read_b64_tr_b16 v[226:227], v44 offset:41984
    s_waitcnt lgkmcnt(15)
    v_mfma_f32_32x32x16_bf16 v[144:159], v[188:191], v[176:179], 0
    ds_read_b64_tr_b16 v[228:229], v45 offset:40960
    ds_read_b64_tr_b16 v[230:231], v45 offset:41984
    s_waitcnt lgkmcnt(15)
    v_mfma_f32_32x32x16_bf16 v[160:175], v[192:195], v[176:179], 0
    ds_read_b64_tr_b16 v[232:233], v46 offset:40960
    ds_read_b64_tr_b16 v[234:235], v46 offset:41984
    s_waitcnt lgkmcnt(15)
    v_mfma_f32_32x32x16_bf16 v[112:127], v[200:203], v[196:199], v[112:127]
    v_subrev_u32 v41, 65536, v41
    ds_read_b128 v[176:179], v41 offset:0
    ds_read_b64_tr_b16 v[180:181], v43 offset:45056
    ds_read_b64_tr_b16 v[182:183], v43 offset:46080
    s_waitcnt lgkmcnt(15)
    v_mfma_f32_32x32x16_bf16 v[128:143], v[204:207], v[196:199], v[128:143]
    ds_read_b64_tr_b16 v[184:185], v44 offset:45056
    ds_read_b64_tr_b16 v[186:187], v44 offset:46080
    s_waitcnt lgkmcnt(15)
    v_mfma_f32_32x32x16_bf16 v[144:159], v[208:211], v[196:199], v[144:159]
    ds_read_b64_tr_b16 v[188:189], v45 offset:45056
    ds_read_b64_tr_b16 v[190:191], v45 offset:46080
    s_waitcnt lgkmcnt(15)
    v_mfma_f32_32x32x16_bf16 v[160:175], v[212:215], v[196:199], v[160:175]
    ds_read_b64_tr_b16 v[192:193], v46 offset:45056
    ds_read_b64_tr_b16 v[194:195], v46 offset:46080
    s_waitcnt vmcnt(8)
    s_waitcnt lgkmcnt(15)
    v_mfma_f32_32x32x16_bf16 v[112:127], v[220:223], v[216:219], v[112:127]
    ds_read_b128 v[196:199], v38 offset:32768
    ds_read_b64_tr_b16 v[200:201], v43 offset:49152
    ds_read_b64_tr_b16 v[202:203], v43 offset:50176
    s_waitcnt lgkmcnt(15)
    v_mfma_f32_32x32x16_bf16 v[128:143], v[224:227], v[216:219], v[128:143]
    ds_read_b64_tr_b16 v[204:205], v44 offset:49152
    ds_read_b64_tr_b16 v[206:207], v44 offset:50176
    s_waitcnt lgkmcnt(15)
    v_mfma_f32_32x32x16_bf16 v[144:159], v[228:231], v[216:219], v[144:159]
    ds_read_b64_tr_b16 v[208:209], v45 offset:49152
    ds_read_b64_tr_b16 v[210:211], v45 offset:50176
    s_waitcnt lgkmcnt(15)
    v_mfma_f32_32x32x16_bf16 v[160:175], v[232:235], v[216:219], v[160:175]
    ds_read_b64_tr_b16 v[212:213], v46 offset:49152
    ds_read_b64_tr_b16 v[214:215], v46 offset:50176
    s_waitcnt lgkmcnt(15)
    v_mfma_f32_32x32x16_bf16 v[112:127], v[180:183], v[176:179], v[112:127]
    ds_read_b128 v[216:219], v39 offset:32768
    ds_read_b64_tr_b16 v[220:221], v43 offset:53248
    ds_read_b64_tr_b16 v[222:223], v43 offset:54272
    s_waitcnt lgkmcnt(15)
    v_mfma_f32_32x32x16_bf16 v[128:143], v[184:187], v[176:179], v[128:143]
    ds_read_b64_tr_b16 v[224:225], v44 offset:53248
    ds_read_b64_tr_b16 v[226:227], v44 offset:54272
    s_mov_b32 s39, 384
    s_add_u32 m0, s38, 65536
    s_nop 0
    buffer_load_dwordx4 v30, s[12:15], s39 offen offset:0 lds
    s_waitcnt lgkmcnt(15)
    v_mfma_f32_32x32x16_bf16 v[144:159], v[188:191], v[176:179], v[144:159]
    ds_read_b64_tr_b16 v[228:229], v45 offset:53248
    ds_read_b64_tr_b16 v[230:231], v45 offset:54272
    s_waitcnt lgkmcnt(15)
    v_mfma_f32_32x32x16_bf16 v[160:175], v[192:195], v[176:179], v[160:175]
    ds_read_b64_tr_b16 v[232:233], v46 offset:53248
    ds_read_b64_tr_b16 v[234:235], v46 offset:54272
    buffer_load_dwordx4 v31, s[12:15], s39 offen offset:1024 lds
    s_waitcnt lgkmcnt(15)
    v_mfma_f32_32x32x16_bf16 v[112:127], v[200:203], v[196:199], v[112:127]
    ds_read_b128 v[176:179], v40 offset:32768
    ds_read_b64_tr_b16 v[180:181], v43 offset:57344
    ds_read_b64_tr_b16 v[182:183], v43 offset:58368
    s_waitcnt lgkmcnt(15)
    v_mfma_f32_32x32x16_bf16 v[128:143], v[204:207], v[196:199], v[128:143]
    ds_read_b64_tr_b16 v[184:185], v44 offset:57344
    ds_read_b64_tr_b16 v[186:187], v44 offset:58368
    buffer_load_dwordx4 v32, s[12:15], s39 offen offset:2048 lds
    s_waitcnt lgkmcnt(15)
    v_mfma_f32_32x32x16_bf16 v[144:159], v[208:211], v[196:199], v[144:159]
    ds_read_b64_tr_b16 v[188:189], v45 offset:57344
    ds_read_b64_tr_b16 v[190:191], v45 offset:58368
    s_waitcnt lgkmcnt(15)
    v_mfma_f32_32x32x16_bf16 v[160:175], v[212:215], v[196:199], v[160:175]
    ds_read_b64_tr_b16 v[192:193], v46 offset:57344
    ds_read_b64_tr_b16 v[194:195], v46 offset:58368
    buffer_load_dwordx4 v33, s[12:15], s39 offen offset:3072 lds
    s_waitcnt lgkmcnt(15)
    v_mfma_f32_32x32x16_bf16 v[112:127], v[220:223], v[216:219], v[112:127]
    ds_read_b128 v[196:199], v41 offset:32768
    ds_read_b64_tr_b16 v[200:201], v43 offset:61440
    ds_read_b64_tr_b16 v[202:203], v43 offset:62464
    ds_read_b64_tr_b16 v[204:205], v44 offset:61440
    ds_read_b64_tr_b16 v[206:207], v44 offset:62464
    s_waitcnt lgkmcnt(15)
    v_mfma_f32_32x32x16_bf16 v[128:143], v[224:227], v[216:219], v[128:143]
    ds_read_b64_tr_b16 v[208:209], v45 offset:61440
    ds_read_b64_tr_b16 v[210:211], v45 offset:62464
    ds_read_b64_tr_b16 v[212:213], v46 offset:61440
    ds_read_b64_tr_b16 v[214:215], v46 offset:62464
    v_mfma_f32_32x32x16_bf16 v[144:159], v[228:231], v[216:219], v[144:159]
    s_add_u32 s36, s51, 0
    buffer_store_dwordx4 v[48:51], v4, s[20:23], s36 offen sc1
    s_waitcnt lgkmcnt(15)
    v_mfma_f32_32x32x16_bf16 v[160:175], v[232:235], v[216:219], v[160:175]
    s_waitcnt vmcnt(5) lgkmcnt(0)
    s_barrier
    v_mfma_f32_32x32x16_bf16 v[112:127], v[180:183], v[176:179], v[112:127]
    v_add_u32 v38, 65536, v38
    ds_read_b128 v[216:219], v38 offset:0
    ds_read_b64_tr_b16 v[220:221], v43 offset:0
    ds_read_b64_tr_b16 v[222:223], v43 offset:1024
    v_mov_b32 v48, 0
    v_mov_b32 v49, 0
    v_mfma_f32_32x32x16_bf16 v[128:143], v[184:187], v[176:179], v[128:143]
    ds_read_b64_tr_b16 v[224:225], v44 offset:0
    ds_read_b64_tr_b16 v[226:227], v44 offset:1024
    s_add_u32 s39, s41, 2097152
    s_add_u32 m0, s38, 32768
    s_nop 0
    buffer_load_dwordx4 v34, s[16:19], s39 offen offset:0 lds
    v_mov_b32 v50, 0
    v_mov_b32 v51, 0
    v_mfma_f32_32x32x16_bf16 v[144:159], v[188:191], v[176:179], v[144:159]
    ds_read_b64_tr_b16 v[228:229], v45 offset:0
    ds_read_b64_tr_b16 v[230:231], v45 offset:1024
    s_add_u32 s36, s51, 1024
    buffer_store_dwordx4 v[52:55], v4, s[20:23], s36 offen sc1
    v_mfma_f32_32x32x16_bf16 v[160:175], v[192:195], v[176:179], v[160:175]
    ds_read_b64_tr_b16 v[232:233], v46 offset:0
    ds_read_b64_tr_b16 v[234:235], v46 offset:1024
    buffer_load_dwordx4 v35, s[16:19], s39 offen offset:1024 lds
    v_mfma_f32_32x32x16_bf16 v[112:127], v[200:203], v[196:199], v[112:127]
    v_add_u32 v39, 65536, v39
    ds_read_b128 v[176:179], v39 offset:0
    ds_read_b64_tr_b16 v[180:181], v43 offset:4096
    ds_read_b64_tr_b16 v[182:183], v43 offset:5120
    v_mov_b32 v52, 0
    v_mov_b32 v53, 0
    v_mfma_f32_32x32x16_bf16 v[128:143], v[204:207], v[196:199], v[128:143]
    ds_read_b64_tr_b16 v[184:185], v44 offset:4096
    ds_read_b64_tr_b16 v[186:187], v44 offset:5120
    buffer_load_dwordx4 v36, s[16:19], s39 offen offset:2048 lds
    v_mov_b32 v54, 0
    v_mov_b32 v55, 0
    v_mfma_f32_32x32x16_bf16 v[144:159], v[208:211], v[196:199], v[144:159]
    ds_read_b64_tr_b16 v[188:189], v45 offset:4096
    ds_read_b64_tr_b16 v[190:191], v45 offset:5120
    v_mfma_f32_32x32x16_bf16 v[160:175], v[212:215], v[196:199], v[160:175]
    ds_read_b64_tr_b16 v[192:193], v46 offset:4096
    ds_read_b64_tr_b16 v[194:195], v46 offset:5120
    buffer_load_dwordx4 v37, s[16:19], s39 offen offset:3072 lds
    s_waitcnt lgkmcnt(15)
    v_mfma_f32_32x32x16_bf16 v[112:127], v[220:223], v[216:219], v[112:127]
    v_add_u32 v40, 65536, v40
    ds_read_b128 v[196:199], v40 offset:0
    ds_read_b64_tr_b16 v[200:201], v43 offset:8192
    ds_read_b64_tr_b16 v[202:203], v43 offset:9216
    s_waitcnt lgkmcnt(15)
    v_mfma_f32_32x32x16_bf16 v[128:143], v[224:227], v[216:219], v[128:143]
    ds_read_b64_tr_b16 v[204:205], v44 offset:8192
    ds_read_b64_tr_b16 v[206:207], v44 offset:9216
    s_mov_b32 s39, 512
    s_add_u32 m0, s38, 98304
    s_nop 0
    buffer_load_dwordx4 v30, s[12:15], s39 offen offset:0 lds
    s_waitcnt lgkmcnt(15)
    v_mfma_f32_32x32x16_bf16 v[144:159], v[228:231], v[216:219], v[144:159]
    ds_read_b64_tr_b16 v[208:209], v45 offset:8192
    ds_read_b64_tr_b16 v[210:211], v45 offset:9216
    s_add_u32 s36, s52, 8192
    buffer_store_dwordx4 v[56:59], v4, s[20:23], s36 offen sc1
    s_waitcnt lgkmcnt(15)
    v_mfma_f32_32x32x16_bf16 v[160:175], v[232:235], v[216:219], v[160:175]
    ds_read_b64_tr_b16 v[212:213], v46 offset:8192
    ds_read_b64_tr_b16 v[214:215], v46 offset:9216
    buffer_load_dwordx4 v31, s[12:15], s39 offen offset:1024 lds
    s_waitcnt lgkmcnt(15)
    v_mfma_f32_32x32x16_bf16 v[112:127], v[180:183], v[176:179], v[112:127]
    v_add_u32 v41, 65536, v41
    ds_read_b128 v[216:219], v41 offset:0
    ds_read_b64_tr_b16 v[220:221], v43 offset:12288
    ds_read_b64_tr_b16 v[222:223], v43 offset:13312
    v_mov_b32 v56, 0
    v_mov_b32 v57, 0
    s_waitcnt lgkmcnt(15)
    v_mfma_f32_32x32x16_bf16 v[128:143], v[184:187], v[176:179], v[128:143]
    ds_read_b64_tr_b16 v[224:225], v44 offset:12288
    ds_read_b64_tr_b16 v[226:227], v44 offset:13312
    buffer_load_dwordx4 v32, s[12:15], s39 offen offset:2048 lds
    v_mov_b32 v58, 0
    v_mov_b32 v59, 0
    s_waitcnt lgkmcnt(15)
    v_mfma_f32_32x32x16_bf16 v[144:159], v[188:191], v[176:179], v[144:159]
    ds_read_b64_tr_b16 v[228:229], v45 offset:12288
    ds_read_b64_tr_b16 v[230:231], v45 offset:13312
    s_waitcnt lgkmcnt(15)
    v_mfma_f32_32x32x16_bf16 v[160:175], v[192:195], v[176:179], v[160:175]
    ds_read_b64_tr_b16 v[232:233], v46 offset:12288
    ds_read_b64_tr_b16 v[234:235], v46 offset:13312
    buffer_load_dwordx4 v33, s[12:15], s39 offen offset:3072 lds
    s_waitcnt vmcnt(11)
    s_waitcnt lgkmcnt(15)
    v_mfma_f32_32x32x16_bf16 v[112:127], v[200:203], v[196:199], v[112:127]
    v_subrev_u32 v38, 65536, v38
    ds_read_b128 v[176:179], v38 offset:0
    ds_read_b64_tr_b16 v[180:181], v43 offset:16384
    ds_read_b64_tr_b16 v[182:183], v43 offset:17408
    s_waitcnt lgkmcnt(15)
    v_mfma_f32_32x32x16_bf16 v[128:143], v[204:207], v[196:199], v[128:143]
    ds_read_b64_tr_b16 v[184:185], v44 offset:16384
    ds_read_b64_tr_b16 v[186:187], v44 offset:17408
    s_waitcnt lgkmcnt(15)
    v_mfma_f32_32x32x16_bf16 v[144:159], v[208:211], v[196:199], v[144:159]
    ds_read_b64_tr_b16 v[188:189], v45 offset:16384
    ds_read_b64_tr_b16 v[190:191], v45 offset:17408
    s_add_u32 s36, s52, 12288
    buffer_store_dwordx4 v[60:63], v4, s[20:23], s36 offen sc1
    s_waitcnt lgkmcnt(15)
    v_mfma_f32_32x32x16_bf16 v[160:175], v[212:215], v[196:199], v[160:175]
    ds_read_b64_tr_b16 v[192:193], v46 offset:16384
    ds_read_b64_tr_b16 v[194:195], v46 offset:17408
    s_waitcnt lgkmcnt(15)
    v_mfma_f32_32x32x16_bf16 v[112:127], v[220:223], v[216:219], v[112:127]
    v_subrev_u32 v39, 65536, v39
    ds_read_b128 v[196:199], v39 offset:0
    ds_read_b64_tr_b16 v[200:201], v43 offset:20480
    ds_read_b64_tr_b16 v[202:203], v43 offset:21504
    v_mov_b32 v60, 0
    v_mov_b32 v61, 0
    s_waitcnt lgkmcnt(15)
    v_mfma_f32_32x32x16_bf16 v[128:143], v[224:227], v[216:219], v[128:143]
    ds_read_b64_tr_b16 v[204:205], v44 offset:20480
    ds_read_b64_tr_b16 v[206:207], v44 offset:21504
    s_mov_b32 s39, 640
    s_add_u32 m0, s38, 131072
    s_nop 0
    buffer_load_dwordx4 v30, s[12:15], s39 offen offset:0 lds
    v_mov_b32 v62, 0
    v_mov_b32 v63, 0
    s_waitcnt lgkmcnt(15)
    v_mfma_f32_32x32x16_bf16 v[144:159], v[228:231], v[216:219], v[144:159]
    ds_read_b64_tr_b16 v[208:209], v45 offset:20480
    ds_read_b64_tr_b16 v[210:211], v45 offset:21504
    s_waitcnt lgkmcnt(15)
    v_mfma_f32_32x32x16_bf16 v[160:175], v[232:235], v[216:219], v[160:175]
    ds_read_b64_tr_b16 v[212:213], v46 offset:20480
    ds_read_b64_tr_b16 v[214:215], v46 offset:21504
    buffer_load_dwordx4 v31, s[12:15], s39 offen offset:1024 lds
    s_waitcnt lgkmcnt(15)
    v_mfma_f32_32x32x16_bf16 v[112:127], v[180:183], v[176:179], v[112:127]
    v_subrev_u32 v40, 65536, v40
    ds_read_b128 v[216:219], v40 offset:0
    ds_read_b64_tr_b16 v[220:221], v43 offset:24576
    ds_read_b64_tr_b16 v[222:223], v43 offset:25600
    s_waitcnt lgkmcnt(15)
    v_mfma_f32_32x32x16_bf16 v[128:143], v[184:187], v[176:179], v[128:143]
    ds_read_b64_tr_b16 v[224:225], v44 offset:24576
    ds_read_b64_tr_b16 v[226:227], v44 offset:25600
    buffer_load_dwordx4 v32, s[12:15], s39 offen offset:2048 lds
    s_waitcnt lgkmcnt(15)
    v_mfma_f32_32x32x16_bf16 v[144:159], v[188:191], v[176:179], v[144:159]
    ds_read_b64_tr_b16 v[228:229], v45 offset:24576
    ds_read_b64_tr_b16 v[230:231], v45 offset:25600
    s_add_u32 s36, s51, 24576
    buffer_store_dwordx4 v[64:67], v4, s[20:23], s36 offen sc1
    s_waitcnt lgkmcnt(15)
    v_mfma_f32_32x32x16_bf16 v[160:175], v[192:195], v[176:179], v[160:175]
    ds_read_b64_tr_b16 v[232:233], v46 offset:24576
    ds_read_b64_tr_b16 v[234:235], v46 offset:25600
    buffer_load_dwordx4 v33, s[12:15], s39 offen offset:3072 lds
    s_waitcnt lgkmcnt(15)
    v_mfma_f32_32x32x16_bf16 v[112:127], v[200:203], v[196:199], v[112:127]
    v_subrev_u32 v41, 65536, v41
    ds_read_b128 v[176:179], v41 offset:0
    ds_read_b64_tr_b16 v[180:181], v43 offset:28672
    ds_read_b64_tr_b16 v[182:183], v43 offset:29696
    ds_read_b64_tr_b16 v[184:185], v44 offset:28672
    ds_read_b64_tr_b16 v[186:187], v44 offset:29696
    v_mov_b32 v64, 0
    v_mov_b32 v65, 0
    s_waitcnt lgkmcnt(15)
    v_mfma_f32_32x32x16_bf16 v[128:143], v[204:207], v[196:199], v[128:143]
    ds_read_b64_tr_b16 v[188:189], v45 offset:28672
    ds_read_b64_tr_b16 v[190:191], v45 offset:29696
    ds_read_b64_tr_b16 v[192:193], v46 offset:28672
    ds_read_b64_tr_b16 v[194:195], v46 offset:29696
    v_mov_b32 v66, 0
    v_mov_b32 v67, 0
    v_mfma_f32_32x32x16_bf16 v[144:159], v[208:211], v[196:199], v[144:159]
    s_waitcnt lgkmcnt(15)
    v_mfma_f32_32x32x16_bf16 v[160:175], v[212:215], v[196:199], v[160:175]
    s_waitcnt vmcnt(6) lgkmcnt(0)
    s_barrier
    v_mfma_f32_32x32x16_bf16 v[112:127], v[220:223], v[216:219], v[112:127]
    ds_read_b128 v[196:199], v38 offset:32768
    ds_read_b64_tr_b16 v[200:201], v43 offset:32768
    ds_read_b64_tr_b16 v[202:203], v43 offset:33792
    v_mfma_f32_32x32x16_bf16 v[128:143], v[224:227], v[216:219], v[128:143]
    ds_read_b64_tr_b16 v[204:205], v44 offset:32768
    ds_read_b64_tr_b16 v[206:207], v44 offset:33792
    s_add_u32 s39, s41, 3145728
    s_add_u32 m0, s38, 0
    s_nop 0
    buffer_load_dwordx4 v34, s[16:19], s39 offen offset:0 lds
    v_mfma_f32_32x32x16_bf16 v[144:159], v[228:231], v[216:219], v[144:159]
    ds_read_b64_tr_b16 v[208:209], v45 offset:32768
    ds_read_b64_tr_b16 v[210:211], v45 offset:33792
    s_add_u32 s36, s51, 25600
    buffer_store_dwordx4 v[68:71], v4, s[20:23], s36 offen sc1
    v_mfma_f32_32x32x16_bf16 v[160:175], v[232:235], v[216:219], v[160:175]
    ds_read_b64_tr_b16 v[212:213], v46 offset:32768
    ds_read_b64_tr_b16 v[214:215], v46 offset:33792
    buffer_load_dwordx4 v35, s[16:19], s39 offen offset:1024 lds
    v_mfma_f32_32x32x16_bf16 v[112:127], v[180:183], v[176:179], v[112:127]
    ds_read_b128 v[216:219], v39 offset:32768
    ds_read_b64_tr_b16 v[220:221], v43 offset:36864
    ds_read_b64_tr_b16 v[222:223], v43 offset:37888
    v_mov_b32 v68, 0
    v_mov_b32 v69, 0
    v_mfma_f32_32x32x16_bf16 v[128:143], v[184:187], v[176:179], v[128:143]
    ds_read_b64_tr_b16 v[224:225], v44 offset:36864
    ds_read_b64_tr_b16 v[226:227], v44 offset:37888
    buffer_load_dwordx4 v36, s[16:19], s39 offen offset:2048 lds
    v_mov_b32 v70, 0
    v_mov_b32 v71, 0
    v_mfma_f32_32x32x16_bf16 v[144:159], v[188:191], v[176:179], v[144:159]
    ds_read_b64_tr_b16 v[228:229], v45 offset:36864
    ds_read_b64_tr_b16 v[230:231], v45 offset:37888
    v_mfma_f32_32x32x16_bf16 v[160:175], v[192:195], v[176:179], v[160:175]
    ds_read_b64_tr_b16 v[232:233], v46 offset:36864
    ds_read_b64_tr_b16 v[234:235], v46 offset:37888
    buffer_load_dwordx4 v37, s[16:19], s39 offen offset:3072 lds
    s_waitcnt lgkmcnt(15)
    v_mfma_f32_32x32x16_bf16 v[112:127], v[200:203], v[196:199], v[112:127]
    ds_read_b128 v[176:179], v40 offset:32768
    ds_read_b64_tr_b16 v[180:181], v43 offset:40960
    ds_read_b64_tr_b16 v[182:183], v43 offset:41984
    s_waitcnt lgkmcnt(15)
    v_mfma_f32_32x32x16_bf16 v[128:143], v[204:207], v[196:199], v[128:143]
    ds_read_b64_tr_b16 v[184:185], v44 offset:40960
    ds_read_b64_tr_b16 v[186:187], v44 offset:41984
    s_mov_b32 s39, 768
    s_add_u32 m0, s38, 65536
    s_nop 0
    buffer_load_dwordx4 v30, s[12:15], s39 offen offset:0 lds
    s_waitcnt lgkmcnt(15)
    v_mfma_f32_32x32x16_bf16 v[144:159], v[208:211], v[196:199], v[144:159]
    ds_read_b64_tr_b16 v[188:189], v45 offset:40960
    ds_read_b64_tr_b16 v[190:191], v45 offset:41984
    s_add_u32 s36, s52, 16384
    buffer_store_dwordx4 v[72:75], v4, s[20:23], s36 offen sc1
    s_waitcnt lgkmcnt(15)
    v_mfma_f32_32x32x16_bf16 v[160:175], v[212:215], v[196:199], v[160:175]
    ds_read_b64_tr_b16 v[192:193], v46 offset:40960
    ds_read_b64_tr_b16 v[194:195], v46 offset:41984
    buffer_load_dwordx4 v31, s[12:15], s39 offen offset:1024 lds
    s_waitcnt lgkmcnt(15)
    v_mfma_f32_32x32x16_bf16 v[112:127], v[220:223], v[216:219], v[112:127]
    ds_read_b128 v[196:199], v41 offset:32768
    ds_read_b64_tr_b16 v[200:201], v43 offset:45056
    ds_read_b64_tr_b16 v[202:203], v43 offset:46080
    v_mov_b32 v72, 0
    v_mov_b32 v73, 0
    s_waitcnt lgkmcnt(15)
    v_mfma_f32_32x32x16_bf16 v[128:143], v[224:227], v[216:219], v[128:143]
    ds_read_b64_tr_b16 v[204:205], v44 offset:45056
    ds_read_b64_tr_b16 v[206:207], v44 offset:46080
    buffer_load_dwordx4 v32, s[12:15], s39 offen offset:2048 lds
    v_mov_b32 v74, 0
    v_mov_b32 v75, 0
    s_waitcnt lgkmcnt(15)
    v_mfma_f32_32x32x16_bf16 v[144:159], v[228:231], v[216:219], v[144:159]
    ds_read_b64_tr_b16 v[208:209], v45 offset:45056
    ds_read_b64_tr_b16 v[210:211], v45 offset:46080
    s_waitcnt lgkmcnt(15)
    v_mfma_f32_32x32x16_bf16 v[160:175], v[232:235], v[216:219], v[160:175]
    ds_read_b64_tr_b16 v[212:213], v46 offset:45056
    ds_read_b64_tr_b16 v[214:215], v46 offset:46080
    buffer_load_dwordx4 v33, s[12:15], s39 offen offset:3072 lds
    s_waitcnt vmcnt(10)
    s_waitcnt lgkmcnt(15)
    v_mfma_f32_32x32x16_bf16 v[112:127], v[180:183], v[176:179], v[112:127]
    v_add_u32 v38, 65536, v38
    ds_read_b128 v[216:219], v38 offset:0
    ds_read_b64_tr_b16 v[220:221], v43 offset:49152
    ds_read_b64_tr_b16 v[222:223], v43 offset:50176
    s_waitcnt lgkmcnt(15)
    v_mfma_f32_32x32x16_bf16 v[128:143], v[184:187], v[176:179], v[128:143]
    ds_read_b64_tr_b16 v[224:225], v44 offset:49152
    ds_read_b64_tr_b16 v[226:227], v44 offset:50176
    s_waitcnt lgkmcnt(15)
    v_mfma_f32_32x32x16_bf16 v[144:159], v[188:191], v[176:179], v[144:159]
    ds_read_b64_tr_b16 v[228:229], v45 offset:49152
    ds_read_b64_tr_b16 v[230:231], v45 offset:50176
    s_add_u32 s36, s52, 20480
    buffer_store_dwordx4 v[76:79], v4, s[20:23], s36 offen sc1
    s_waitcnt lgkmcnt(15)
    v_mfma_f32_32x32x16_bf16 v[160:175], v[192:195], v[176:179], v[160:175]
    ds_read_b64_tr_b16 v[232:233], v46 offset:49152
    ds_read_b64_tr_b16 v[234:235], v46 offset:50176
    s_waitcnt lgkmcnt(15)
    v_mfma_f32_32x32x16_bf16 v[112:127], v[200:203], v[196:199], v[112:127]
    v_add_u32 v39, 65536, v39
    ds_read_b128 v[176:179], v39 offset:0
    ds_read_b64_tr_b16 v[180:181], v43 offset:53248
    ds_read_b64_tr_b16 v[182:183], v43 offset:54272
    v_mov_b32 v76, 0
    v_mov_b32 v77, 0
    s_waitcnt lgkmcnt(15)
    v_mfma_f32_32x32x16_bf16 v[128:143], v[204:207], v[196:199], v[128:143]
    ds_read_b64_tr_b16 v[184:185], v44 offset:53248
    ds_read_b64_tr_b16 v[186:187], v44 offset:54272
    s_mov_b32 s39, 896
    s_add_u32 m0, s38, 98304
    s_nop 0
    buffer_load_dwordx4 v30, s[12:15], s39 offen offset:0 lds
    v_mov_b32 v78, 0
    v_mov_b32 v79, 0
    s_waitcnt lgkmcnt(15)
    v_mfma_f32_32x32x16_bf16 v[144:159], v[208:211], v[196:199], v[144:159]
    ds_read_b64_tr_b16 v[188:189], v45 offset:53248
    ds_read_b64_tr_b16 v[190:191], v45 offset:54272
    s_waitcnt lgkmcnt(15)
    v_mfma_f32_32x32x16_bf16 v[160:175], v[212:215], v[196:199], v[160:175]
    ds_read_b64_tr_b16 v[192:193], v46 offset:53248
    ds_read_b64_tr_b16 v[194:195], v46 offset:54272
    buffer_load_dwordx4 v31, s[12:15], s39 offen offset:1024 lds
    s_waitcnt lgkmcnt(15)
    v_mfma_f32_32x32x16_bf16 v[112:127], v[220:223], v[216:219], v[112:127]
    v_add_u32 v40, 65536, v40
    ds_read_b128 v[196:199], v40 offset:0
    ds_read_b64_tr_b16 v[200:201], v43 offset:57344
    ds_read_b64_tr_b16 v[202:203], v43 offset:58368
    s_waitcnt lgkmcnt(15)
    v_mfma_f32_32x32x16_bf16 v[128:143], v[224:227], v[216:219], v[128:143]
    ds_read_b64_tr_b16 v[204:205], v44 offset:57344
    ds_read_b64_tr_b16 v[206:207], v44 offset:58368
    buffer_load_dwordx4 v32, s[12:15], s39 offen offset:2048 lds
    s_waitcnt lgkmcnt(15)
    v_mfma_f32_32x32x16_bf16 v[144:159], v[228:231], v[216:219], v[144:159]
    ds_read_b64_tr_b16 v[208:209], v45 offset:57344
    ds_read_b64_tr_b16 v[210:211], v45 offset:58368
    s_add_u32 s36, s51, 32768
    buffer_store_dwordx4 v[80:83], v4, s[20:23], s36 offen sc1
    s_waitcnt lgkmcnt(15)
    v_mfma_f32_32x32x16_bf16 v[160:175], v[232:235], v[216:219], v[160:175]
    ds_read_b64_tr_b16 v[212:213], v46 offset:57344
    ds_read_b64_tr_b16 v[214:215], v46 offset:58368
    buffer_load_dwordx4 v33, s[12:15], s39 offen offset:3072 lds
    s_waitcnt lgkmcnt(15)
    v_mfma_f32_32x32x16_bf16 v[112:127], v[180:183], v[176:179], v[112:127]
    v_add_u32 v41, 65536, v41
    ds_read_b128 v[216:219], v41 offset:0
    ds_read_b64_tr_b16 v[220:221], v43 offset:61440
    ds_read_b64_tr_b16 v[222:223], v43 offset:62464
    ds_read_b64_tr_b16 v[224:225], v44 offset:61440
    ds_read_b64_tr_b16 v[226:227], v44 offset:62464
    v_mov_b32 v80, 0
    v_mov_b32 v81, 0
    s_waitcnt lgkmcnt(15)
    v_mfma_f32_32x32x16_bf16 v[128:143], v[184:187], v[176:179], v[128:143]
    ds_read_b64_tr_b16 v[228:229], v45 offset:61440
    ds_read_b64_tr_b16 v[230:231], v45 offset:62464
    ds_read_b64_tr_b16 v[232:233], v46 offset:61440
    ds_read_b64_tr_b16 v[234:235], v46 offset:62464
    v_mov_b32 v82, 0
    v_mov_b32 v83, 0
    v_mfma_f32_32x32x16_bf16 v[144:159], v[188:191], v[176:179], v[144:159]
    s_waitcnt lgkmcnt(15)
    v_mfma_f32_32x32x16_bf16 v[160:175], v[192:195], v[176:179], v[160:175]
    s_waitcnt vmcnt(6) lgkmcnt(0)
    s_barrier
    v_mfma_f32_32x32x16_bf16 v[112:127], v[200:203], v[196:199], v[112:127]
    v_subrev_u32 v38, 65536, v38
    ds_read_b128 v[176:179], v38 offset:0
    ds_read_b64_tr_b16 v[180:181], v43 offset:0
    ds_read_b64_tr_b16 v[182:183], v43 offset:1024
    v_mfma_f32_32x32x16_bf16 v[128:143], v[204:207], v[196:199], v[128:143]
    ds_read_b64_tr_b16 v[184:185], v44 offset:0
    ds_read_b64_tr_b16 v[186:187], v44 offset:1024
    s_add_u32 s39, s41, 4194304
    s_add_u32 m0, s38, 32768
    s_nop 0
    buffer_load_dwordx4 v34, s[16:19], s39 offen offset:0 lds
    v_mfma_f32_32x32x16_bf16 v[144:159], v[208:211], v[196:199], v[144:159]
    ds_read_b64_tr_b16 v[188:189], v45 offset:0
    ds_read_b64_tr_b16 v[190:191], v45 offset:1024
    s_add_u32 s36, s51, 33792
    buffer_store_dwordx4 v[84:87], v4, s[20:23], s36 offen sc1
    v_mfma_f32_32x32x16_bf16 v[160:175], v[212:215], v[196:199], v[160:175]
    ds_read_b64_tr_b16 v[192:193], v46 offset:0
    ds_read_b64_tr_b16 v[194:195], v46 offset:1024
    buffer_load_dwordx4 v35, s[16:19], s39 offen offset:1024 lds
    v_mfma_f32_32x32x16_bf16 v[112:127], v[220:223], v[216:219], v[112:127]
    v_subrev_u32 v39, 65536, v39
    ds_read_b128 v[196:199], v39 offset:0
    ds_read_b64_tr_b16 v[200:201], v43 offset:4096
    ds_read_b64_tr_b16 v[202:203], v43 offset:5120
    v_mov_b32 v84, 0
    v_mov_b32 v85, 0
    v_mfma_f32_32x32x16_bf16 v[128:143], v[224:227], v[216:219], v[128:143]
    ds_read_b64_tr_b16 v[204:205], v44 offset:4096
    ds_read_b64_tr_b16 v[206:207], v44 offset:5120
    buffer_load_dwordx4 v36, s[16:19], s39 offen offset:2048 lds
    v_mov_b32 v86, 0
    v_mov_b32 v87, 0
    v_mfma_f32_32x32x16_bf16 v[144:159], v[228:231], v[216:219], v[144:159]
    ds_read_b64_tr_b16 v[208:209], v45 offset:4096
    ds_read_b64_tr_b16 v[210:211], v45 offset:5120
    v_mfma_f32_32x32x16_bf16 v[160:175], v[232:235], v[216:219], v[160:175]
    ds_read_b64_tr_b16 v[212:213], v46 offset:4096
    ds_read_b64_tr_b16 v[214:215], v46 offset:5120
    buffer_load_dwordx4 v37, s[16:19], s39 offen offset:3072 lds
    s_waitcnt lgkmcnt(15)
    v_mfma_f32_32x32x16_bf16 v[112:127], v[180:183], v[176:179], v[112:127]
    v_subrev_u32 v40, 65536, v40
    ds_read_b128 v[216:219], v40 offset:0
    ds_read_b64_tr_b16 v[220:221], v43 offset:8192
    ds_read_b64_tr_b16 v[222:223], v43 offset:9216
    s_waitcnt lgkmcnt(15)
    v_mfma_f32_32x32x16_bf16 v[128:143], v[184:187], v[176:179], v[128:143]
    ds_read_b64_tr_b16 v[224:225], v44 offset:8192
    ds_read_b64_tr_b16 v[226:227], v44 offset:9216
    s_mov_b32 s39, 1024
    s_add_u32 m0, s38, 131072
    s_nop 0
    buffer_load_dwordx4 v30, s[12:15], s39 offen offset:0 lds
    s_waitcnt lgkmcnt(15)
    v_mfma_f32_32x32x16_bf16 v[144:159], v[188:191], v[176:179], v[144:159]
    ds_read_b64_tr_b16 v[228:229], v45 offset:8192
    ds_read_b64_tr_b16 v[230:231], v45 offset:9216
    s_add_u32 s36, s52, 40960
    buffer_store_dwordx4 v[88:91], v4, s[20:23], s36 offen sc1
    s_waitcnt lgkmcnt(15)
    v_mfma_f32_32x32x16_bf16 v[160:175], v[192:195], v[176:179], v[160:175]
    ds_read_b64_tr_b16 v[232:233], v46 offset:8192
    ds_read_b64_tr_b16 v[234:235], v46 offset:9216
    buffer_load_dwordx4 v31, s[12:15], s39 offen offset:1024 lds
    s_waitcnt lgkmcnt(15)
    v_mfma_f32_32x32x16_bf16 v[112:127], v[200:203], v[196:199], v[112:127]
    v_subrev_u32 v41, 65536, v41
    ds_read_b128 v[176:179], v41 offset:0
    ds_read_b64_tr_b16 v[180:181], v43 offset:12288
    ds_read_b64_tr_b16 v[182:183], v43 offset:13312
    v_mov_b32 v88, 0
    v_mov_b32 v89, 0
    s_waitcnt lgkmcnt(15)
    v_mfma_f32_32x32x16_bf16 v[128:143], v[204:207], v[196:199], v[128:143]
    ds_read_b64_tr_b16 v[184:185], v44 offset:12288
    ds_read_b64_tr_b16 v[186:187], v44 offset:13312
    buffer_load_dwordx4 v32, s[12:15], s39 offen offset:2048 lds
    v_mov_b32 v90, 0
    v_mov_b32 v91, 0
    s_waitcnt lgkmcnt(15)
    v_mfma_f32_32x32x16_bf16 v[144:159], v[208:211], v[196:199], v[144:159]
    ds_read_b64_tr_b16 v[188:189], v45 offset:12288
    ds_read_b64_tr_b16 v[190:191], v45 offset:13312
    s_waitcnt lgkmcnt(15)
    v_mfma_f32_32x32x16_bf16 v[160:175], v[212:215], v[196:199], v[160:175]
    ds_read_b64_tr_b16 v[192:193], v46 offset:12288
    ds_read_b64_tr_b16 v[194:195], v46 offset:13312
    buffer_load_dwordx4 v33, s[12:15], s39 offen offset:3072 lds
    s_waitcnt vmcnt(10)
    s_waitcnt lgkmcnt(15)
    v_mfma_f32_32x32x16_bf16 v[112:127], v[220:223], v[216:219], v[112:127]
    ds_read_b128 v[196:199], v38 offset:32768
    ds_read_b64_tr_b16 v[200:201], v43 offset:16384
    ds_read_b64_tr_b16 v[202:203], v43 offset:17408
    s_waitcnt lgkmcnt(15)
    v_mfma_f32_32x32x16_bf16 v[128:143], v[224:227], v[216:219], v[128:143]
    ds_read_b64_tr_b16 v[204:205], v44 offset:16384
    ds_read_b64_tr_b16 v[206:207], v44 offset:17408
    s_waitcnt lgkmcnt(15)
    v_mfma_f32_32x32x16_bf16 v[144:159], v[228:231], v[216:219], v[144:159]
    ds_read_b64_tr_b16 v[208:209], v45 offset:16384
    ds_read_b64_tr_b16 v[210:211], v45 offset:17408
    s_add_u32 s36, s52, 45056
    buffer_store_dwordx4 v[92:95], v4, s[20:23], s36 offen sc1
    s_waitcnt lgkmcnt(15)
    v_mfma_f32_32x32x16_bf16 v[160:175], v[232:235], v[216:219], v[160:175]
    ds_read_b64_tr_b16 v[212:213], v46 offset:16384
    ds_read_b64_tr_b16 v[214:215], v46 offset:17408
    s_cmp_lg_u32 s32, 0
    s_cbranch_scc1 L_mn_nopoll_l
    buffer_load_dword v2, v19, s[28:31], 0 offen sc1
L_mn_nopoll_l:
    s_waitcnt lgkmcnt(15)
    v_mfma_f32_32x32x16_bf16 v[112:127], v[180:183], v[176:179], v[112:127]
    ds_read_b128 v[216:219], v39 offset:32768
    ds_read_b64_tr_b16 v[220:221], v43 offset:20480
    ds_read_b64_tr_b16 v[222:223], v43 offset:21504
    v_mov_b32 v92, 0
    v_mov_b32 v93, 0
    s_waitcnt lgkmcnt(15)
    v_mfma_f32_32x32x16_bf16 v[128:143], v[184:187], v[176:179], v[128:143]
    ds_read_b64_tr_b16 v[224:225], v44 offset:20480
    ds_read_b64_tr_b16 v[226:227], v44 offset:21504
    s_mov_b32 s39, 1152
    s_add_u32 m0, s38, 65536
    s_nop 0
    buffer_load_dwordx4 v30, s[12:15], s39 offen offset:0 lds
    v_mov_b32 v94, 0
    v_mov_b32 v95, 0
    s_waitcnt lgkmcnt(15)
    v_mfma_f32_32x32x16_bf16 v[144:159], v[188:191], v[176:179], v[144:159]
    ds_read_b64_tr_b16 v[228:229], v45 offset:20480
    ds_read_b64_tr_b16 v[230:231], v45 offset:21504
    s_waitcnt lgkmcnt(15)
    v_mfma_f32_32x32x16_bf16 v[160:175], v[192:195], v[176:179], v[160:175]
    ds_read_b64_tr_b16 v[232:233], v46 offset:20480
    ds_read_b64_tr_b16 v[234:235], v46 offset:21504
    buffer_load_dwordx4 v31, s[12:15], s39 offen offset:1024 lds
    s_waitcnt lgkmcnt(15)
    v_mfma_f32_32x32x16_bf16 v[112:127], v[200:203], v[196:199], v[112:127]
    ds_read_b128 v[176:179], v40 offset:32768
    ds_read_b64_tr_b16 v[180:181], v43 offset:24576
    ds_read_b64_tr_b16 v[182:183], v43 offset:25600
    s_waitcnt lgkmcnt(15)
    v_mfma_f32_32x32x16_bf16 v[128:143], v[204:207], v[196:199], v[128:143]
    ds_read_b64_tr_b16 v[184:185], v44 offset:24576
    ds_read_b64_tr_b16 v[186:187], v44 offset:25600
    buffer_load_dwordx4 v32, s[12:15], s39 offen offset:2048 lds
    s_waitcnt lgkmcnt(15)
    v_mfma_f32_32x32x16_bf16 v[144:159], v[208:211], v[196:199], v[144:159]
    ds_read_b64_tr_b16 v[188:189], v45 offset:24576
    ds_read_b64_tr_b16 v[190:191], v45 offset:25600
    s_add_u32 s36, s51, 57344
    buffer_store_dwordx4 v[96:99], v4, s[20:23], s36 offen sc1
    s_waitcnt lgkmcnt(15)
    v_mfma_f32_32x32x16_bf16 v[160:175], v[212:215], v[196:199], v[160:175]
    ds_read_b64_tr_b16 v[192:193], v46 offset:24576
    ds_read_b64_tr_b16 v[194:195], v46 offset:25600
    buffer_load_dwordx4 v33, s[12:15], s39 offen offset:3072 lds
    s_waitcnt lgkmcnt(15)
    v_mfma_f32_32x32x16_bf16 v[112:127], v[220:223], v[216:219], v[112:127]
    ds_read_b128 v[196:199], v41 offset:32768
    ds_read_b64_tr_b16 v[200:201], v43 offset:28672
    ds_read_b64_tr_b16 v[202:203], v43 offset:29696
    ds_read_b64_tr_b16 v[204:205], v44 offset:28672
    ds_read_b64_tr_b16 v[206:207], v44 offset:29696
    v_mov_b32 v96, 0
    v_mov_b32 v97, 0
    s_waitcnt lgkmcnt(15)
    v_mfma_f32_32x32x16_bf16 v[128:143], v[224:227], v[216:219], v[128:143]
    ds_read_b64_tr_b16 v[208:209], v45 offset:28672
    ds_read_b64_tr_b16 v[210:211], v45 offset:29696
    ds_read_b64_tr_b16 v[212:213], v46 offset:28672
    ds_read_b64_tr_b16 v[214:215], v46 offset:29696
    v_mov_b32 v98, 0
    v_mov_b32 v99, 0
    v_mfma_f32_32x32x16_bf16 v[144:159], v[228:231], v[216:219], v[144:159]
    s_waitcnt lgkmcnt(15)
    v_mfma_f32_32x32x16_bf16 v[160:175], v[232:235], v[216:219], v[160:175]
    s_waitcnt vmcnt(5)
    s_cmp_lg_u32 s32, 0
    s_cbranch_scc1 L_mn_spun_l
    v_and_b32 v2, 0x0101, v2
    v_cmp_ne_u32 vcc, 0x0101, v2
    s_cbranch_vccnz L_mn_spin_l
L_mn_spun_l:
    s_waitcnt lgkmcnt(0)
    s_barrier
    v_mfma_f32_32x32x16_bf16 v[112:127], v[180:183], v[176:179], v[112:127]
    v_add_u32 v38, 65536, v38
    ds_read_b128 v[216:219], v38 offset:0
    ds_read_b64_tr_b16 v[220:221], v43 offset:32768
    ds_read_b64_tr_b16 v[222:223], v43 offset:33792
    v_mfma_f32_32x32x16_bf16 v[128:143], v[184:187], v[176:179], v[128:143]
    ds_read_b64_tr_b16 v[224:225], v44 offset:32768
    ds_read_b64_tr_b16 v[226:227], v44 offset:33792
    v_mfma_f32_32x32x16_bf16 v[144:159], v[188:191], v[176:179], v[144:159]
    ds_read_b64_tr_b16 v[228:229], v45 offset:32768
    ds_read_b64_tr_b16 v[230:231], v45 offset:33792
    s_add_u32 s36, s51, 58368
    buffer_store_dwordx4 v[100:103], v4, s[20:23], s36 offen sc1
    v_mfma_f32_32x32x16_bf16 v[160:175], v[192:195], v[176:179], v[160:175]
    ds_read_b64_tr_b16 v[232:233], v46 offset:32768
    ds_read_b64_tr_b16 v[234:235], v46 offset:33792
    v_mov_b32 v11, 0
    v_mov_b32 v17, 2
    ds_write_b32 v14, v11 offset:0
    ds_write_b32 v14, v17 offset:2048
    v_mfma_f32_32x32x16_bf16 v[112:127], v[200:203], v[196:199], v[112:127]
    v_add_u32 v39, 65536, v39
    ds_read_b128 v[176:179], v39 offset:0
    ds_read_b64_tr_b16 v[180:181], v43 offset:36864
    ds_read_b64_tr_b16 v[182:183], v43 offset:37888
    v_mov_b32 v100, 0
    v_mov_b32 v101, 0
    v_mfma_f32_32x32x16_bf16 v[128:143], v[204:207], v[196:199], v[128:143]
    ds_read_b64_tr_b16 v[184:185], v44 offset:36864
    ds_read_b64_tr_b16 v[186:187], v44 offset:37888
    s_lshl_b32 s39, s32, 10
    s_add_u32 m0, s39, 4096
    s_nop 0
    buffer_load_dwordx4 v4, s[20:23], s39 offen sc1 lds
    v_mov_b32 v102, 0
    v_mov_b32 v103, 0
    v_mfma_f32_32x32x16_bf16 v[144:159], v[208:211], v[196:199], v[144:159]
    ds_read_b64_tr_b16 v[188:189], v45 offset:36864
    ds_read_b64_tr_b16 v[190:191], v45 offset:37888
    v_mfma_f32_32x32x16_bf16 v[160:175], v[212:215], v[196:199], v[160:175]
    ds_read_b64_tr_b16 v[192:193], v46 offset:36864
    ds_read_b64_tr_b16 v[194:195], v46 offset:37888
    s_cmp_ge_u32 s32, 5
    s_cbranch_scc1 L_mn_nowo_l
    s_add_u32 m0, s38, 12288
    s_nop 0
    buffer_load_dwordx4 v30, s[56:59], 0 offen offset:0 lds
    buffer_load_dwordx4 v31, s[56:59], 0 offen offset:1024 lds
    buffer_load_dwordx4 v32, s[56:59], 0 offen offset:2048 lds
    buffer_load_dwordx4 v33, s[56:59], 0 offen offset:3072 lds
L_mn_nowo_l:
    s_waitcnt lgkmcnt(15)
    v_mfma_f32_32x32x16_bf16 v[112:127], v[220:223], v[216:219], v[112:127]
    v_add_u32 v40, 65536, v40
    ds_read_b128 v[196:199], v40 offset:0
    ds_read_b64_tr_b16 v[200:201], v43 offset:40960
    ds_read_b64_tr_b16 v[202:203], v43 offset:41984
    v_mfma_f32_32x32x16_bf16 v[128:143], v[224:227], v[216:219], v[128:143]
    ds_read_b64_tr_b16 v[204:205], v44 offset:40960
    ds_read_b64_tr_b16 v[206:207], v44 offset:41984
    s_add_u32 s39, s38, 8192
    s_add_u32 m0, s38, 98304
    s_nop 0
    buffer_load_dwordx4 v4, s[20:23], s39 offen offset:0 sc1 lds
    s_waitcnt lgkmcnt(15)
    v_mfma_f32_32x32x16_bf16 v[144:159], v[228:231], v[216:219], v[144:159]
    ds_read_b64_tr_b16 v[208:209], v45 offset:40960
    ds_read_b64_tr_b16 v[210:211], v45 offset:41984
    s_add_u32 s36, s52, 49152
    buffer_store_dwordx4 v[104:107], v4, s[20:23], s36 offen sc1
    v_mfma_f32_32x32x16_bf16 v[160:175], v[232:235], v[216:219], v[160:175]
    ds_read_b64_tr_b16 v[212:213], v46 offset:40960
    ds_read_b64_tr_b16 v[214:215], v46 offset:41984
    buffer_load_dwordx4 v4, s[20:23], s39 offen offset:1024 sc1 lds
    s_waitcnt lgkmcnt(15)
    v_mfma_f32_32x32x16_bf16 v[112:127], v[180:183], v[176:179], v[112:127]
    v_add_u32 v41, 65536, v41
    ds_read_b128 v[216:219], v41 offset:0
    ds_read_b64_tr_b16 v[220:221], v43 offset:45056
    ds_read_b64_tr_b16 v[222:223], v43 offset:46080
    v_mov_b32 v104, 0
    v_mov_b32 v105, 0
    s_waitcnt lgkmcnt(15)
    v_mfma_f32_32x32x16_bf16 v[128:143], v[184:187], v[176:179], v[128:143]
    ds_read_b64_tr_b16 v[224:225], v44 offset:45056
    ds_read_b64_tr_b16 v[226:227], v44 offset:46080
    buffer_load_dwordx4 v4, s[20:23], s39 offen offset:2048 sc1 lds
    v_mov_b32 v106, 0
    v_mov_b32 v107, 0
    s_waitcnt lgkmcnt(15)
    v_mfma_f32_32x32x16_bf16 v[144:159], v[188:191], v[176:179], v[144:159]
    ds_read_b64_tr_b16 v[228:229], v45 offset:45056
    ds_read_b64_tr_b16 v[230:231], v45 offset:46080
    s_waitcnt lgkmcnt(15)
    v_mfma_f32_32x32x16_bf16 v[160:175], v[192:195], v[176:179], v[160:175]
    ds_read_b64_tr_b16 v[232:233], v46 offset:45056
    ds_read_b64_tr_b16 v[234:235], v46 offset:46080
    buffer_load_dwordx4 v4, s[20:23], s39 offen offset:3072 sc1 lds
    s_waitcnt vmcnt(7)
    s_waitcnt lgkmcnt(15)
    v_mfma_f32_32x32x16_bf16 v[112:127], v[200:203], v[196:199], v[112:127]
    v_subrev_u32 v38, 65536, v38
    ds_read_b128 v[176:179], v38 offset:0
    ds_read_b64_tr_b16 v[180:181], v43 offset:49152
    ds_read_b64_tr_b16 v[182:183], v43 offset:50176
    s_waitcnt lgkmcnt(15)
    v_mfma_f32_32x32x16_bf16 v[128:143], v[204:207], v[196:199], v[128:143]
    ds_read_b64_tr_b16 v[184:185], v44 offset:49152
    ds_read_b64_tr_b16 v[186:187], v44 offset:50176
    s_waitcnt lgkmcnt(15)
    v_mfma_f32_32x32x16_bf16 v[144:159], v[208:211], v[196:199], v[144:159]
    ds_read_b64_tr_b16 v[188:189], v45 offset:49152
    ds_read_b64_tr_b16 v[190:191], v45 offset:50176
    s_add_u32 s36, s52, 53248
    buffer_store_dwordx4 v[108:111], v4, s[20:23], s36 offen sc1
    s_waitcnt lgkmcnt(15)
    v_mfma_f32_32x32x16_bf16 v[160:175], v[212:215], v[196:199], v[160:175]
    ds_read_b64_tr_b16 v[192:193], v46 offset:49152
    ds_read_b64_tr_b16 v[194:195], v46 offset:50176
    s_waitcnt lgkmcnt(15)
    v_mfma_f32_32x32x16_bf16 v[112:127], v[220:223], v[216:219], v[112:127]
    v_subrev_u32 v39, 65536, v39
    ds_read_b128 v[196:199], v39 offset:0
    ds_read_b64_tr_b16 v[200:201], v43 offset:53248
    ds_read_b64_tr_b16 v[202:203], v43 offset:54272
    v_mov_b32 v108, 0
    v_mov_b32 v109, 0
    s_waitcnt lgkmcnt(15)
    v_mfma_f32_32x32x16_bf16 v[128:143], v[224:227], v[216:219], v[128:143]
    ds_read_b64_tr_b16 v[204:205], v44 offset:53248
    ds_read_b64_tr_b16 v[206:207], v44 offset:54272
    s_add_u32 s39, s38, 40960
    s_add_u32 m0, s38, 131072
    s_nop 0
    buffer_load_dwordx4 v4, s[20:23], s39 offen offset:0 sc1 lds
    v_mov_b32 v110, 0
    v_mov_b32 v111, 0
    s_waitcnt lgkmcnt(15)
    v_mfma_f32_32x32x16_bf16 v[144:159], v[228:231], v[216:219], v[144:159]
    ds_read_b64_tr_b16 v[208:209], v45 offset:53248
    ds_read_b64_tr_b16 v[210:211], v45 offset:54272
    s_waitcnt lgkmcnt(15)
    v_mfma_f32_32x32x16_bf16 v[160:175], v[232:235], v[216:219], v[160:175]
    ds_read_b64_tr_b16 v[212:213], v46 offset:53248
    ds_read_b64_tr_b16 v[214:215], v46 offset:54272
    buffer_load_dwordx4 v4, s[20:23], s39 offen offset:1024 sc1 lds
    s_waitcnt lgkmcnt(15)
    v_mfma_f32_32x32x16_bf16 v[112:127], v[180:183], v[176:179], v[112:127]
    v_subrev_u32 v40, 65536, v40
    ds_read_b128 v[216:219], v40 offset:0
    ds_read_b64_tr_b16 v[220:221], v43 offset:57344
    ds_read_b64_tr_b16 v[222:223], v43 offset:58368
    s_waitcnt lgkmcnt(15)
    v_mfma_f32_32x32x16_bf16 v[128:143], v[184:187], v[176:179], v[128:143]
    ds_read_b64_tr_b16 v[224:225], v44 offset:57344
    ds_read_b64_tr_b16 v[226:227], v44 offset:58368
    buffer_load_dwordx4 v4, s[20:23], s39 offen offset:2048 sc1 lds
    s_waitcnt lgkmcnt(15)
    v_mfma_f32_32x32x16_bf16 v[144:159], v[188:191], v[176:179], v[144:159]
    ds_read_b64_tr_b16 v[228:229], v45 offset:57344
    ds_read_b64_tr_b16 v[230:231], v45 offset:58368
    s_waitcnt lgkmcnt(15)
    v_mfma_f32_32x32x16_bf16 v[160:175], v[192:195], v[176:179], v[160:175]
    ds_read_b64_tr_b16 v[232:233], v46 offset:57344
    ds_read_b64_tr_b16 v[234:235], v46 offset:58368
    buffer_load_dwordx4 v4, s[20:23], s39 offen offset:3072 sc1 lds
    s_waitcnt vmcnt(10)
    v_xor_b32 v8, 0, v21
    v_xor_b32 v9, 64, v21
    ds_read_b64_tr_b16 v[236:237], v8
    ds_read_b64_tr_b16 v[238:239], v9 offset:1024
    v_xor_b32 v8, 32, v21
    v_xor_b32 v9, 96, v21
    ds_read_b64_tr_b16 v[240:241], v8
    ds_read_b64_tr_b16 v[242:243], v9 offset:1024
    v_xor_b32 v8, 64, v21
    v_xor_b32 v9, 0, v21
    ds_read_b64_tr_b16 v[244:245], v8
    ds_read_b64_tr_b16 v[246:247], v9 offset:1024
    v_xor_b32 v8, 96, v21
    v_xor_b32 v9, 32, v21
    ds_read_b64_tr_b16 v[248:249], v8
    ds_read_b64_tr_b16 v[250:251], v9 offset:1024
    v_subrev_u32 v41, 65536, v41
    ds_read_b128 v[176:179], v41 offset:0
    ds_read_b64_tr_b16 v[180:181], v43 offset:61440
    ds_read_b64_tr_b16 v[182:183], v43 offset:62464
    ds_read_b64_tr_b16 v[184:185], v44 offset:61440
    ds_read_b64_tr_b16 v[186:187], v44 offset:62464
    ds_read_b64_tr_b16 v[188:189], v45 offset:61440
    ds_read_b64_tr_b16 v[190:191], v45 offset:62464
    ds_read_b64_tr_b16 v[192:193], v46 offset:61440
    ds_read_b64_tr_b16 v[194:195], v46 offset:62464
    s_waitcnt lgkmcnt(15)
    v_mfma_f32_32x32x16_bf16 v[112:127], v[200:203], v[196:199], v[112:127]
    s_add_u32 s36, s61, 0
    s_mul_i32 s37, s36, 52
    s_lshr_b32 s37, s37, 8
    s_mul_i32 s37, s37, 635
    s_add_u32 s36, s36, s37
    s_lshl_b32 s36, s36, 10
    s_add_u32 s36, s36, s60
    s_waitcnt lgkmcnt(9)
    buffer_store_dwordx4 v[236:239], v4, s[24:27], s36 offen sc1
    v_mfma_f32_32x32x16_bf16 v[112:127], v[220:223], v[216:219], v[112:127]
    s_add_u32 s36, s61, 1
    s_mul_i32 s37, s36, 52
    s_lshr_b32 s37, s37, 8
    s_mul_i32 s37, s37, 635
    s_add_u32 s36, s36, s37
    s_lshl_b32 s36, s36, 10
    s_add_u32 s36, s36, s60
    buffer_store_dwordx4 v[240:243], v4, s[24:27], s36 offen sc1
    s_waitcnt lgkmcnt(6)
    v_mfma_f32_32x32x16_bf16 v[112:127], v[180:183], v[176:179], v[112:127]
    s_add_u32 s36, s61, 2
    s_mul_i32 s37, s36, 52
    s_lshr_b32 s37, s37, 8
    s_mul_i32 s37, s37, 635
    s_add_u32 s36, s36, s37
    s_lshl_b32 s36, s36, 10
    s_add_u32 s36, s36, s60
    buffer_store_dwordx4 v[244:247], v4, s[24:27], s36 offen sc1
    v_mfma_f32_32x32x16_bf16 v[128:143], v[204:207], v[196:199], v[128:143]
    s_add_u32 s36, s61, 3
    s_mul_i32 s37, s36, 52
    s_lshr_b32 s37, s37, 8
    s_mul_i32 s37, s37, 635
    s_add_u32 s36, s36, s37
    s_lshl_b32 s36, s36, 10
    s_add_u32 s36, s36, s60
    buffer_store_dwordx4 v[248:251], v4, s[24:27], s36 offen sc1
    s_add_u32 s24, s24, 4273995776
    s_addc_u32 s25, s25, -1
    s_mov_b32 s26, 16777216
    v_mfma_f32_32x32x16_bf16 v[128:143], v[224:227], v[216:219], v[128:143]
    s_waitcnt lgkmcnt(4)
    v_mfma_f32_32x32x16_bf16 v[128:143], v[184:187], v[176:179], v[128:143]
    v_mul_f32 v112, s62, v112
    v_mul_f32 v113, s62, v113
    v_cvt_pk_bf16_f32 v112, v112, v113
    v_mul_f32 v114, s62, v114
    v_mul_f32 v115, s62, v115
    v_cvt_pk_bf16_f32 v113, v114, v115
    v_mul_f32 v116, s62, v116
    v_mul_f32 v117, s62, v117
    v_cvt_pk_bf16_f32 v114, v116, v117
    v_mul_f32 v118, s62, v118
    v_mul_f32 v119, s62, v119
    v_cvt_pk_bf16_f32 v115, v118, v119
    v_mfma_f32_32x32x16_bf16 v[144:159], v[208:211], v[196:199], v[144:159]
    v_mul_f32 v120, s62, v120
    v_mul_f32 v121, s62, v121
    v_cvt_pk_bf16_f32 v116, v120, v121
    v_mul_f32 v122, s62, v122
    v_mul_f32 v123, s62, v123
    v_cvt_pk_bf16_f32 v117, v122, v123
    v_mul_f32 v124, s62, v124
    v_mul_f32 v125, s62, v125
    v_cvt_pk_bf16_f32 v118, v124, v125
    v_mul_f32 v126, s62, v126
    v_mul_f32 v127, s62, v127
    v_cvt_pk_bf16_f32 v119, v126, v127
    v_mfma_f32_32x32x16_bf16 v[144:159], v[228:231], v[216:219], v[144:159]
    s_waitcnt lgkmcnt(2)
    v_mfma_f32_32x32x16_bf16 v[144:159], v[188:191], v[176:179], v[144:159]
    v_mul_f32 v128, s62, v128
    v_mul_f32 v129, s62, v129
    v_cvt_pk_bf16_f32 v128, v128, v129
    v_mul_f32 v130, s62, v130
    v_mul_f32 v131, s62, v131
    v_cvt_pk_bf16_f32 v129, v130, v131
    v_mul_f32 v132, s62, v132
    v_mul_f32 v133, s62, v133
    v_cvt_pk_bf16_f32 v130, v132, v133
    v_mul_f32 v134, s62, v134
    v_mul_f32 v135, s62, v135
    v_cvt_pk_bf16_f32 v131, v134, v135
    v_mfma_f32_32x32x16_bf16 v[160:175], v[212:215], v[196:199], v[160:175]
    v_mul_f32 v136, s62, v136
    v_mul_f32 v137, s62, v137
    v_cvt_pk_bf16_f32 v132, v136, v137
    v_mul_f32 v138, s62, v138
    v_mul_f32 v139, s62, v139
    v_cvt_pk_bf16_f32 v133, v138, v139
    v_mul_f32 v140, s62, v140
    v_mul_f32 v141, s62, v141
    v_cvt_pk_bf16_f32 v134, v140, v141
    v_mul_f32 v142, s62, v142
    v_mul_f32 v143, s62, v143
    v_cvt_pk_bf16_f32 v135, v142, v143
    v_mfma_f32_32x32x16_bf16 v[160:175], v[232:235], v[216:219], v[160:175]
    s_waitcnt lgkmcnt(0)
    v_mfma_f32_32x32x16_bf16 v[160:175], v[192:195], v[176:179], v[160:175]
    v_mul_f32 v144, s62, v144
    v_mul_f32 v145, s62, v145
    v_cvt_pk_bf16_f32 v144, v144, v145
    v_mul_f32 v146, s62, v146
    v_mul_f32 v147, s62, v147
    v_cvt_pk_bf16_f32 v145, v146, v147
    v_mul_f32 v148, s62, v148
    v_mul_f32 v149, s62, v149
    v_cvt_pk_bf16_f32 v146, v148, v149
    v_mul_f32 v150, s62, v150
    v_mul_f32 v151, s62, v151
    v_cvt_pk_bf16_f32 v147, v150, v151
    v_mul_f32 v152, s62, v152
    v_mul_f32 v153, s62, v153
    v_cvt_pk_bf16_f32 v148, v152, v153
    v_mul_f32 v154, s62, v154
    v_mul_f32 v155, s62, v155
    v_cvt_pk_bf16_f32 v149, v154, v155
    v_mul_f32 v156, s62, v156
    v_mul_f32 v157, s62, v157
    v_cvt_pk_bf16_f32 v150, v156, v157
    v_mul_f32 v158, s62, v158
    v_mul_f32 v159, s62, v159
    v_cvt_pk_bf16_f32 v151, v158, v159
    s_waitcnt vmcnt(9)
    s_branch L_mn_f
L_mn_b_e:
    s_waitcnt lgkmcnt(15)
    v_mfma_f32_32x32x16_bf16 v[112:127], v[180:183], v[176:179], 0
    v_subrev_u32 v40, 65536, v40
    ds_read_b128 v[216:219], v40 offset:0
    ds_read_b64_tr_b16 v[220:221], v43 offset:40960
    ds_read_b64_tr_b16 v[222:223], v43 offset:41984
    s_add_u32 s36, s51, 0
    buffer_store_dwordx4 v[48:51], v4, s[20:23], s36 offen sc1
    s_waitcnt lgkmcnt(15)
    v_mfma_f32_32x32x16_bf16 v[128:143], v[184:187], v[176:179], 0
    ds_read_b64_tr_b16 v[224:225], v44 offset:40960
    ds_read_b64_tr_b16 v[226:227], v44 offset:41984
    s_waitcnt lgkmcnt(15)
    v_mfma_f32_32x32x16_bf16 v[144:159], v[188:191], v[176:179], 0
    ds_read_b64_tr_b16 v[228:229], v45 offset:40960
    ds_read_b64_tr_b16 v[230:231], v45 offset:41984
    s_add_u32 s36, s51, 1024
    buffer_store_dwordx4 v[52:55], v4, s[20:23], s36 offen sc1
    s_waitcnt lgkmcnt(15)
    v_mfma_f32_32x32x16_bf16 v[160:175], v[192:195], v[176:179], 0
    ds_read_b64_tr_b16 v[232:233], v46 offset:40960
    ds_read_b64_tr_b16 v[234:235], v46 offset:41984
    s_waitcnt lgkmcnt(15)
    v_mfma_f32_32x32x16_bf16 v[112:127], v[200:203], v[196:199], v[112:127]
    v_subrev_u32 v41, 65536, v41
    ds_read_b128 v[176:179], v41 offset:0
    ds_read_b64_tr_b16 v[180:181], v43 offset:45056
    ds_read_b64_tr_b16 v[182:183], v43 offset:46080
    s_add_u32 s36, s52, 8192
    buffer_store_dwordx4 v[56:59], v4, s[20:23], s36 offen sc1
    v_mov_b32 v48, 0
    v_mov_b32 v49, 0
    s_waitcnt lgkmcnt(15)
    v_mfma_f32_32x32x16_bf16 v[128:143], v[204:207], v[196:199], v[128:143]
    ds_read_b64_tr_b16 v[184:185], v44 offset:45056
    ds_read_b64_tr_b16 v[186:187], v44 offset:46080
    v_mov_b32 v50, 0
    v_mov_b32 v51, 0
    s_waitcnt lgkmcnt(15)
    v_mfma_f32_32x32x16_bf16 v[144:159], v[208:211], v[196:199], v[144:159]
    ds_read_b64_tr_b16 v[188:189], v45 offset:45056
    ds_read_b64_tr_b16 v[190:191], v45 offset:46080
    s_add_u32 s36, s52, 12288
    buffer_store_dwordx4 v[60:63], v4, s[20:23], s36 offen sc1
    v_mov_b32 v52, 0
    v_mov_b32 v53, 0
    s_waitcnt lgkmcnt(15)
    v_mfma_f32_32x32x16_bf16 v[160:175], v[212:215], v[196:199], v[160:175]
    ds_read_b64_tr_b16 v[192:193], v46 offset:45056
    ds_read_b64_tr_b16 v[194:195], v46 offset:46080
    v_mov_b32 v54, 0
    v_mov_b32 v55, 0
    s_waitcnt vmcnt(12)
    s_waitcnt lgkmcnt(15)
    v_mfma_f32_32x32x16_bf16 v[112:127], v[220:223], v[216:219], v[112:127]
    ds_read_b128 v[196:199], v38 offset:32768
    ds_read_b64_tr_b16 v[200:201], v43 offset:49152
    ds_read_b64_tr_b16 v[202:203], v43 offset:50176
    s_add_u32 s36, s51, 24576
    buffer_store_dwordx4 v[64:67], v4, s[20:23], s36 offen sc1
    v_mov_b32 v56, 0
    v_mov_b32 v57, 0
    s_waitcnt lgkmcnt(15)
    v_mfma_f32_32x32x16_bf16 v[128:143], v[224:227], v[216:219], v[128:143]
    ds_read_b64_tr_b16 v[204:205], v44 offset:49152
    ds_read_b64_tr_b16 v[206:207], v44 offset:50176
    v_mov_b32 v58, 0
    v_mov_b32 v59, 0
    s_waitcnt lgkmcnt(15)
    v_mfma_f32_32x32x16_bf16 v[144:159], v[228:231], v[216:219], v[144:159]
    ds_read_b64_tr_b16 v[208:209], v45 offset:49152
    ds_read_b64_tr_b16 v[210:211], v45 offset:50176
    s_add_u32 s36, s51, 25600
    buffer_store_dwordx4 v[68:71], v4, s[20:23], s36 offen sc1
    v_mov_b32 v60, 0
    v_mov_b32 v61, 0
    s_waitcnt lgkmcnt(15)
    v_mfma_f32_32x32x16_bf16 v[160:175], v[232:235], v[216:219], v[160:175]
    ds_read_b64_tr_b16 v[212:213], v46 offset:49152
    ds_read_b64_tr_b16 v[214:215], v46 offset:50176
    v_mov_b32 v62, 0
    v_mov_b32 v63, 0
    s_waitcnt lgkmcnt(15)
    v_mfma_f32_32x32x16_bf16 v[112:127], v[180:183], v[176:179], v[112:127]
    ds_read_b128 v[216:219], v39 offset:32768
    ds_read_b64_tr_b16 v[220:221], v43 offset:53248
    ds_read_b64_tr_b16 v[222:223], v43 offset:54272
    s_add_u32 s36, s52, 16384
    buffer_store_dwordx4 v[72:75], v4, s[20:23], s36 offen sc1
    v_mov_b32 v64, 0
    v_mov_b32 v65, 0
    s_waitcnt lgkmcnt(15)
    v_mfma_f32_32x32x16_bf16 v[128:143], v[184:187], v[176:179], v[128:143]
    ds_read_b64_tr_b16 v[224:225], v44 offset:53248
    ds_read_b64_tr_b16 v[226:227], v44 offset:54272
    s_mov_b32 s39, 384
    s_add_u32 m0, s38, 65536
    s_nop 0
    buffer_load_dwordx4 v30, s[12:15], s39 offen offset:0 lds
    v_mov_b32 v66, 0
    v_mov_b32 v67, 0
    s_waitcnt lgkmcnt(15)
    v_mfma_f32_32x32x16_bf16 v[144:159], v[188:191], v[176:179], v[144:159]
    ds_read_b64_tr_b16 v[228:229], v45 offset:53248
    ds_read_b64_tr_b16 v[230:231], v45 offset:54272
    s_add_u32 s36, s52, 20480
    buffer_store_dwordx4 v[76:79], v4, s[20:23], s36 offen sc1
    v_mov_b32 v68, 0
    v_mov_b32 v69, 0
    s_waitcnt lgkmcnt(15)
    v_mfma_f32_32x32x16_bf16 v[160:175], v[192:195], v[176:179], v[160:175]
    ds_read_b64_tr_b16 v[232:233], v46 offset:53248
    ds_read_b64_tr_b16 v[234:235], v46 offset:54272
    buffer_load_dwordx4 v31, s[12:15], s39 offen offset:1024 lds
    v_mov_b32 v70, 0
    v_mov_b32 v71, 0
    s_waitcnt lgkmcnt(15)
    v_mfma_f32_32x32x16_bf16 v[112:127], v[200:203], v[196:199], v[112:127]
    ds_read_b128 v[176:179], v40 offset:32768
    ds_read_b64_tr_b16 v[180:181], v43 offset:57344
    ds_read_b64_tr_b16 v[182:183], v43 offset:58368
    s_add_u32 s36, s51, 32768
    buffer_store_dwordx4 v[80:83], v4, s[20:23], s36 offen sc1
    v_mov_b32 v72, 0
    v_mov_b32 v73, 0
    s_waitcnt lgkmcnt(15)
    v_mfma_f32_32x32x16_bf16 v[128:143], v[204:207], v[196:199], v[128:143]
    ds_read_b64_tr_b16 v[184:185], v44 offset:57344
    ds_read_b64_tr_b16 v[186:187], v44 offset:58368
    buffer_load_dwordx4 v32, s[12:15], s39 offen offset:2048 lds
    v_mov_b32 v74, 0
    v_mov_b32 v75, 0
    s_waitcnt lgkmcnt(15)
    v_mfma_f32_32x32x16_bf16 v[144:159], v[208:211], v[196:199], v[144:159]
    ds_read_b64_tr_b16 v[188:189], v45 offset:57344
    ds_read_b64_tr_b16 v[190:191], v45 offset:58368
    s_add_u32 s36, s51, 33792
    buffer_store_dwordx4 v[84:87], v4, s[20:23], s36 offen sc1
    v_mov_b32 v76, 0
    v_mov_b32 v77, 0
    s_waitcnt lgkmcnt(15)
    v_mfma_f32_32x32x16_bf16 v[160:175], v[212:215], v[196:199], v[160:175]
    ds_read_b64_tr_b16 v[192:193], v46 offset:57344
    ds_read_b64_tr_b16 v[194:195], v46 offset:58368
    buffer_load_dwordx4 v33, s[12:15], s39 offen offset:3072 lds
    v_mov_b32 v78, 0
    v_mov_b32 v79, 0
    s_waitcnt lgkmcnt(15)
    v_mfma_f32_32x32x16_bf16 v[112:127], v[220:223], v[216:219], v[112:127]
    ds_read_b128 v[196:199], v41 offset:32768
    ds_read_b64_tr_b16 v[200:201], v43 offset:61440
    ds_read_b64_tr_b16 v[202:203], v43 offset:62464
    ds_read_b64_tr_b16 v[204:205], v44 offset:61440
    ds_read_b64_tr_b16 v[206:207], v44 offset:62464
    s_add_u32 s36, s52, 40960
    buffer_store_dwordx4 v[88:91], v4, s[20:23], s36 offen sc1
    v_mov_b32 v80, 0
    v_mov_b32 v81, 0
    s_waitcnt lgkmcnt(15)
    v_mfma_f32_32x32x16_bf16 v[128:143], v[224:227], v[216:219], v[128:143]
    ds_read_b64_tr_b16 v[208:209], v45 offset:61440
    ds_read_b64_tr_b16 v[210:211], v45 offset:62464
    ds_read_b64_tr_b16 v[212:213], v46 offset:61440
    ds_read_b64_tr_b16 v[214:215], v46 offset:62464
    v_mov_b32 v82, 0
    v_mov_b32 v83, 0
    v_mfma_f32_32x32x16_bf16 v[144:159], v[228:231], v[216:219], v[144:159]
    s_add_u32 s36, s52, 45056
    buffer_store_dwordx4 v[92:95], v4, s[20:23], s36 offen sc1
    v_mov_b32 v84, 0
    v_mov_b32 v85, 0
    s_waitcnt lgkmcnt(15)
    v_mfma_f32_32x32x16_bf16 v[160:175], v[232:235], v[216:219], v[160:175]
    v_mov_b32 v86, 0
    v_mov_b32 v87, 0
    s_waitcnt vmcnt(16) lgkmcnt(0)
    s_barrier
    v_mfma_f32_32x32x16_bf16 v[112:127], v[180:183], v[176:179], v[112:127]
    v_add_u32 v38, 65536, v38
    ds_read_b128 v[216:219], v38 offset:0
    ds_read_b64_tr_b16 v[220:221], v43 offset:0
    ds_read_b64_tr_b16 v[222:223], v43 offset:1024
    s_add_u32 s36, s51, 57344
    buffer_store_dwordx4 v[96:99], v4, s[20:23], s36 offen sc1
    v_mov_b32 v88, 0
    v_mov_b32 v89, 0
    v_mfma_f32_32x32x16_bf16 v[128:143], v[184:187], v[176:179], v[128:143]
    ds_read_b64_tr_b16 v[224:225], v44 offset:0
    ds_read_b64_tr_b16 v[226:227], v44 offset:1024
    s_add_u32 s39, s41, 2097152
    s_add_u32 m0, s38, 32768
    s_nop 0
    buffer_load_dwordx4 v34, s[16:19], s39 offen offset:0 lds
    v_mov_b32 v90, 0
    v_mov_b32 v91, 0
    v_mfma_f32_32x32x16_bf16 v[144:159], v[188:191], v[176:179], v[144:159]
    ds_read_b64_tr_b16 v[228:229], v45 offset:0
    ds_read_b64_tr_b16 v[230:231], v45 offset:1024
    s_add_u32 s36, s51, 58368
    buffer_store_dwordx4 v[100:103], v4, s[20:23], s36 offen sc1
    v_mov_b32 v92, 0
    v_mov_b32 v93, 0
    v_mfma_f32_32x32x16_bf16 v[160:175], v[192:195], v[176:179], v[160:175]
    ds_read_b64_tr_b16 v[232:233], v46 offset:0
    ds_read_b64_tr_b16 v[234:235], v46 offset:1024
    buffer_load_dwordx4 v35, s[16:19], s39 offen offset:1024 lds
    v_mov_b32 v94, 0
    v_mov_b32 v95, 0
    v_mfma_f32_32x32x16_bf16 v[112:127], v[200:203], v[196:199], v[112:127]
    v_add_u32 v39, 65536, v39
    ds_read_b128 v[176:179], v39 offset:0
    ds_read_b64_tr_b16 v[180:181], v43 offset:4096
    ds_read_b64_tr_b16 v[182:183], v43 offset:5120
    s_add_u32 s36, s52, 49152
    buffer_store_dwordx4 v[104:107], v4, s[20:23], s36 offen sc1
    v_mov_b32 v96, 0
    v_mov_b32 v97, 0
    v_mfma_f32_32x32x16_bf16 v[128:143], v[204:207], v[196:199], v[128:143]
    ds_read_b64_tr_b16 v[184:185], v44 offset:4096
    ds_read_b64_tr_b16 v[186:187], v44 offset:5120
    buffer_load_dwordx4 v36, s[16:19], s39 offen offset:2048 lds
    v_mov_b32 v98, 0
    v_mov_b32 v99, 0
    v_mfma_f32_32x32x16_bf16 v[144:159], v[208:211], v[196:199], v[144:159]
    ds_read_b64_tr_b16 v[188:189], v45 offset:4096
    ds_read_b64_tr_b16 v[190:191], v45 offset:5120
    s_add_u32 s36, s52, 53248
    buffer_store_dwordx4 v[108:111], v4, s[20:23], s36 offen sc1
    v_mov_b32 v100, 0
    v_mov_b32 v101, 0
    v_mfma_f32_32x32x16_bf16 v[160:175], v[212:215], v[196:199], v[160:175]
    ds_read_b64_tr_b16 v[192:193], v46 offset:4096
    ds_read_b64_tr_b16 v[194:195], v46 offset:5120
    buffer_load_dwordx4 v37, s[16:19], s39 offen offset:3072 lds
    v_mov_b32 v102, 0
    v_mov_b32 v103, 0
    s_waitcnt lgkmcnt(15)
    v_mfma_f32_32x32x16_bf16 v[112:127], v[220:223], v[216:219], v[112:127]
    v_add_u32 v40, 65536, v40
    ds_read_b128 v[196:199], v40 offset:0
    ds_read_b64_tr_b16 v[200:201], v43 offset:8192
    ds_read_b64_tr_b16 v[202:203], v43 offset:9216
    v_mov_b32 v104, 0
    v_mov_b32 v105, 0
    s_waitcnt lgkmcnt(15)
    v_mfma_f32_32x32x16_bf16 v[128:143], v[224:227], v[216:219], v[128:143]
    ds_read_b64_tr_b16 v[204:205], v44 offset:8192
    ds_read_b64_tr_b16 v[206:207], v44 offset:9216
    s_mov_b32 s39, 512
    s_add_u32 m0, s38, 98304
    s_nop 0
    buffer_load_dwordx4 v30, s[12:15], s39 offen offset:0 lds
    v_mov_b32 v106, 0
    v_mov_b32 v107, 0
    s_waitcnt lgkmcnt(15)
    v_mfma_f32_32x32x16_bf16 v[144:159], v[228:231], v[216:219], v[144:159]
    ds_read_b64_tr_b16 v[208:209], v45 offset:8192
    ds_read_b64_tr_b16 v[210:211], v45 offset:9216
    v_mov_b32 v108, 0
    v_mov_b32 v109, 0
    s_waitcnt lgkmcnt(15)
    v_mfma_f32_32x32x16_bf16 v[160:175], v[232:235], v[216:219], v[160:175]
    ds_read_b64_tr_b16 v[212:213], v46 offset:8192
    ds_read_b64_tr_b16 v[214:215], v46 offset:9216
    buffer_load_dwordx4 v31, s[12:15], s39 offen offset:1024 lds
    v_mov_b32 v110, 0
    v_mov_b32 v111, 0
    s_waitcnt lgkmcnt(15)
    v_mfma_f32_32x32x16_bf16 v[112:127], v[180:183], v[176:179], v[112:127]
    v_add_u32 v41, 65536, v41
    ds_read_b128 v[216:219], v41 offset:0
    ds_read_b64_tr_b16 v[220:221], v43 offset:12288
    ds_read_b64_tr_b16 v[222:223], v43 offset:13312
    s_waitcnt lgkmcnt(15)
    v_mfma_f32_32x32x16_bf16 v[128:143], v[184:187], v[176:179], v[128:143]
    ds_read_b64_tr_b16 v[224:225], v44 offset:12288
    ds_read_b64_tr_b16 v[226:227], v44 offset:13312
    buffer_load_dwordx4 v32, s[12:15], s39 offen offset:2048 lds
    s_waitcnt lgkmcnt(15)
    v_mfma_f32_32x32x16_bf16 v[144:159], v[188:191], v[176:179], v[144:159]
    ds_read_b64_tr_b16 v[228:229], v45 offset:12288
    ds_read_b64_tr_b16 v[230:231], v45 offset:13312
    s_waitcnt lgkmcnt(15)
    v_mfma_f32_32x32x16_bf16 v[160:175], v[192:195], v[176:179], v[160:175]
    ds_read_b64_tr_b16 v[232:233], v46 offset:12288
    ds_read_b64_tr_b16 v[234:235], v46 offset:13312
    buffer_load_dwordx4 v33, s[12:15], s39 offen offset:3072 lds
    s_waitcnt vmcnt(14)
    s_waitcnt lgkmcnt(15)
    v_mfma_f32_32x32x16_bf16 v[112:127], v[200:203], v[196:199], v[112:127]
    v_subrev_u32 v38, 65536, v38
    ds_read_b128 v[176:179], v38 offset:0
    ds_read_b64_tr_b16 v[180:181], v43 offset:16384
    ds_read_b64_tr_b16 v[182:183], v43 offset:17408
    s_waitcnt lgkmcnt(15)
    v_mfma_f32_32x32x16_bf16 v[128:143], v[204:207], v[196:199], v[128:143]
    ds_read_b64_tr_b16 v[184:185], v44 offset:16384
    ds_read_b64_tr_b16 v[186:187], v44 offset:17408
    s_waitcnt lgkmcnt(15)
    v_mfma_f32_32x32x16_bf16 v[144:159], v[208:211], v[196:199], v[144:159]
    ds_read_b64_tr_b16 v[188:189], v45 offset:16384
    ds_read_b64_tr_b16 v[190:191], v45 offset:17408
    s_waitcnt lgkmcnt(15)
    v_mfma_f32_32x32x16_bf16 v[160:175], v[212:215], v[196:199], v[160:175]
    ds_read_b64_tr_b16 v[192:193], v46 offset:16384
    ds_read_b64_tr_b16 v[194:195], v46 offset:17408
    s_waitcnt lgkmcnt(15)
    v_mfma_f32_32x32x16_bf16 v[112:127], v[220:223], v[216:219], v[112:127]
    v_subrev_u32 v39, 65536, v39
    ds_read_b128 v[196:199], v39 offset:0
    ds_read_b64_tr_b16 v[200:201], v43 offset:20480
    ds_read_b64_tr_b16 v[202:203], v43 offset:21504
    s_waitcnt lgkmcnt(15)
    v_mfma_f32_32x32x16_bf16 v[128:143], v[224:227], v[216:219], v[128:143]
    ds_read_b64_tr_b16 v[204:205], v44 offset:20480
    ds_read_b64_tr_b16 v[206:207], v44 offset:21504
    s_mov_b32 s39, 640
    s_add_u32 m0, s38, 131072
    s_nop 0
    buffer_load_dwordx4 v30, s[12:15], s39 offen offset:0 lds
    s_waitcnt lgkmcnt(15)
    v_mfma_f32_32x32x16_bf16 v[144:159], v[228:231], v[216:219], v[144:159]
    ds_read_b64_tr_b16 v[208:209], v45 offset:20480
    ds_read_b64_tr_b16 v[210:211], v45 offset:21504
    s_waitcnt lgkmcnt(15)
    v_mfma_f32_32x32x16_bf16 v[160:175], v[232:235], v[216:219], v[160:175]
    ds_read_b64_tr_b16 v[212:213], v46 offset:20480
    ds_read_b64_tr_b16 v[214:215], v46 offset:21504
    buffer_load_dwordx4 v31, s[12:15], s39 offen offset:1024 lds
    s_waitcnt lgkmcnt(15)
    v_mfma_f32_32x32x16_bf16 v[112:127], v[180:183], v[176:179], v[112:127]
    v_subrev_u32 v40, 65536, v40
    ds_read_b128 v[216:219], v40 offset:0
    ds_read_b64_tr_b16 v[220:221], v43 offset:24576
    ds_read_b64_tr_b16 v[222:223], v43 offset:25600
    s_waitcnt lgkmcnt(15)
    v_mfma_f32_32x32x16_bf16 v[128:143], v[184:187], v[176:179], v[128:143]
    ds_read_b64_tr_b16 v[224:225], v44 offset:24576
    ds_read_b64_tr_b16 v[226:227], v44 offset:25600
    buffer_load_dwordx4 v32, s[12:15], s39 offen offset:2048 lds
    s_waitcnt lgkmcnt(15)
    v_mfma_f32_32x32x16_bf16 v[144:159], v[188:191], v[176:179], v[144:159]
    ds_read_b64_tr_b16 v[228:229], v45 offset:24576
    ds_read_b64_tr_b16 v[230:231], v45 offset:25600
    s_waitcnt lgkmcnt(15)
    v_mfma_f32_32x32x16_bf16 v[160:175], v[192:195], v[176:179], v[160:175]
    ds_read_b64_tr_b16 v[232:233], v46 offset:24576
    ds_read_b64_tr_b16 v[234:235], v46 offset:25600
    buffer_load_dwordx4 v33, s[12:15], s39 offen offset:3072 lds
    s_waitcnt lgkmcnt(15)
    v_mfma_f32_32x32x16_bf16 v[112:127], v[200:203], v[196:199], v[112:127]
    v_subrev_u32 v41, 65536, v41
    ds_read_b128 v[176:179], v41 offset:0
    ds_read_b64_tr_b16 v[180:181], v43 offset:28672
    ds_read_b64_tr_b16 v[182:183], v43 offset:29696
    ds_read_b64_tr_b16 v[184:185], v44 offset:28672
    ds_read_b64_tr_b16 v[186:187], v44 offset:29696
    s_waitcnt lgkmcnt(15)
    v_mfma_f32_32x32x16_bf16 v[128:143], v[204:207], v[196:199], v[128:143]
    ds_read_b64_tr_b16 v[188:189], v45 offset:28672
    ds_read_b64_tr_b16 v[190:191], v45 offset:29696
    ds_read_b64_tr_b16 v[192:193], v46 offset:28672
    ds_read_b64_tr_b16 v[194:195], v46 offset:29696
    v_mfma_f32_32x32x16_bf16 v[144:159], v[208:211], v[196:199], v[144:159]
    s_waitcnt lgkmcnt(15)
    v_mfma_f32_32x32x16_bf16 v[160:175], v[212:215], v[196:199], v[160:175]
    s_waitcnt vmcnt(4) lgkmcnt(0)
    s_barrier
    s_cmp_lg_u32 s32, 0
    s_cbranch_scc1 L_mn_nosig_e
    v_mov_b32 v8, 1
    s_mov_b64 exec, 1
    buffer_store_byte v8, v19, s[28:31], s34 offen sc1
    s_mov_b64 exec, -1
L_mn_nosig_e:
    v_mfma_f32_32x32x16_bf16 v[112:127], v[220:223], v[216:219], v[112:127]
    ds_read_b128 v[196:199], v38 offset:32768
    ds_read_b64_tr_b16 v[200:201], v43 offset:32768
    ds_read_b64_tr_b16 v[202:203], v43 offset:33792
    v_mfma_f32_32x32x16_bf16 v[128:143], v[224:227], v[216:219], v[128:143]
    ds_read_b64_tr_b16 v[204:205], v44 offset:32768
    ds_read_b64_tr_b16 v[206:207], v44 offset:33792
    s_add_u32 s39, s41, 3145728
    s_add_u32 m0, s38, 0
    s_nop 0
    buffer_load_dwordx4 v34, s[16:19], s39 offen offset:0 lds
    v_mfma_f32_32x32x16_bf16 v[144:159], v[228:231], v[216:219], v[144:159]
    ds_read_b64_tr_b16 v[208:209], v45 offset:32768
    ds_read_b64_tr_b16 v[210:211], v45 offset:33792
    v_mfma_f32_32x32x16_bf16 v[160:175], v[232:235], v[216:219], v[160:175]
    ds_read_b64_tr_b16 v[212:213], v46 offset:32768
    ds_read_b64_tr_b16 v[214:215], v46 offset:33792
    buffer_load_dwordx4 v35, s[16:19], s39 offen offset:1024 lds
    v_mfma_f32_32x32x16_bf16 v[112:127], v[180:183], v[176:179], v[112:127]
    ds_read_b128 v[216:219], v39 offset:32768
    ds_read_b64_tr_b16 v[220:221], v43 offset:36864
    ds_read_b64_tr_b16 v[222:223], v43 offset:37888
    v_mfma_f32_32x32x16_bf16 v[128:143], v[184:187], v[176:179], v[128:143]
    ds_read_b64_tr_b16 v[224:225], v44 offset:36864
    ds_read_b64_tr_b16 v[226:227], v44 offset:37888
    buffer_load_dwordx4 v36, s[16:19], s39 offen offset:2048 lds
    v_mfma_f32_32x32x16_bf16 v[144:159], v[188:191], v[176:179], v[144:159]
    ds_read_b64_tr_b16 v[228:229], v45 offset:36864
    ds_read_b64_tr_b16 v[230:231], v45 offset:37888
    v_mfma_f32_32x32x16_bf16 v[160:175], v[192:195], v[176:179], v[160:175]
    ds_read_b64_tr_b16 v[232:233], v46 offset:36864
    ds_read_b64_tr_b16 v[234:235], v46 offset:37888
    buffer_load_dwordx4 v37, s[16:19], s39 offen offset:3072 lds
    s_waitcnt lgkmcnt(15)
    v_mfma_f32_32x32x16_bf16 v[112:127], v[200:203], v[196:199], v[112:127]
    ds_read_b128 v[176:179], v40 offset:32768
    ds_read_b64_tr_b16 v[180:181], v43 offset:40960
    ds_read_b64_tr_b16 v[182:183], v43 offset:41984
    s_waitcnt lgkmcnt(15)
    v_mfma_f32_32x32x16_bf16 v[128:143], v[204:207], v[196:199], v[128:143]
    ds_read_b64_tr_b16 v[184:185], v44 offset:40960
    ds_read_b64_tr_b16 v[186:187], v44 offset:41984
    s_mov_b32 s39, 768
    s_add_u32 m0, s38, 65536
    s_nop 0
    buffer_load_dwordx4 v30, s[12:15], s39 offen offset:0 lds
    s_waitcnt lgkmcnt(15)
    v_mfma_f32_32x32x16_bf16 v[144:159], v[208:211], v[196:199], v[144:159]
    ds_read_b64_tr_b16 v[188:189], v45 offset:40960
    ds_read_b64_tr_b16 v[190:191], v45 offset:41984
    s_waitcnt lgkmcnt(15)
    v_mfma_f32_32x32x16_bf16 v[160:175], v[212:215], v[196:199], v[160:175]
    ds_read_b64_tr_b16 v[192:193], v46 offset:40960
    ds_read_b64_tr_b16 v[194:195], v46 offset:41984
    buffer_load_dwordx4 v31, s[12:15], s39 offen offset:1024 lds
    s_waitcnt lgkmcnt(15)
    v_mfma_f32_32x32x16_bf16 v[112:127], v[220:223], v[216:219], v[112:127]
    ds_read_b128 v[196:199], v41 offset:32768
    ds_read_b64_tr_b16 v[200:201], v43 offset:45056
    ds_read_b64_tr_b16 v[202:203], v43 offset:46080
    s_waitcnt lgkmcnt(15)
    v_mfma_f32_32x32x16_bf16 v[128:143], v[224:227], v[216:219], v[128:143]
    ds_read_b64_tr_b16 v[204:205], v44 offset:45056
    ds_read_b64_tr_b16 v[206:207], v44 offset:46080
    buffer_load_dwordx4 v32, s[12:15], s39 offen offset:2048 lds
    s_waitcnt lgkmcnt(15)
    v_mfma_f32_32x32x16_bf16 v[144:159], v[228:231], v[216:219], v[144:159]
    ds_read_b64_tr_b16 v[208:209], v45 offset:45056
    ds_read_b64_tr_b16 v[210:211], v45 offset:46080
    s_waitcnt lgkmcnt(15)
    v_mfma_f32_32x32x16_bf16 v[160:175], v[232:235], v[216:219], v[160:175]
    ds_read_b64_tr_b16 v[212:213], v46 offset:45056
    ds_read_b64_tr_b16 v[214:215], v46 offset:46080
    buffer_load_dwordx4 v33, s[12:15], s39 offen offset:3072 lds
    s_waitcnt vmcnt(8)
    s_waitcnt lgkmcnt(15)
    v_mfma_f32_32x32x16_bf16 v[112:127], v[180:183], v[176:179], v[112:127]
    v_add_u32 v38, 65536, v38
    ds_read_b128 v[216:219], v38 offset:0
    ds_read_b64_tr_b16 v[220:221], v43 offset:49152
    ds_read_b64_tr_b16 v[222:223], v43 offset:50176
    s_waitcnt lgkmcnt(15)
    v_mfma_f32_32x32x16_bf16 v[128:143], v[184:187], v[176:179], v[128:143]
    ds_read_b64_tr_b16 v[224:225], v44 offset:49152
    ds_read_b64_tr_b16 v[226:227], v44 offset:50176
    s_waitcnt lgkmcnt(15)
    v_mfma_f32_32x32x16_bf16 v[144:159], v[188:191], v[176:179], v[144:159]
    ds_read_b64_tr_b16 v[228:229], v45 offset:49152
    ds_read_b64_tr_b16 v[230:231], v45 offset:50176
    s_waitcnt lgkmcnt(15)
    v_mfma_f32_32x32x16_bf16 v[160:175], v[192:195], v[176:179], v[160:175]
    ds_read_b64_tr_b16 v[232:233], v46 offset:49152
    ds_read_b64_tr_b16 v[234:235], v46 offset:50176
    s_waitcnt lgkmcnt(15)
    v_mfma_f32_32x32x16_bf16 v[112:127], v[200:203], v[196:199], v[112:127]
    v_add_u32 v39, 65536, v39
    ds_read_b128 v[176:179], v39 offset:0
    ds_read_b64_tr_b16 v[180:181], v43 offset:53248
    ds_read_b64_tr_b16 v[182:183], v43 offset:54272
    s_waitcnt lgkmcnt(15)
    v_mfma_f32_32x32x16_bf16 v[128:143], v[204:207], v[196:199], v[128:143]
    ds_read_b64_tr_b16 v[184:185], v44 offset:53248
    ds_read_b64_tr_b16 v[186:187], v44 offset:54272
    s_mov_b32 s39, 896
    s_add_u32 m0, s38, 98304
    s_nop 0
    buffer_load_dwordx4 v30, s[12:15], s39 offen offset:0 lds
    s_waitcnt lgkmcnt(15)
    v_mfma_f32_32x32x16_bf16 v[144:159], v[208:211], v[196:199], v[144:159]
    ds_read_b64_tr_b16 v[188:189], v45 offset:53248
    ds_read_b64_tr_b16 v[190:191], v45 offset:54272
    s_waitcnt lgkmcnt(15)
    v_mfma_f32_32x32x16_bf16 v[160:175], v[212:215], v[196:199], v[160:175]
    ds_read_b64_tr_b16 v[192:193], v46 offset:53248
    ds_read_b64_tr_b16 v[194:195], v46 offset:54272
    buffer_load_dwordx4 v31, s[12:15], s39 offen offset:1024 lds
    s_waitcnt lgkmcnt(15)
    v_mfma_f32_32x32x16_bf16 v[112:127], v[220:223], v[216:219], v[112:127]
    v_add_u32 v40, 65536, v40
    ds_read_b128 v[196:199], v40 offset:0
    ds_read_b64_tr_b16 v[200:201], v43 offset:57344
    ds_read_b64_tr_b16 v[202:203], v43 offset:58368
    s_waitcnt lgkmcnt(15)
    v_mfma_f32_32x32x16_bf16 v[128:143], v[224:227], v[216:219], v[128:143]
    ds_read_b64_tr_b16 v[204:205], v44 offset:57344
    ds_read_b64_tr_b16 v[206:207], v44 offset:58368
    buffer_load_dwordx4 v32, s[12:15], s39 offen offset:2048 lds
    s_waitcnt lgkmcnt(15)
    v_mfma_f32_32x32x16_bf16 v[144:159], v[228:231], v[216:219], v[144:159]
    ds_read_b64_tr_b16 v[208:209], v45 offset:57344
    ds_read_b64_tr_b16 v[210:211], v45 offset:58368
    s_waitcnt lgkmcnt(15)
    v_mfma_f32_32x32x16_bf16 v[160:175], v[232:235], v[216:219], v[160:175]
    ds_read_b64_tr_b16 v[212:213], v46 offset:57344
    ds_read_b64_tr_b16 v[214:215], v46 offset:58368
    buffer_load_dwordx4 v33, s[12:15], s39 offen offset:3072 lds
    s_waitcnt lgkmcnt(15)
    v_mfma_f32_32x32x16_bf16 v[112:127], v[180:183], v[176:179], v[112:127]
    v_add_u32 v41, 65536, v41
    ds_read_b128 v[216:219], v41 offset:0
    ds_read_b64_tr_b16 v[220:221], v43 offset:61440
    ds_read_b64_tr_b16 v[222:223], v43 offset:62464
    ds_read_b64_tr_b16 v[224:225], v44 offset:61440
    ds_read_b64_tr_b16 v[226:227], v44 offset:62464
    s_waitcnt lgkmcnt(15)
    v_mfma_f32_32x32x16_bf16 v[128:143], v[184:187], v[176:179], v[128:143]
    ds_read_b64_tr_b16 v[228:229], v45 offset:61440
    ds_read_b64_tr_b16 v[230:231], v45 offset:62464
    ds_read_b64_tr_b16 v[232:233], v46 offset:61440
    ds_read_b64_tr_b16 v[234:235], v46 offset:62464
    v_mfma_f32_32x32x16_bf16 v[144:159], v[188:191], v[176:179], v[144:159]
    s_waitcnt lgkmcnt(15)
    v_mfma_f32_32x32x16_bf16 v[160:175], v[192:195], v[176:179], v[160:175]
    s_waitcnt vmcnt(4) lgkmcnt(0)
    s_barrier
    v_mfma_f32_32x32x16_bf16 v[112:127], v[200:203], v[196:199], v[112:127]
    v_subrev_u32 v38, 65536, v38
    ds_read_b128 v[176:179], v38 offset:0
    ds_read_b64_tr_b16 v[180:181], v43 offset:0
    ds_read_b64_tr_b16 v[182:183], v43 offset:1024
    v_mfma_f32_32x32x16_bf16 v[128:143], v[204:207], v[196:199], v[128:143]
    ds_read_b64_tr_b16 v[184:185], v44 offset:0
    ds_read_b64_tr_b16 v[186:187], v44 offset:1024
    s_add_u32 s39, s41, 4194304
    s_add_u32 m0, s38, 32768
    s_nop 0
    buffer_load_dwordx4 v34, s[16:19], s39 offen offset:0 lds
    v_mfma_f32_32x32x16_bf16 v[144:159], v[208:211], v[196:199], v[144:159]
    ds_read_b64_tr_b16 v[188:189], v45 offset:0
    ds_read_b64_tr_b16 v[190:191], v45 offset:1024
    v_mfma_f32_32x32x16_bf16 v[160:175], v[212:215], v[196:199], v[160:175]
    ds_read_b64_tr_b16 v[192:193], v46 offset:0
    ds_read_b64_tr_b16 v[194:195], v46 offset:1024
    buffer_load_dwordx4 v35, s[16:19], s39 offen offset:1024 lds
    v_mfma_f32_32x32x16_bf16 v[112:127], v[220:223], v[216:219], v[112:127]
    v_subrev_u32 v39, 65536, v39
    ds_read_b128 v[196:199], v39 offset:0
    ds_read_b64_tr_b16 v[200:201], v43 offset:4096
    ds_read_b64_tr_b16 v[202:203], v43 offset:5120
    v_mfma_f32_32x32x16_bf16 v[128:143], v[224:227], v[216:219], v[128:143]
    ds_read_b64_tr_b16 v[204:205], v44 offset:4096
    ds_read_b64_tr_b16 v[206:207], v44 offset:5120
    buffer_load_dwordx4 v36, s[16:19], s39 offen offset:2048 lds
    v_mfma_f32_32x32x16_bf16 v[144:159], v[228:231], v[216:219], v[144:159]
    ds_read_b64_tr_b16 v[208:209], v45 offset:4096
    ds_read_b64_tr_b16 v[210:211], v45 offset:5120
    v_mfma_f32_32x32x16_bf16 v[160:175], v[232:235], v[216:219], v[160:175]
    ds_read_b64_tr_b16 v[212:213], v46 offset:4096
    ds_read_b64_tr_b16 v[214:215], v46 offset:5120
    buffer_load_dwordx4 v37, s[16:19], s39 offen offset:3072 lds
    s_waitcnt lgkmcnt(15)
    v_mfma_f32_32x32x16_bf16 v[112:127], v[180:183], v[176:179], v[112:127]
    v_subrev_u32 v40, 65536, v40
    ds_read_b128 v[216:219], v40 offset:0
    ds_read_b64_tr_b16 v[220:221], v43 offset:8192
    ds_read_b64_tr_b16 v[222:223], v43 offset:9216
    s_waitcnt lgkmcnt(15)
    v_mfma_f32_32x32x16_bf16 v[128:143], v[184:187], v[176:179], v[128:143]
    ds_read_b64_tr_b16 v[224:225], v44 offset:8192
    ds_read_b64_tr_b16 v[226:227], v44 offset:9216
    s_mov_b32 s39, 1024
    s_add_u32 m0, s38, 131072
    s_nop 0
    buffer_load_dwordx4 v30, s[12:15], s39 offen offset:0 lds
    s_waitcnt lgkmcnt(15)
    v_mfma_f32_32x32x16_bf16 v[144:159], v[188:191], v[176:179], v[144:159]
    ds_read_b64_tr_b16 v[228:229], v45 offset:8192
    ds_read_b64_tr_b16 v[230:231], v45 offset:9216
    s_waitcnt lgkmcnt(15)
    v_mfma_f32_32x32x16_bf16 v[160:175], v[192:195], v[176:179], v[160:175]
    ds_read_b64_tr_b16 v[232:233], v46 offset:8192
    ds_read_b64_tr_b16 v[234:235], v46 offset:9216
    buffer_load_dwordx4 v31, s[12:15], s39 offen offset:1024 lds
    s_waitcnt lgkmcnt(15)
    v_mfma_f32_32x32x16_bf16 v[112:127], v[200:203], v[196:199], v[112:127]
    v_subrev_u32 v41, 65536, v41
    ds_read_b128 v[176:179], v41 offset:0
    ds_read_b64_tr_b16 v[180:181], v43 offset:12288
    ds_read_b64_tr_b16 v[182:183], v43 offset:13312
    s_waitcnt lgkmcnt(15)
    v_mfma_f32_32x32x16_bf16 v[128:143], v[204:207], v[196:199], v[128:143]
    ds_read_b64_tr_b16 v[184:185], v44 offset:12288
    ds_read_b64_tr_b16 v[186:187], v44 offset:13312
    buffer_load_dwordx4 v32, s[12:15], s39 offen offset:2048 lds
    s_waitcnt lgkmcnt(15)
    v_mfma_f32_32x32x16_bf16 v[144:159], v[208:211], v[196:199], v[144:159]
    ds_read_b64_tr_b16 v[188:189], v45 offset:12288
    ds_read_b64_tr_b16 v[190:191], v45 offset:13312
    s_waitcnt lgkmcnt(15)
    v_mfma_f32_32x32x16_bf16 v[160:175], v[212:215], v[196:199], v[160:175]
    ds_read_b64_tr_b16 v[192:193], v46 offset:12288
    ds_read_b64_tr_b16 v[194:195], v46 offset:13312
    buffer_load_dwordx4 v33, s[12:15], s39 offen offset:3072 lds
    s_waitcnt vmcnt(8)
    s_waitcnt lgkmcnt(15)
    v_mfma_f32_32x32x16_bf16 v[112:127], v[220:223], v[216:219], v[112:127]
    ds_read_b128 v[196:199], v38 offset:32768
    ds_read_b64_tr_b16 v[200:201], v43 offset:16384
    ds_read_b64_tr_b16 v[202:203], v43 offset:17408
    s_waitcnt lgkmcnt(15)
    v_mfma_f32_32x32x16_bf16 v[128:143], v[224:227], v[216:219], v[128:143]
    ds_read_b64_tr_b16 v[204:205], v44 offset:16384
    ds_read_b64_tr_b16 v[206:207], v44 offset:17408
    s_waitcnt lgkmcnt(15)
    v_mfma_f32_32x32x16_bf16 v[144:159], v[228:231], v[216:219], v[144:159]
    ds_read_b64_tr_b16 v[208:209], v45 offset:16384
    ds_read_b64_tr_b16 v[210:211], v45 offset:17408
    s_waitcnt lgkmcnt(15)
    v_mfma_f32_32x32x16_bf16 v[160:175], v[232:235], v[216:219], v[160:175]
    ds_read_b64_tr_b16 v[212:213], v46 offset:16384
    ds_read_b64_tr_b16 v[214:215], v46 offset:17408
    s_cmp_lg_u32 s32, 0
    s_cbranch_scc1 L_mn_nopoll_e
    buffer_load_dword v2, v19, s[28:31], 0 offen sc1
L_mn_nopoll_e:
    s_waitcnt lgkmcnt(15)
    v_mfma_f32_32x32x16_bf16 v[112:127], v[180:183], v[176:179], v[112:127]
    ds_read_b128 v[216:219], v39 offset:32768
    ds_read_b64_tr_b16 v[220:221], v43 offset:20480
    ds_read_b64_tr_b16 v[222:223], v43 offset:21504
    s_waitcnt lgkmcnt(15)
    v_mfma_f32_32x32x16_bf16 v[128:143], v[184:187], v[176:179], v[128:143]
    ds_read_b64_tr_b16 v[224:225], v44 offset:20480
    ds_read_b64_tr_b16 v[226:227], v44 offset:21504
    s_mov_b32 s39, 1152
    s_add_u32 m0, s38, 65536
    s_nop 0
    buffer_load_dwordx4 v30, s[12:15], s39 offen offset:0 lds
    s_waitcnt lgkmcnt(15)
    v_mfma_f32_32x32x16_bf16 v[144:159], v[188:191], v[176:179], v[144:159]
    ds_read_b64_tr_b16 v[228:229], v45 offset:20480
    ds_read_b64_tr_b16 v[230:231], v45 offset:21504
    s_waitcnt lgkmcnt(15)
    v_mfma_f32_32x32x16_bf16 v[160:175], v[192:195], v[176:179], v[160:175]
    ds_read_b64_tr_b16 v[232:233], v46 offset:20480
    ds_read_b64_tr_b16 v[234:235], v46 offset:21504
    buffer_load_dwordx4 v31, s[12:15], s39 offen offset:1024 lds
    s_waitcnt lgkmcnt(15)
    v_mfma_f32_32x32x16_bf16 v[112:127], v[200:203], v[196:199], v[112:127]
    ds_read_b128 v[176:179], v40 offset:32768
    ds_read_b64_tr_b16 v[180:181], v43 offset:24576
    ds_read_b64_tr_b16 v[182:183], v43 offset:25600
    s_waitcnt lgkmcnt(15)
    v_mfma_f32_32x32x16_bf16 v[128:143], v[204:207], v[196:199], v[128:143]
    ds_read_b64_tr_b16 v[184:185], v44 offset:24576
    ds_read_b64_tr_b16 v[186:187], v44 offset:25600
    buffer_load_dwordx4 v32, s[12:15], s39 offen offset:2048 lds
    s_waitcnt lgkmcnt(15)
    v_mfma_f32_32x32x16_bf16 v[144:159], v[208:211], v[196:199], v[144:159]
    ds_read_b64_tr_b16 v[188:189], v45 offset:24576
    ds_read_b64_tr_b16 v[190:191], v45 offset:25600
    s_waitcnt lgkmcnt(15)
    v_mfma_f32_32x32x16_bf16 v[160:175], v[212:215], v[196:199], v[160:175]
    ds_read_b64_tr_b16 v[192:193], v46 offset:24576
    ds_read_b64_tr_b16 v[194:195], v46 offset:25600
    buffer_load_dwordx4 v33, s[12:15], s39 offen offset:3072 lds
    s_waitcnt lgkmcnt(15)
    v_mfma_f32_32x32x16_bf16 v[112:127], v[220:223], v[216:219], v[112:127]
    ds_read_b128 v[196:199], v41 offset:32768
    ds_read_b64_tr_b16 v[200:201], v43 offset:28672
    ds_read_b64_tr_b16 v[202:203], v43 offset:29696
    ds_read_b64_tr_b16 v[204:205], v44 offset:28672
    ds_read_b64_tr_b16 v[206:207], v44 offset:29696
    s_waitcnt lgkmcnt(15)
    v_mfma_f32_32x32x16_bf16 v[128:143], v[224:227], v[216:219], v[128:143]
    ds_read_b64_tr_b16 v[208:209], v45 offset:28672
    ds_read_b64_tr_b16 v[210:211], v45 offset:29696
    ds_read_b64_tr_b16 v[212:213], v46 offset:28672
    ds_read_b64_tr_b16 v[214:215], v46 offset:29696
    v_mfma_f32_32x32x16_bf16 v[144:159], v[228:231], v[216:219], v[144:159]
    s_waitcnt lgkmcnt(15)
    v_mfma_f32_32x32x16_bf16 v[160:175], v[232:235], v[216:219], v[160:175]
    s_waitcnt vmcnt(4)
    s_cmp_lg_u32 s32, 0
    s_cbranch_scc1 L_mn_spun_e
    v_and_b32 v2, 0x0101, v2
    v_cmp_ne_u32 vcc, 0x0101, v2
    s_cbranch_vccnz L_mn_spin_e
L_mn_spun_e:
    s_waitcnt lgkmcnt(0)
    s_barrier
    v_mfma_f32_32x32x16_bf16 v[112:127], v[180:183], v[176:179], v[112:127]
    v_add_u32 v38, 65536, v38
    ds_read_b128 v[216:219], v38 offset:0
    ds_read_b64_tr_b16 v[220:221], v43 offset:32768
    ds_read_b64_tr_b16 v[222:223], v43 offset:33792
    v_mfma_f32_32x32x16_bf16 v[128:143], v[184:187], v[176:179], v[128:143]
    ds_read_b64_tr_b16 v[224:225], v44 offset:32768
    ds_read_b64_tr_b16 v[226:227], v44 offset:33792
    v_mfma_f32_32x32x16_bf16 v[144:159], v[188:191], v[176:179], v[144:159]
    ds_read_b64_tr_b16 v[228:229], v45 offset:32768
    ds_read_b64_tr_b16 v[230:231], v45 offset:33792
    v_mfma_f32_32x32x16_bf16 v[160:175], v[192:195], v[176:179], v[160:175]
    ds_read_b64_tr_b16 v[232:233], v46 offset:32768
    ds_read_b64_tr_b16 v[234:235], v46 offset:33792
    v_mov_b32 v11, 0
    v_mov_b32 v17, 2
    ds_write_b32 v14, v11 offset:0
    ds_write_b32 v14, v17 offset:2048
    v_mfma_f32_32x32x16_bf16 v[112:127], v[200:203], v[196:199], v[112:127]
    v_add_u32 v39, 65536, v39
    ds_read_b128 v[176:179], v39 offset:0
    ds_read_b64_tr_b16 v[180:181], v43 offset:36864
    ds_read_b64_tr_b16 v[182:183], v43 offset:37888
    v_mfma_f32_32x32x16_bf16 v[128:143], v[204:207], v[196:199], v[128:143]
    ds_read_b64_tr_b16 v[184:185], v44 offset:36864
    ds_read_b64_tr_b16 v[186:187], v44 offset:37888
    s_lshl_b32 s39, s32, 10
    s_add_u32 m0, s39, 4096
    s_nop 0
    buffer_load_dwordx4 v4, s[20:23], s39 offen sc1 lds
    v_mfma_f32_32x32x16_bf16 v[144:159], v[208:211], v[196:199], v[144:159]
    ds_read_b64_tr_b16 v[188:189], v45 offset:36864
    ds_read_b64_tr_b16 v[190:191], v45 offset:37888
    v_mfma_f32_32x32x16_bf16 v[160:175], v[212:215], v[196:199], v[160:175]
    ds_read_b64_tr_b16 v[192:193], v46 offset:36864
    ds_read_b64_tr_b16 v[194:195], v46 offset:37888
    s_cmp_ge_u32 s32, 5
    s_cbranch_scc1 L_mn_nowo_e
    s_add_u32 m0, s38, 12288
    s_nop 0
    buffer_load_dwordx4 v30, s[56:59], 0 offen offset:0 lds
    buffer_load_dwordx4 v31, s[56:59], 0 offen offset:1024 lds
    buffer_load_dwordx4 v32, s[56:59], 0 offen offset:2048 lds
    buffer_load_dwordx4 v33, s[56:59], 0 offen offset:3072 lds
L_mn_nowo_e:
    s_waitcnt lgkmcnt(15)
    v_mfma_f32_32x32x16_bf16 v[112:127], v[220:223], v[216:219], v[112:127]
    v_add_u32 v40, 65536, v40
    ds_read_b128 v[196:199], v40 offset:0
    ds_read_b64_tr_b16 v[200:201], v43 offset:40960
    ds_read_b64_tr_b16 v[202:203], v43 offset:41984
    v_mfma_f32_32x32x16_bf16 v[128:143], v[224:227], v[216:219], v[128:143]
    ds_read_b64_tr_b16 v[204:205], v44 offset:40960
    ds_read_b64_tr_b16 v[206:207], v44 offset:41984
    s_add_u32 s39, s38, 8192
    s_add_u32 m0, s38, 98304
    s_nop 0
    buffer_load_dwordx4 v4, s[20:23], s39 offen offset:0 sc1 lds
    s_waitcnt lgkmcnt(15)
    v_mfma_f32_32x32x16_bf16 v[144:159], v[228:231], v[216:219], v[144:159]
    ds_read_b64_tr_b16 v[208:209], v45 offset:40960
    ds_read_b64_tr_b16 v[210:211], v45 offset:41984
    v_mfma_f32_32x32x16_bf16 v[160:175], v[232:235], v[216:219], v[160:175]
    ds_read_b64_tr_b16 v[212:213], v46 offset:40960
    ds_read_b64_tr_b16 v[214:215], v46 offset:41984
    buffer_load_dwordx4 v4, s[20:23], s39 offen offset:1024 sc1 lds
    s_waitcnt lgkmcnt(15)
    v_mfma_f32_32x32x16_bf16 v[112:127], v[180:183], v[176:179], v[112:127]
    v_add_u32 v41, 65536, v41
    ds_read_b128 v[216:219], v41 offset:0
    ds_read_b64_tr_b16 v[220:221], v43 offset:45056
    ds_read_b64_tr_b16 v[222:223], v43 offset:46080
    s_waitcnt lgkmcnt(15)
    v_mfma_f32_32x32x16_bf16 v[128:143], v[184:187], v[176:179], v[128:143]
    ds_read_b64_tr_b16 v[224:225], v44 offset:45056
    ds_read_b64_tr_b16 v[226:227], v44 offset:46080
    buffer_load_dwordx4 v4, s[20:23], s39 offen offset:2048 sc1 lds
    s_waitcnt lgkmcnt(15)
    v_mfma_f32_32x32x16_bf16 v[144:159], v[188:191], v[176:179], v[144:159]
    ds_read_b64_tr_b16 v[228:229], v45 offset:45056
    ds_read_b64_tr_b16 v[230:231], v45 offset:46080
    s_waitcnt lgkmcnt(15)
    v_mfma_f32_32x32x16_bf16 v[160:175], v[192:195], v[176:179], v[160:175]
    ds_read_b64_tr_b16 v[232:233], v46 offset:45056
    ds_read_b64_tr_b16 v[234:235], v46 offset:46080
    buffer_load_dwordx4 v4, s[20:23], s39 offen offset:3072 sc1 lds
    s_waitcnt vmcnt(5)
    s_waitcnt lgkmcnt(15)
    v_mfma_f32_32x32x16_bf16 v[112:127], v[200:203], v[196:199], v[112:127]
    v_subrev_u32 v38, 65536, v38
    ds_read_b128 v[176:179], v38 offset:0
    ds_read_b64_tr_b16 v[180:181], v43 offset:49152
    ds_read_b64_tr_b16 v[182:183], v43 offset:50176
    s_waitcnt lgkmcnt(15)
    v_mfma_f32_32x32x16_bf16 v[128:143], v[204:207], v[196:199], v[128:143]
    ds_read_b64_tr_b16 v[184:185], v44 offset:49152
    ds_read_b64_tr_b16 v[186:187], v44 offset:50176
    s_waitcnt lgkmcnt(15)
    v_mfma_f32_32x32x16_bf16 v[144:159], v[208:211], v[196:199], v[144:159]
    ds_read_b64_tr_b16 v[188:189], v45 offset:49152
    ds_read_b64_tr_b16 v[190:191], v45 offset:50176
    s_waitcnt lgkmcnt(15)
    v_mfma_f32_32x32x16_bf16 v[160:175], v[212:215], v[196:199], v[160:175]
    ds_read_b64_tr_b16 v[192:193], v46 offset:49152
    ds_read_b64_tr_b16 v[194:195], v46 offset:50176
    s_waitcnt lgkmcnt(15)
    v_mfma_f32_32x32x16_bf16 v[112:127], v[220:223], v[216:219], v[112:127]
    v_subrev_u32 v39, 65536, v39
    ds_read_b128 v[196:199], v39 offset:0
    ds_read_b64_tr_b16 v[200:201], v43 offset:53248
    ds_read_b64_tr_b16 v[202:203], v43 offset:54272
    s_waitcnt lgkmcnt(15)
    v_mfma_f32_32x32x16_bf16 v[128:143], v[224:227], v[216:219], v[128:143]
    ds_read_b64_tr_b16 v[204:205], v44 offset:53248
    ds_read_b64_tr_b16 v[206:207], v44 offset:54272
    s_add_u32 s39, s38, 40960
    s_add_u32 m0, s38, 131072
    s_nop 0
    buffer_load_dwordx4 v4, s[20:23], s39 offen offset:0 sc1 lds
    s_waitcnt lgkmcnt(15)
    v_mfma_f32_32x32x16_bf16 v[144:159], v[228:231], v[216:219], v[144:159]
    ds_read_b64_tr_b16 v[208:209], v45 offset:53248
    ds_read_b64_tr_b16 v[210:211], v45 offset:54272
    s_waitcnt lgkmcnt(15)
    v_mfma_f32_32x32x16_bf16 v[160:175], v[232:235], v[216:219], v[160:175]
    ds_read_b64_tr_b16 v[212:213], v46 offset:53248
    ds_read_b64_tr_b16 v[214:215], v46 offset:54272
    buffer_load_dwordx4 v4, s[20:23], s39 offen offset:1024 sc1 lds
    s_waitcnt lgkmcnt(15)
    v_mfma_f32_32x32x16_bf16 v[112:127], v[180:183], v[176:179], v[112:127]
    v_subrev_u32 v40, 65536, v40
    ds_read_b128 v[216:219], v40 offset:0
    ds_read_b64_tr_b16 v[220:221], v43 offset:57344
    ds_read_b64_tr_b16 v[222:223], v43 offset:58368
    s_waitcnt lgkmcnt(15)
    v_mfma_f32_32x32x16_bf16 v[128:143], v[184:187], v[176:179], v[128:143]
    ds_read_b64_tr_b16 v[224:225], v44 offset:57344
    ds_read_b64_tr_b16 v[226:227], v44 offset:58368
    buffer_load_dwordx4 v4, s[20:23], s39 offen offset:2048 sc1 lds
    s_waitcnt lgkmcnt(15)
    v_mfma_f32_32x32x16_bf16 v[144:159], v[188:191], v[176:179], v[144:159]
    ds_read_b64_tr_b16 v[228:229], v45 offset:57344
    ds_read_b64_tr_b16 v[230:231], v45 offset:58368
    s_waitcnt lgkmcnt(15)
    v_mfma_f32_32x32x16_bf16 v[160:175], v[192:195], v[176:179], v[160:175]
    ds_read_b64_tr_b16 v[232:233], v46 offset:57344
    ds_read_b64_tr_b16 v[234:235], v46 offset:58368
    buffer_load_dwordx4 v4, s[20:23], s39 offen offset:3072 sc1 lds
    s_waitcnt vmcnt(8)
    v_xor_b32 v8, 0, v21
    v_xor_b32 v9, 64, v21
    ds_read_b64_tr_b16 v[236:237], v8
    ds_read_b64_tr_b16 v[238:239], v9 offset:1024
    v_xor_b32 v8, 32, v21
    v_xor_b32 v9, 96, v21
    ds_read_b64_tr_b16 v[240:241], v8
    ds_read_b64_tr_b16 v[242:243], v9 offset:1024
    v_xor_b32 v8, 64, v21
    v_xor_b32 v9, 0, v21
    ds_read_b64_tr_b16 v[244:245], v8
    ds_read_b64_tr_b16 v[246:247], v9 offset:1024
    v_xor_b32 v8, 96, v21
    v_xor_b32 v9, 32, v21
    ds_read_b64_tr_b16 v[248:249], v8
    ds_read_b64_tr_b16 v[250:251], v9 offset:1024
    v_subrev_u32 v41, 65536, v41
    ds_read_b128 v[176:179], v41 offset:0
    ds_read_b64_tr_b16 v[180:181], v43 offset:61440
    ds_read_b64_tr_b16 v[182:183], v43 offset:62464
    ds_read_b64_tr_b16 v[184:185], v44 offset:61440
    ds_read_b64_tr_b16 v[186:187], v44 offset:62464
    ds_read_b64_tr_b16 v[188:189], v45 offset:61440
    ds_read_b64_tr_b16 v[190:191], v45 offset:62464
    ds_read_b64_tr_b16 v[192:193], v46 offset:61440
    ds_read_b64_tr_b16 v[194:195], v46 offset:62464
    s_waitcnt lgkmcnt(15)
    v_mfma_f32_32x32x16_bf16 v[112:127], v[200:203], v[196:199], v[112:127]
    s_add_u32 s36, s61, 0
    s_mul_i32 s37, s36, 52
    s_lshr_b32 s37, s37, 8
    s_mul_i32 s37, s37, 635
    s_add_u32 s36, s36, s37
    s_lshl_b32 s36, s36, 10
    s_add_u32 s36, s36, s60
    s_waitcnt lgkmcnt(9)
    buffer_store_dwordx4 v[236:239], v4, s[24:27], s36 offen sc1
    v_mfma_f32_32x32x16_bf16 v[112:127], v[220:223], v[216:219], v[112:127]
    s_add_u32 s36, s61, 1
    s_mul_i32 s37, s36, 52
    s_lshr_b32 s37, s37, 8
    s_mul_i32 s37, s37, 635
    s_add_u32 s36, s36, s37
    s_lshl_b32 s36, s36, 10
    s_add_u32 s36, s36, s60
    buffer_store_dwordx4 v[240:243], v4, s[24:27], s36 offen sc1
    s_waitcnt lgkmcnt(6)
    v_mfma_f32_32x32x16_bf16 v[112:127], v[180:183], v[176:179], v[112:127]
    s_add_u32 s36, s61, 2
    s_mul_i32 s37, s36, 52
    s_lshr_b32 s37, s37, 8
    s_mul_i32 s37, s37, 635
    s_add_u32 s36, s36, s37
    s_lshl_b32 s36, s36, 10
    s_add_u32 s36, s36, s60
    buffer_store_dwordx4 v[244:247], v4, s[24:27], s36 offen sc1
    v_mfma_f32_32x32x16_bf16 v[128:143], v[204:207], v[196:199], v[128:143]
    s_add_u32 s36, s61, 3
    s_mul_i32 s37, s36, 52
    s_lshr_b32 s37, s37, 8
    s_mul_i32 s37, s37, 635
    s_add_u32 s36, s36, s37
    s_lshl_b32 s36, s36, 10
    s_add_u32 s36, s36, s60
    buffer_store_dwordx4 v[248:251], v4, s[24:27], s36 offen sc1
    s_add_u32 s24, s24, 4273995776
    s_addc_u32 s25, s25, -1
    s_mov_b32 s26, 16777216
    v_mfma_f32_32x32x16_bf16 v[128:143], v[224:227], v[216:219], v[128:143]
    s_waitcnt lgkmcnt(4)
    v_mfma_f32_32x32x16_bf16 v[128:143], v[184:187], v[176:179], v[128:143]
    v_mul_f32 v112, s62, v112
    v_mul_f32 v113, s62, v113
    v_cvt_pk_bf16_f32 v112, v112, v113
    v_mul_f32 v114, s62, v114
    v_mul_f32 v115, s62, v115
    v_cvt_pk_bf16_f32 v113, v114, v115
    v_mul_f32 v116, s62, v116
    v_mul_f32 v117, s62, v117
    v_cvt_pk_bf16_f32 v114, v116, v117
    v_mul_f32 v118, s62, v118
    v_mul_f32 v119, s62, v119
    v_cvt_pk_bf16_f32 v115, v118, v119
    v_mfma_f32_32x32x16_bf16 v[144:159], v[208:211], v[196:199], v[144:159]
    v_mul_f32 v120, s62, v120
    v_mul_f32 v121, s62, v121
    v_cvt_pk_bf16_f32 v116, v120, v121
    v_mul_f32 v122, s62, v122
    v_mul_f32 v123, s62, v123
    v_cvt_pk_bf16_f32 v117, v122, v123
    v_mul_f32 v124, s62, v124
    v_mul_f32 v125, s62, v125
    v_cvt_pk_bf16_f32 v118, v124, v125
    v_mul_f32 v126, s62, v126
    v_mul_f32 v127, s62, v127
    v_cvt_pk_bf16_f32 v119, v126, v127
    v_mfma_f32_32x32x16_bf16 v[144:159], v[228:231], v[216:219], v[144:159]
    s_waitcnt lgkmcnt(2)
    v_mfma_f32_32x32x16_bf16 v[144:159], v[188:191], v[176:179], v[144:159]
    v_mul_f32 v128, s62, v128
    v_mul_f32 v129, s62, v129
    v_cvt_pk_bf16_f32 v128, v128, v129
    v_mul_f32 v130, s62, v130
    v_mul_f32 v131, s62, v131
    v_cvt_pk_bf16_f32 v129, v130, v131
    v_mul_f32 v132, s62, v132
    v_mul_f32 v133, s62, v133
    v_cvt_pk_bf16_f32 v130, v132, v133
    v_mul_f32 v134, s62, v134
    v_mul_f32 v135, s62, v135
    v_cvt_pk_bf16_f32 v131, v134, v135
    v_mfma_f32_32x32x16_bf16 v[160:175], v[212:215], v[196:199], v[160:175]
    v_mul_f32 v136, s62, v136
    v_mul_f32 v137, s62, v137
    v_cvt_pk_bf16_f32 v132, v136, v137
    v_mul_f32 v138, s62, v138
    v_mul_f32 v139, s62, v139
    v_cvt_pk_bf16_f32 v133, v138, v139
    v_mul_f32 v140, s62, v140
    v_mul_f32 v141, s62, v141
    v_cvt_pk_bf16_f32 v134, v140, v141
    v_mul_f32 v142, s62, v142
    v_mul_f32 v143, s62, v143
    v_cvt_pk_bf16_f32 v135, v142, v143
    v_mfma_f32_32x32x16_bf16 v[160:175], v[232:235], v[216:219], v[160:175]
    s_waitcnt lgkmcnt(0)
    v_mfma_f32_32x32x16_bf16 v[160:175], v[192:195], v[176:179], v[160:175]
    v_mul_f32 v144, s62, v144
    v_mul_f32 v145, s62, v145
    v_cvt_pk_bf16_f32 v144, v144, v145
    v_mul_f32 v146, s62, v146
    v_mul_f32 v147, s62, v147
    v_cvt_pk_bf16_f32 v145, v146, v147
    v_mul_f32 v148, s62, v148
    v_mul_f32 v149, s62, v149
    v_cvt_pk_bf16_f32 v146, v148, v149
    v_mul_f32 v150, s62, v150
    v_mul_f32 v151, s62, v151
    v_cvt_pk_bf16_f32 v147, v150, v151
    v_mul_f32 v152, s62, v152
    v_mul_f32 v153, s62, v153
    v_cvt_pk_bf16_f32 v148, v152, v153
    v_mul_f32 v154, s62, v154
    v_mul_f32 v155, s62, v155
    v_cvt_pk_bf16_f32 v149, v154, v155
    v_mul_f32 v156, s62, v156
    v_mul_f32 v157, s62, v157
    v_cvt_pk_bf16_f32 v150, v156, v157
    v_mul_f32 v158, s62, v158
    v_mul_f32 v159, s62, v159
    v_cvt_pk_bf16_f32 v151, v158, v159
    s_waitcnt vmcnt(8)
L_mn_f:
    s_barrier
    s_and_b32 s36, s32, 3
    s_lshl_b32 s42, s36, 13
    s_add_u32 s43, s42, 73728
    s_lshl_b32 s46, s34, 1
    s_sub_u32 s46, 32, s46
    s_lshl_b32 s36, s34, 16
    s_sub_u32 s22, 1048576, s36
    s_mov_b32 s49, -1
    s_mov_b32 s39, 3
    s_cmp_lt_u32 s32, 4
    s_cbranch_scc1 L_mn_nos2
    s_add_u32 m0, s42, 32768
    s_add_u32 s50, s43, 0
    buffer_load_dwordx4 v4, s[20:23], s50 offen offset:0 sc1 lds
    buffer_load_dwordx4 v4, s[20:23], s50 offen offset:1024 sc1 lds
    buffer_load_dwordx4 v4, s[20:23], s50 offen offset:2048 sc1 lds
    buffer_load_dwordx4 v4, s[20:23], s50 offen offset:3072 sc1 lds
    s_add_u32 m0, s42, 36864
    s_add_u32 s50, s43, 4096
    buffer_load_dwordx4 v4, s[20:23], s50 offen offset:0 sc1 lds
    buffer_load_dwordx4 v4, s[20:23], s50 offen offset:1024 sc1 lds
    buffer_load_dwordx4 v4, s[20:23], s50 offen offset:2048 sc1 lds
    buffer_load_dwordx4 v4, s[20:23], s50 offen offset:3072 sc1 lds
    s_add_u32 s43, s43, 32768
    s_add_u32 s42, s42, 32768
    s_and_b32 s42, s42, 0x1ffff
    s_add_u32 s49, s49, 1
    s_sub_u32 s46, s46, 1
L_mn_nos2:
    v_mul_f32 v160, s62, v160
    v_mul_f32 v161, s62, v161
    v_cvt_pk_bf16_f32 v160, v160, v161
    v_mul_f32 v162, s62, v162
    v_mul_f32 v163, s62, v163
    v_cvt_pk_bf16_f32 v161, v162, v163
    v_mul_f32 v164, s62, v164
    v_mul_f32 v165, s62, v165
    v_cvt_pk_bf16_f32 v162, v164, v165
    v_mul_f32 v166, s62, v166
    v_mul_f32 v167, s62, v167
    v_cvt_pk_bf16_f32 v163, v166, v167
    v_mul_f32 v168, s62, v168
    v_mul_f32 v169, s62, v169
    v_cvt_pk_bf16_f32 v164, v168, v169
    v_mul_f32 v170, s62, v170
    v_mul_f32 v171, s62, v171
    v_cvt_pk_bf16_f32 v165, v170, v171
    v_mul_f32 v172, s62, v172
    v_mul_f32 v173, s62, v173
    v_cvt_pk_bf16_f32 v166, v172, v173
    v_mul_f32 v174, s62, v174
    v_mul_f32 v175, s62, v175
    v_cvt_pk_bf16_f32 v167, v174, v175
    ds_read_b128 v[152:155], v4 offset:4096
    ds_read_b128 v[156:159], v4 offset:5120
    ds_read_b128 v[168:171], v4 offset:6144
    ds_read_b128 v[172:175], v4 offset:7168
    ds_read_b128 v[120:123], v4 offset:8192
    ds_read_b128 v[124:127], v4 offset:9216
    ds_read_b128 v[136:139], v4 offset:10240
    ds_read_b128 v[140:143], v4 offset:11264
    v_mov_b32 v208, 0
    v_mov_b32 v209, 0
    v_mov_b32 v210, 0
    v_mov_b32 v211, 0
    v_mov_b32 v212, 0
    v_mov_b32 v213, 0
    v_mov_b32 v214, 0
    v_mov_b32 v215, 0
    v_mov_b32 v216, 0
    v_mov_b32 v217, 0
    v_mov_b32 v218, 0
    v_mov_b32 v219, 0
    v_mov_b32 v220, 0
    v_mov_b32 v221, 0
    v_mov_b32 v222, 0
    v_mov_b32 v223, 0
    v_mov_b32 v2, 0
    v_mov_b32 v3, 0
    s_sub_u32 s44, s35, 1
    s_mov_b32 s45, 0
    s_cmp_ge_u32 s32, 4
    s_cbranch_scc1 L_mn_notch
    s_mul_i32 s36, s34, 3
    s_sub_u32 s36, s36, 5
    s_max_i32 s36, s36, 2
    s_sub_u32 s46, s44, s36
    s_sub_u32 s46, s46, 1
    s_mov_b32 s44, s36
    s_mov_b32 s45, -1
L_mn_notch:
    s_cmp_lg_u32 s35, 0
    s_cbranch_scc1 L_mn_nomask0
    v_min_f32 v208, v6, v208
    v_add_f32 v9, 0xf1800000, v6
    v_min_f32 v209, v9, v209
    v_add_f32 v8, 0xf2000000, v6
    v_min_f32 v210, v8, v210
    v_add_f32 v9, 0xf2400000, v6
    v_min_f32 v211, v9, v211
    v_add_f32 v8, 0xf3000000, v6
    v_min_f32 v212, v8, v212
    v_add_f32 v9, 0xf3100000, v6
    v_min_f32 v213, v9, v213
    v_add_f32 v8, 0xf3200000, v6
    v_min_f32 v214, v8, v214
    v_add_f32 v9, 0xf3300000, v6
    v_min_f32 v215, v9, v215
    v_add_f32 v8, 0xf3800000, v6
    v_min_f32 v216, v8, v216
    v_add_f32 v9, 0xf3880000, v6
    v_min_f32 v217, v9, v217
    v_add_f32 v8, 0xf3900000, v6
    v_min_f32 v218, v8, v218
    v_add_f32 v9, 0xf3980000, v6
    v_min_f32 v219, v9, v219
    v_add_f32 v8, 0xf3c00000, v6
    v_min_f32 v220, v8, v220
    v_add_f32 v9, 0xf3c80000, v6
    v_min_f32 v221, v9, v221
    v_add_f32 v8, 0xf3d00000, v6
    v_min_f32 v222, v8, v222
    v_add_f32 v9, 0xf3d80000, v6
    v_min_f32 v223, v9, v223
    s_mov_b32 s44, 1
    s_mov_b32 s45, 1
L_mn_nomask0:
    v_add_u32 v5, 65536, v4
    s_nop 0
    s_waitcnt lgkmcnt(7)
    v_mfma_f32_32x32x16_bf16 v[176:191], v[152:155], v[112:115], v[208:223]
    s_waitcnt lgkmcnt(6)
    v_mfma_f32_32x32x16_bf16 v[176:191], v[156:159], v[116:119], v[176:191]
    s_waitcnt lgkmcnt(5)
    v_mfma_f32_32x32x16_bf16 v[176:191], v[168:171], v[128:131], v[176:191]
    s_waitcnt lgkmcnt(4)
    v_mfma_f32_32x32x16_bf16 v[176:191], v[172:175], v[132:135], v[176:191]
    s_waitcnt lgkmcnt(3)
    v_mfma_f32_32x32x16_bf16 v[176:191], v[120:123], v[144:147], v[176:191]
    s_waitcnt lgkmcnt(2)
    v_mfma_f32_32x32x16_bf16 v[176:191], v[124:127], v[148:151], v[176:191]
    s_waitcnt lgkmcnt(1)
    v_mfma_f32_32x32x16_bf16 v[176:191], v[136:139], v[160:163], v[176:191]
    s_waitcnt lgkmcnt(0)
    v_mfma_f32_32x32x16_bf16 v[176:191], v[140:143], v[164:167], v[176:191]
    ds_read_b128 v[120:123], v5 offset:49152
    ds_read_b128 v[124:127], v5 offset:50176
    ds_read_b128 v[136:139], v5 offset:51200
    ds_read_b128 v[140:143], v5 offset:52224
    ds_read_b128 v[152:155], v5 offset:53248
    ds_read_b128 v[156:159], v5 offset:54272
    ds_read_b128 v[168:171], v5 offset:55296
    v_subrev_u32 v16, 1024, v14
    s_nop 4
    v_max3_f32 v7, v176, v177, v178
    v_max3_f32 v7, v179, v180, v7
    v_max3_f32 v7, v181, v182, v7
    v_max3_f32 v7, v183, v184, v7
    v_max3_f32 v7, v185, v186, v7
    v_max3_f32 v7, v187, v188, v7
    v_max3_f32 v7, v189, v190, v7
    v_max_f32 v7, v191, v7
    v_mov_b32 v8, v7
    s_nop 1
    v_permlane32_swap_b32 v8, v7
    s_nop 1
    v_max_f32 v7, v8, v7
    v_sub_f32 v176, v176, v7
    v_sub_f32 v208, v208, v7
    v_sub_f32 v177, v177, v7
    v_sub_f32 v209, v209, v7
    v_sub_f32 v178, v178, v7
    v_sub_f32 v210, v210, v7
    v_sub_f32 v179, v179, v7
    v_sub_f32 v211, v211, v7
    v_sub_f32 v180, v180, v7
    v_sub_f32 v212, v212, v7
    v_sub_f32 v181, v181, v7
    v_sub_f32 v213, v213, v7
    v_sub_f32 v182, v182, v7
    v_sub_f32 v214, v214, v7
    v_sub_f32 v183, v183, v7
    v_sub_f32 v215, v215, v7
    v_sub_f32 v184, v184, v7
    v_sub_f32 v216, v216, v7
    v_sub_f32 v185, v185, v7
    v_sub_f32 v217, v217, v7
    v_sub_f32 v186, v186, v7
    v_sub_f32 v218, v218, v7
    v_sub_f32 v187, v187, v7
    v_sub_f32 v219, v219, v7
    v_sub_f32 v188, v188, v7
    v_sub_f32 v220, v220, v7
    v_sub_f32 v189, v189, v7
    v_sub_f32 v221, v221, v7
    v_sub_f32 v190, v190, v7
    v_sub_f32 v222, v222, v7
    v_sub_f32 v191, v191, v7
    v_sub_f32 v223, v223, v7
    s_mov_b64 vcc, 0
    s_cmp_lt_u32 s32, 4
    s_cbranch_scc0 L_mn_g_s
    s_waitcnt vmcnt(0)
L_mn_g_s:
    s_waitcnt vmcnt(8) lgkmcnt(0)
    s_barrier
    s_cmp_lg_u32 s32, 0
    s_cbranch_scc1 L_mn_nosig_l
    v_mov_b32 v8, 5
    s_mov_b64 exec, 1
    buffer_store_byte v8, v19, s[28:31], s34 offen sc1
    s_mov_b64 exec, -1
L_mn_nosig_l:
    s_setprio 1
    s_cmp_lt_u32 s32, 4
    s_cbranch_scc0 L_mn_loop_s0
    s_setprio 0
    .p2align 6
L_mn_loop_l0:
    s_sub_u32 s44, s44, 1
    s_cbranch_scc1 L_mn_spec_l0
L_mn_back1_l0:
    s_cbranch_vccnz L_mn_resc_l0
L_mn_back2_l0:
    v_mfma_f32_32x32x16_bf16 v[192:207], v[120:123], v[112:115], v[208:223]
    ds_read_b128 v[172:175], v5 offset:56320
    v_exp_f32 v176, v176
    v_exp_f32 v177, v177
    v_add_f32 v2, v176, v2
    v_mfma_f32_32x32x16_bf16 v[192:207], v[124:127], v[116:119], v[192:207]
    ds_read_b128 v[120:123], v5 offset:32768
    v_exp_f32 v178, v178
    v_add_f32 v3, v177, v3
    v_cvt_pk_bf16_f32 v176, v176, v177
    s_waitcnt lgkmcnt(5)
    v_mfma_f32_32x32x16_bf16 v[192:207], v[136:139], v[128:131], v[192:207]
    ds_read_b128 v[124:127], v5 offset:33792
    v_exp_f32 v179, v179
    v_exp_f32 v180, v180
    v_add_f32 v2, v178, v2
    v_mfma_f32_32x32x16_bf16 v[192:207], v[140:143], v[132:135], v[192:207]
    ds_read_b128 v[136:139], v5 offset:34816
    v_exp_f32 v181, v181
    v_add_f32 v3, v179, v3
    v_cvt_pk_bf16_f32 v177, v178, v179
    s_waitcnt lgkmcnt(5)
    v_mfma_f32_32x32x16_bf16 v[192:207], v[152:155], v[144:147], v[192:207]
    ds_read_b128 v[140:143], v5 offset:35840
    v_exp_f32 v182, v182
    v_exp_f32 v183, v183
    v_cvt_pk_bf16_f32 v178, v180, v181
    v_mfma_f32_32x32x16_bf16 v[192:207], v[156:159], v[148:151], v[192:207]
    ds_read_b128 v[152:155], v5 offset:36864
    v_exp_f32 v184, v184
    v_cvt_pk_bf16_f32 v179, v182, v183
    v_add_f32 v2, v180, v2
    s_waitcnt lgkmcnt(5)
    v_mfma_f32_32x32x16_bf16 v[192:207], v[168:171], v[160:163], v[192:207]
    ds_read_b128 v[156:159], v5 offset:37888
    v_exp_f32 v185, v185
    v_exp_f32 v186, v186
    v_add_f32 v2, v184, v2
    v_mfma_f32_32x32x16_bf16 v[192:207], v[172:175], v[164:167], v[192:207]
    ds_read_b128 v[168:171], v5 offset:38912
    v_exp_f32 v187, v187
    v_add_f32 v3, v185, v3
    v_cvt_pk_bf16_f32 v184, v184, v185
    s_waitcnt lgkmcnt(5)
    v_mfma_f32_32x32x16_bf16 v[48:63], v[120:123], v[176:179], v[48:63]
    ds_read_b128 v[172:175], v5 offset:39936
    v_exp_f32 v188, v188
    v_exp_f32 v189, v189
    v_add_f32 v2, v186, v2
    v_mfma_f32_32x32x16_bf16 v[64:79], v[124:127], v[176:179], v[64:79]
    ds_read_b128 v[120:123], v5 offset:57344
    v_exp_f32 v190, v190
    v_add_f32 v3, v187, v3
    v_cvt_pk_bf16_f32 v185, v186, v187
    s_waitcnt lgkmcnt(5)
    v_mfma_f32_32x32x16_bf16 v[80:95], v[136:139], v[176:179], v[80:95]
    ds_read_b128 v[124:127], v5 offset:58368
    v_exp_f32 v191, v191
    v_cvt_pk_bf16_f32 v186, v188, v189
    v_add_f32 v3, v181, v3
    v_cvt_pk_bf16_f32 v187, v190, v191
    v_mfma_f32_32x32x16_bf16 v[96:111], v[140:143], v[176:179], v[96:111]
    ds_read_b128 v[136:139], v5 offset:59392
    v_add_f32 v2, v182, v2
    v_add_f32 v3, v183, v3
    v_add_f32 v2, v188, v2
    v_add_f32 v3, v189, v3
    s_waitcnt lgkmcnt(5)
    v_mfma_f32_32x32x16_bf16 v[48:63], v[152:155], v[184:187], v[48:63]
    ds_read_b128 v[140:143], v5 offset:60416
    v_max3_f32 v7, v192, v193, v194
    v_max3_f32 v7, v195, v196, v7
    v_max3_f32 v7, v197, v198, v7
    v_max3_f32 v7, v199, v200, v7
    v_add_f32 v2, v190, v2
    v_mfma_f32_32x32x16_bf16 v[64:79], v[156:159], v[184:187], v[64:79]
    ds_read_b128 v[152:155], v5 offset:61440
    v_max3_f32 v7, v201, v202, v7
    v_max3_f32 v7, v203, v204, v7
    v_max3_f32 v7, v205, v206, v7
    v_max_f32 v7, v207, v7
    s_waitcnt lgkmcnt(5)
    v_mfma_f32_32x32x16_bf16 v[80:95], v[168:171], v[184:187], v[80:95]
    ds_read_b128 v[156:159], v5 offset:62464
    v_add_f32 v3, v191, v3
    v_cmp_lt_f32 vcc, s47, v7
    v_add_u32 v10, 32768, v5
    v_add_u32 v11, 1, v11
    v_mfma_f32_32x32x16_bf16 v[96:111], v[172:175], v[184:187], v[96:111]
    ds_read_b128 v[168:171], v5 offset:63488
    ds_read_b32 v12, v13 offset:2048
    v_and_b32 v10, 0x1ffff, v10
    s_waitcnt lgkmcnt(6)
L_mn_loop_l1:
    s_sub_u32 s44, s44, 1
    s_cbranch_scc1 L_mn_spec_l1
L_mn_back1_l1:
    s_cbranch_vccnz L_mn_resc_l1
L_mn_back2_l1:
    v_mfma_f32_32x32x16_bf16 v[176:191], v[120:123], v[112:115], v[208:223]
    ds_read_b128 v[172:175], v5 offset:64512
    v_exp_f32 v192, v192
    v_exp_f32 v193, v193
    v_add_f32 v2, v192, v2
    v_mfma_f32_32x32x16_bf16 v[176:191], v[124:127], v[116:119], v[176:191]
    ds_read_b128 v[120:123], v5 offset:40960
    v_exp_f32 v194, v194
    v_add_f32 v3, v193, v3
    v_cvt_pk_bf16_f32 v192, v192, v193
    s_waitcnt lgkmcnt(6)
    v_mfma_f32_32x32x16_bf16 v[176:191], v[136:139], v[128:131], v[176:191]
    ds_read_b128 v[124:127], v5 offset:41984
    v_exp_f32 v195, v195
    v_exp_f32 v196, v196
    v_add_f32 v2, v194, v2
    v_mfma_f32_32x32x16_bf16 v[176:191], v[140:143], v[132:135], v[176:191]
    ds_read_b128 v[136:139], v5 offset:43008
    v_exp_f32 v197, v197
    v_add_f32 v3, v195, v3
    v_cvt_pk_bf16_f32 v193, v194, v195
    s_waitcnt lgkmcnt(6)
    v_mfma_f32_32x32x16_bf16 v[176:191], v[152:155], v[144:147], v[176:191]
    ds_read_b128 v[140:143], v5 offset:44032
    v_exp_f32 v198, v198
    v_exp_f32 v199, v199
    v_cvt_pk_bf16_f32 v194, v196, v197
    v_mfma_f32_32x32x16_bf16 v[176:191], v[156:159], v[148:151], v[176:191]
    ds_read_b128 v[152:155], v5 offset:45056
    v_exp_f32 v200, v200
    v_cvt_pk_bf16_f32 v195, v198, v199
    v_add_f32 v2, v196, v2
    s_waitcnt lgkmcnt(5)
    v_mfma_f32_32x32x16_bf16 v[176:191], v[168:171], v[160:163], v[176:191]
    ds_read_b128 v[156:159], v5 offset:46080
    v_exp_f32 v201, v201
    v_exp_f32 v202, v202
    v_add_f32 v2, v200, v2
    v_mfma_f32_32x32x16_bf16 v[176:191], v[172:175], v[164:167], v[176:191]
    ds_read_b128 v[168:171], v5 offset:47104
    v_exp_f32 v203, v203
    v_add_f32 v3, v201, v3
    v_cvt_pk_bf16_f32 v200, v200, v201
    v_cmp_ge_u32 vcc, v11, v12
    s_waitcnt lgkmcnt(5)
    v_mfma_f32_32x32x16_bf16 v[48:63], v[120:123], v[192:195], v[48:63]
    ds_read_b128 v[172:175], v5 offset:48128
    ds_write_b32 v14, v11 offset:0
    v_mov_b32 v5, v10
    v_exp_f32 v204, v204
    v_exp_f32 v205, v205
    v_add_f32 v2, v202, v2
    s_cbranch_vccnz L_mn_wait_l
    L_mn_waited_l:
    v_mfma_f32_32x32x16_bf16 v[64:79], v[124:127], v[192:195], v[64:79]
    ds_read_b128 v[120:123], v5 offset:49152
    v_exp_f32 v206, v206
    v_add_f32 v3, v203, v3
    v_cvt_pk_bf16_f32 v201, v202, v203
    s_waitcnt lgkmcnt(6)
    v_mfma_f32_32x32x16_bf16 v[80:95], v[136:139], v[192:195], v[80:95]
    ds_read_b128 v[124:127], v5 offset:50176
    v_exp_f32 v207, v207
    v_cvt_pk_bf16_f32 v202, v204, v205
    v_add_f32 v3, v197, v3
    v_cvt_pk_bf16_f32 v203, v206, v207
    v_mfma_f32_32x32x16_bf16 v[96:111], v[140:143], v[192:195], v[96:111]
    ds_read_b128 v[136:139], v5 offset:51200
    v_add_f32 v2, v198, v2
    v_add_f32 v3, v199, v3
    v_add_f32 v2, v204, v2
    v_add_f32 v3, v205, v3
    s_waitcnt lgkmcnt(6)
    v_mfma_f32_32x32x16_bf16 v[48:63], v[152:155], v[200:203], v[48:63]
    ds_read_b128 v[140:143], v5 offset:52224
    v_max3_f32 v7, v176, v177, v178
    v_max3_f32 v7, v179, v180, v7
    v_max3_f32 v7, v181, v182, v7
    v_max3_f32 v7, v183, v184, v7
    v_add_f32 v2, v206, v2
    v_mfma_f32_32x32x16_bf16 v[64:79], v[156:159], v[200:203], v[64:79]
    ds_read_b128 v[152:155], v5 offset:53248
    v_max3_f32 v7, v185, v186, v7
    v_max3_f32 v7, v187, v188, v7
    v_max3_f32 v7, v189, v190, v7
    v_max_f32 v7, v191, v7
    s_waitcnt lgkmcnt(6)
    v_mfma_f32_32x32x16_bf16 v[80:95], v[168:171], v[200:203], v[80:95]
    ds_read_b128 v[156:159], v5 offset:54272
    v_add_f32 v3, v207, v3
    v_cmp_lt_f32 vcc, s47, v7
    v_mfma_f32_32x32x16_bf16 v[96:111], v[172:175], v[200:203], v[96:111]
    ds_read_b128 v[168:171], v5 offset:55296
    s_waitcnt lgkmcnt(5)
    s_branch L_mn_loop_l0
    .p2align 6
L_mn_loop_s0:
    s_sub_u32 s44, s44, 1
    s_cbranch_scc1 L_mn_spec_s0
L_mn_back1_s0:
    s_cbranch_vccnz L_mn_resc_s0
L_mn_back2_s0:
    v_mfma_f32_32x32x16_bf16 v[192:207], v[120:123], v[112:115], v[208:223]
    ds_read_b128 v[172:175], v5 offset:56320
    v_exp_f32 v176, v176
    v_exp_f32 v177, v177
    v_add_f32 v2, v176, v2
    v_mfma_f32_32x32x16_bf16 v[192:207], v[124:127], v[116:119], v[192:207]
    ds_read_b128 v[120:123], v5 offset:32768
    v_exp_f32 v178, v178
    v_add_f32 v3, v177, v3
    v_cvt_pk_bf16_f32 v176, v176, v177
    s_waitcnt lgkmcnt(5)
    v_mfma_f32_32x32x16_bf16 v[192:207], v[136:139], v[128:131], v[192:207]
    ds_read_b128 v[124:127], v5 offset:33792
    v_exp_f32 v179, v179
    v_exp_f32 v180, v180
    v_add_f32 v2, v178, v2
    v_mfma_f32_32x32x16_bf16 v[192:207], v[140:143], v[132:135], v[192:207]
    ds_read_b128 v[136:139], v5 offset:34816
    v_exp_f32 v181, v181
    v_add_f32 v3, v179, v3
    v_cvt_pk_bf16_f32 v177, v178, v179
    s_waitcnt lgkmcnt(5)
    v_mfma_f32_32x32x16_bf16 v[192:207], v[152:155], v[144:147], v[192:207]
    ds_read_b128 v[140:143], v5 offset:35840
    v_exp_f32 v182, v182
    v_exp_f32 v183, v183
    v_cvt_pk_bf16_f32 v178, v180, v181
    v_mfma_f32_32x32x16_bf16 v[192:207], v[156:159], v[148:151], v[192:207]
    ds_read_b128 v[152:155], v5 offset:36864
    v_exp_f32 v184, v184
    v_cvt_pk_bf16_f32 v179, v182, v183
    v_add_f32 v2, v180, v2
    s_waitcnt lgkmcnt(5)
    v_mfma_f32_32x32x16_bf16 v[192:207], v[168:171], v[160:163], v[192:207]
    ds_read_b128 v[156:159], v5 offset:37888
    v_exp_f32 v185, v185
    v_exp_f32 v186, v186
    v_add_f32 v2, v184, v2
    v_mfma_f32_32x32x16_bf16 v[192:207], v[172:175], v[164:167], v[192:207]
    ds_read_b128 v[168:171], v5 offset:38912
    v_exp_f32 v187, v187
    v_add_f32 v3, v185, v3
    v_cvt_pk_bf16_f32 v184, v184, v185
    s_waitcnt lgkmcnt(5)
    v_mfma_f32_32x32x16_bf16 v[48:63], v[120:123], v[176:179], v[48:63]
    ds_read_b128 v[172:175], v5 offset:39936
    v_exp_f32 v188, v188
    v_exp_f32 v189, v189
    v_add_f32 v2, v186, v2
    v_mfma_f32_32x32x16_bf16 v[64:79], v[124:127], v[176:179], v[64:79]
    ds_read_b128 v[120:123], v5 offset:57344
    v_exp_f32 v190, v190
    v_add_f32 v3, v187, v3
    v_cvt_pk_bf16_f32 v185, v186, v187
    s_waitcnt lgkmcnt(5)
    v_mfma_f32_32x32x16_bf16 v[80:95], v[136:139], v[176:179], v[80:95]
    ds_read_b128 v[124:127], v5 offset:58368
    v_exp_f32 v191, v191
    v_cvt_pk_bf16_f32 v186, v188, v189
    v_add_f32 v3, v181, v3
    v_cvt_pk_bf16_f32 v187, v190, v191
    v_mfma_f32_32x32x16_bf16 v[96:111], v[140:143], v[176:179], v[96:111]
    ds_read_b128 v[136:139], v5 offset:59392
    v_add_f32 v2, v182, v2
    v_add_f32 v3, v183, v3
    v_add_f32 v2, v188, v2
    v_add_f32 v3, v189, v3
    s_waitcnt lgkmcnt(5)
    v_mfma_f32_32x32x16_bf16 v[48:63], v[152:155], v[184:187], v[48:63]
    ds_read_b128 v[140:143], v5 offset:60416
    v_max3_f32 v7, v192, v193, v194
    v_max3_f32 v7, v195, v196, v7
    v_max3_f32 v7, v197, v198, v7
    v_max3_f32 v7, v199, v200, v7
    v_add_f32 v2, v190, v2
    v_mfma_f32_32x32x16_bf16 v[64:79], v[156:159], v[184:187], v[64:79]
    ds_read_b128 v[152:155], v5 offset:61440
    v_max3_f32 v7, v201, v202, v7
    v_max3_f32 v7, v203, v204, v7
    v_max3_f32 v7, v205, v206, v7
    v_max_f32 v7, v207, v7
    s_waitcnt lgkmcnt(5)
    v_mfma_f32_32x32x16_bf16 v[80:95], v[168:171], v[184:187], v[80:95]
    ds_read_b128 v[156:159], v5 offset:62464
    v_add_f32 v3, v191, v3
    v_cmp_lt_f32 vcc, s47, v7
    v_add_u32 v10, 32768, v5
    v_add_u32 v11, 1, v11
    v_mfma_f32_32x32x16_bf16 v[96:111], v[172:175], v[184:187], v[96:111]
    ds_read_b128 v[168:171], v5 offset:63488
    ds_read_b32 v12, v13 offset:2048
    v_and_b32 v10, 0x1ffff, v10
    s_waitcnt lgkmcnt(6)
L_mn_loop_s1:
    s_sub_u32 s44, s44, 1
    s_cbranch_scc1 L_mn_spec_s1
L_mn_back1_s1:
    s_cbranch_vccnz L_mn_resc_s1
L_mn_back2_s1:
    v_mfma_f32_32x32x16_bf16 v[176:191], v[120:123], v[112:115], v[208:223]
    ds_read_b128 v[172:175], v5 offset:64512
    v_exp_f32 v192, v192
    v_exp_f32 v193, v193
    v_add_f32 v2, v192, v2
    v_mfma_f32_32x32x16_bf16 v[176:191], v[124:127], v[116:119], v[176:191]
    ds_read_b128 v[120:123], v5 offset:40960
    ds_read_b32 v18, v15 offset:0
    v_exp_f32 v194, v194
    v_add_f32 v3, v193, v3
    v_cvt_pk_bf16_f32 v192, v192, v193
    s_waitcnt lgkmcnt(5)
    v_mfma_f32_32x32x16_bf16 v[176:191], v[136:139], v[128:131], v[176:191]
    ds_read_b128 v[124:127], v5 offset:41984
    v_exp_f32 v195, v195
    v_exp_f32 v196, v196
    v_add_f32 v2, v194, v2
    v_mfma_f32_32x32x16_bf16 v[176:191], v[140:143], v[132:135], v[176:191]
    ds_read_b128 v[136:139], v5 offset:43008
    v_exp_f32 v197, v197
    v_add_f32 v3, v195, v3
    v_cvt_pk_bf16_f32 v193, v194, v195
    s_waitcnt lgkmcnt(5)
    v_mfma_f32_32x32x16_bf16 v[176:191], v[152:155], v[144:147], v[176:191]
    ds_read_b128 v[140:143], v5 offset:44032
    v_exp_f32 v198, v198
    v_exp_f32 v199, v199
    v_cvt_pk_bf16_f32 v194, v196, v197
    v_mfma_f32_32x32x16_bf16 v[176:191], v[156:159], v[148:151], v[176:191]
    ds_read_b128 v[152:155], v5 offset:45056
    v_exp_f32 v200, v200
    v_cvt_pk_bf16_f32 v195, v198, v199
    v_add_f32 v2, v196, v2
    s_waitcnt lgkmcnt(5)
    v_mfma_f32_32x32x16_bf16 v[176:191], v[168:171], v[160:163], v[176:191]
    ds_read_b128 v[156:159], v5 offset:46080
    v_exp_f32 v201, v201
    v_exp_f32 v202, v202
    v_add_f32 v2, v200, v2
    v_mfma_f32_32x32x16_bf16 v[176:191], v[172:175], v[164:167], v[176:191]
    ds_read_b128 v[168:171], v5 offset:47104
    v_exp_f32 v203, v203
    v_add_f32 v3, v201, v3
    v_cvt_pk_bf16_f32 v200, v200, v201
    v_cmp_ge_u32 vcc, v11, v12
    s_waitcnt lgkmcnt(5)
    v_mfma_f32_32x32x16_bf16 v[48:63], v[120:123], v[192:195], v[48:63]
    ds_read_b128 v[172:175], v5 offset:48128
    ds_write_b32 v14, v11 offset:0
    v_mov_b32 v5, v10
    v_exp_f32 v204, v204
    v_exp_f32 v205, v205
    v_add_f32 v2, v202, v2
    s_cbranch_vccnz L_mn_wait_s
    L_mn_waited_s:
    v_mfma_f32_32x32x16_bf16 v[64:79], v[124:127], v[192:195], v[64:79]
    ds_read_b128 v[120:123], v5 offset:49152
    v_exp_f32 v206, v206
    v_add_f32 v3, v203, v3
    v_cvt_pk_bf16_f32 v201, v202, v203
    s_waitcnt vmcnt(0)
    v_add_u32 v17, 2, v11
    v_cmp_gt_u32 vcc, s49, v18
    ds_write_b32 v16, v17 offset:2048
    s_cbranch_vccnz L_mn_pwait
    L_mn_pwaited:
    s_cmp_eq_u32 s49, s39
    s_cbranch_scc1 L_mn_all_c
    L_mn_alld_c:
    s_add_u32 m0, s42, 32768
    s_add_u32 s50, s43, 0
    buffer_load_dwordx4 v4, s[20:23], s50 offen offset:0 sc1 lds
    s_waitcnt lgkmcnt(5)
    v_mfma_f32_32x32x16_bf16 v[80:95], v[136:139], v[192:195], v[80:95]
    ds_read_b128 v[124:127], v5 offset:50176
    v_exp_f32 v207, v207
    v_cvt_pk_bf16_f32 v202, v204, v205
    v_add_f32 v3, v197, v3
    v_cvt_pk_bf16_f32 v203, v206, v207
    buffer_load_dwordx4 v4, s[20:23], s50 offen offset:1024 sc1 lds
    buffer_load_dwordx4 v4, s[20:23], s50 offen offset:2048 sc1 lds
    v_mfma_f32_32x32x16_bf16 v[96:111], v[140:143], v[192:195], v[96:111]
    ds_read_b128 v[136:139], v5 offset:51200
    v_add_f32 v2, v198, v2
    v_add_f32 v3, v199, v3
    v_add_f32 v2, v204, v2
    v_add_f32 v3, v205, v3
    buffer_load_dwordx4 v4, s[20:23], s50 offen offset:3072 sc1 lds
    s_waitcnt lgkmcnt(5)
    v_mfma_f32_32x32x16_bf16 v[48:63], v[152:155], v[200:203], v[48:63]
    ds_read_b128 v[140:143], v5 offset:52224
    v_max3_f32 v7, v176, v177, v178
    v_max3_f32 v7, v179, v180, v7
    v_max3_f32 v7, v181, v182, v7
    v_max3_f32 v7, v183, v184, v7
    v_add_f32 v2, v206, v2
    s_add_u32 m0, s42, 36864
    s_add_u32 s50, s43, 4096
    buffer_load_dwordx4 v4, s[20:23], s50 offen offset:0 sc1 lds
    v_mfma_f32_32x32x16_bf16 v[64:79], v[156:159], v[200:203], v[64:79]
    ds_read_b128 v[152:155], v5 offset:53248
    v_max3_f32 v7, v185, v186, v7
    v_max3_f32 v7, v187, v188, v7
    v_max3_f32 v7, v189, v190, v7
    v_max_f32 v7, v191, v7
    buffer_load_dwordx4 v4, s[20:23], s50 offen offset:1024 sc1 lds
    buffer_load_dwordx4 v4, s[20:23], s50 offen offset:2048 sc1 lds
    s_waitcnt lgkmcnt(5)
    v_mfma_f32_32x32x16_bf16 v[80:95], v[168:171], v[200:203], v[80:95]
    ds_read_b128 v[156:159], v5 offset:54272
    v_add_f32 v3, v207, v3
    v_cmp_lt_f32 vcc, s47, v7
    v_mfma_f32_32x32x16_bf16 v[96:111], v[172:175], v[200:203], v[96:111]
    ds_read_b128 v[168:171], v5 offset:55296
    buffer_load_dwordx4 v4, s[20:23], s50 offen offset:3072 sc1 lds
    s_add_u32 s43, s43, 32768
    s_add_u32 s42, s42, 32768
    s_and_b32 s42, s42, 0x1ffff
    s_add_u32 s49, s49, 1
    s_sub_u32 s46, s46, 1
    s_waitcnt lgkmcnt(5)
    s_branch L_mn_loop_s0
L_mn_spec_l0:
    s_cmp_gt_i32 s45, 0
    s_cbranch_scc1 L_mn_exit
    s_cmp_eq_u32 s45, 0
    s_cbranch_scc1 L_mn_mask_l0
    s_lshl_b32 s36, s34, 2
    s_add_u32 s36, s36, s32
    s_lshl_b32 s36, s36, 15
    s_mov_b32 s22, 1056768
    s_waitcnt vmcnt(0)
    v_lshlrev_b32 v8, 7, v1
    buffer_load_dword v24, v8, s[20:23], s36 offen sc1
    s_add_u32 s36, s36, 8192
    buffer_load_dword v24, v8, s[20:23], s36 offen sc1
    s_add_u32 s36, s36, 8192
    buffer_load_dword v24, v8, s[20:23], s36 offen sc1
    s_add_u32 s36, s36, 8192
    buffer_load_dword v24, v8, s[20:23], s36 offen sc1
    s_add_u32 s36, s36, 8192
    s_mov_b32 s44, s46
    s_mov_b32 s45, 0
    s_branch L_mn_back1_l0
L_mn_mask_l0:
    v_lshlrev_b32 v8, 2, v1
    buffer_load_dword v20, v8, s[28:31], 0 offen sc1
    v_min_f32 v208, v6, v208
    v_add_f32 v9, 0xf1800000, v6
    v_min_f32 v209, v9, v209
    v_add_f32 v8, 0xf2000000, v6
    v_min_f32 v210, v8, v210
    v_add_f32 v9, 0xf2400000, v6
    v_min_f32 v211, v9, v211
    v_add_f32 v8, 0xf3000000, v6
    v_min_f32 v212, v8, v212
    v_add_f32 v9, 0xf3100000, v6
    v_min_f32 v213, v9, v213
    v_add_f32 v8, 0xf3200000, v6
    v_min_f32 v214, v8, v214
    v_add_f32 v9, 0xf3300000, v6
    v_min_f32 v215, v9, v215
    v_add_f32 v8, 0xf3800000, v6
    v_min_f32 v216, v8, v216
    v_add_f32 v9, 0xf3880000, v6
    v_min_f32 v217, v9, v217
    v_add_f32 v8, 0xf3900000, v6
    v_min_f32 v218, v8, v218
    v_add_f32 v9, 0xf3980000, v6
    v_min_f32 v219, v9, v219
    v_add_f32 v8, 0xf3c00000, v6
    v_min_f32 v220, v8, v220
    v_add_f32 v9, 0xf3c80000, v6
    v_min_f32 v221, v9, v221
    v_add_f32 v8, 0xf3d00000, v6
    v_min_f32 v222, v8, v222
    v_add_f32 v9, 0xf3d80000, v6
    v_min_f32 v223, v9, v223
    s_mov_b32 s44, 1
    s_mov_b32 s45, 1
    s_branch L_mn_back1_l0
L_mn_resc_l0:
    s_nop 15
    v_mov_b32 v8, v7
    s_nop 1
    v_permlane32_swap_b32 v8, v7
    s_nop 1
    v_max_f32 v7, v8, v7
    v_max_f32 v7, 0, v7
    v_exp_f32 v9, -v7
    v_sub_f32 v176, v176, v7
    v_sub_f32 v208, v208, v7
    v_sub_f32 v177, v177, v7
    v_sub_f32 v209, v209, v7
    v_sub_f32 v178, v178, v7
    v_sub_f32 v210, v210, v7
    v_sub_f32 v179, v179, v7
    v_sub_f32 v211, v211, v7
    v_sub_f32 v180, v180, v7
    v_sub_f32 v212, v212, v7
    v_sub_f32 v181, v181, v7
    v_sub_f32 v213, v213, v7
    v_sub_f32 v182, v182, v7
    v_sub_f32 v214, v214, v7
    v_sub_f32 v183, v183, v7
    v_sub_f32 v215, v215, v7
    v_sub_f32 v184, v184, v7
    v_sub_f32 v216, v216, v7
    v_sub_f32 v185, v185, v7
    v_sub_f32 v217, v217, v7
    v_sub_f32 v186, v186, v7
    v_sub_f32 v218, v218, v7
    v_sub_f32 v187, v187, v7
    v_sub_f32 v219, v219, v7
    v_sub_f32 v188, v188, v7
    v_sub_f32 v220, v220, v7
    v_sub_f32 v189, v189, v7
    v_sub_f32 v221, v221, v7
    v_sub_f32 v190, v190, v7
    v_sub_f32 v222, v222, v7
    v_sub_f32 v191, v191, v7
    v_sub_f32 v223, v223, v7
    v_mul_f32 v48, v9, v48
    v_mul_f32 v49, v9, v49
    v_mul_f32 v50, v9, v50
    v_mul_f32 v51, v9, v51
    v_mul_f32 v52, v9, v52
    v_mul_f32 v53, v9, v53
    v_mul_f32 v54, v9, v54
    v_mul_f32 v55, v9, v55
    v_mul_f32 v56, v9, v56
    v_mul_f32 v57, v9, v57
    v_mul_f32 v58, v9, v58
    v_mul_f32 v59, v9, v59
    v_mul_f32 v60, v9, v60
    v_mul_f32 v61, v9, v61
    v_mul_f32 v62, v9, v62
    v_mul_f32 v63, v9, v63
    v_mul_f32 v64, v9, v64
    v_mul_f32 v65, v9, v65
    v_mul_f32 v66, v9, v66
    v_mul_f32 v67, v9, v67
    v_mul_f32 v68, v9, v68
    v_mul_f32 v69, v9, v69
    v_mul_f32 v70, v9, v70
    v_mul_f32 v71, v9, v71
    v_mul_f32 v72, v9, v72
    v_mul_f32 v73, v9, v73
    v_mul_f32 v74, v9, v74
    v_mul_f32 v75, v9, v75
    v_mul_f32 v76, v9, v76
    v_mul_f32 v77, v9, v77
    v_mul_f32 v78, v9, v78
    v_mul_f32 v79, v9, v79
    v_mul_f32 v80, v9, v80
    v_mul_f32 v81, v9, v81
    v_mul_f32 v82, v9, v82
    v_mul_f32 v83, v9, v83
    v_mul_f32 v84, v9, v84
    v_mul_f32 v85, v9, v85
    v_mul_f32 v86, v9, v86
    v_mul_f32 v87, v9, v87
    v_mul_f32 v88, v9, v88
    v_mul_f32 v89, v9, v89
    v_mul_f32 v90, v9, v90
    v_mul_f32 v91, v9, v91
    v_mul_f32 v92, v9, v92
    v_mul_f32 v93, v9, v93
    v_mul_f32 v94, v9, v94
    v_mul_f32 v95, v9, v95
    v_mul_f32 v96, v9, v96
    v_mul_f32 v97, v9, v97
    v_mul_f32 v98, v9, v98
    v_mul_f32 v99, v9, v99
    v_mul_f32 v100, v9, v100
    v_mul_f32 v101, v9, v101
    v_mul_f32 v102, v9, v102
    v_mul_f32 v103, v9, v103
    v_mul_f32 v104, v9, v104
    v_mul_f32 v105, v9, v105
    v_mul_f32 v106, v9, v106
    v_mul_f32 v107, v9, v107
    v_mul_f32 v108, v9, v108
    v_mul_f32 v109, v9, v109
    v_mul_f32 v110, v9, v110
    v_mul_f32 v111, v9, v111
    v_mul_f32 v2, v9, v2
    v_mul_f32 v3, v9, v3
    s_nop 1
    s_branch L_mn_back2_l0
L_mn_spec_l1:
    s_cmp_gt_i32 s45, 0
    s_cbranch_scc1 L_mn_exit
    s_cmp_eq_u32 s45, 0
    s_cbranch_scc1 L_mn_mask_l1
    s_lshl_b32 s36, s34, 2
    s_add_u32 s36, s36, s32
    s_lshl_b32 s36, s36, 15
    s_mov_b32 s22, 1056768
    s_waitcnt vmcnt(0)
    v_lshlrev_b32 v8, 7, v1
    buffer_load_dword v24, v8, s[20:23], s36 offen sc1
    s_add_u32 s36, s36, 8192
    buffer_load_dword v24, v8, s[20:23], s36 offen sc1
    s_add_u32 s36, s36, 8192
    buffer_load_dword v24, v8, s[20:23], s36 offen sc1
    s_add_u32 s36, s36, 8192
    buffer_load_dword v24, v8, s[20:23], s36 offen sc1
    s_add_u32 s36, s36, 8192
    s_mov_b32 s44, s46
    s_mov_b32 s45, 0
    s_branch L_mn_back1_l1
L_mn_mask_l1:
    v_lshlrev_b32 v8, 2, v1
    buffer_load_dword v20, v8, s[28:31], 0 offen sc1
    v_min_f32 v208, v6, v208
    v_add_f32 v9, 0xf1800000, v6
    v_min_f32 v209, v9, v209
    v_add_f32 v8, 0xf2000000, v6
    v_min_f32 v210, v8, v210
    v_add_f32 v9, 0xf2400000, v6
    v_min_f32 v211, v9, v211
    v_add_f32 v8, 0xf3000000, v6
    v_min_f32 v212, v8, v212
    v_add_f32 v9, 0xf3100000, v6
    v_min_f32 v213, v9, v213
    v_add_f32 v8, 0xf3200000, v6
    v_min_f32 v214, v8, v214
    v_add_f32 v9, 0xf3300000, v6
    v_min_f32 v215, v9, v215
    v_add_f32 v8, 0xf3800000, v6
    v_min_f32 v216, v8, v216
    v_add_f32 v9, 0xf3880000, v6
    v_min_f32 v217, v9, v217
    v_add_f32 v8, 0xf3900000, v6
    v_min_f32 v218, v8, v218
    v_add_f32 v9, 0xf3980000, v6
    v_min_f32 v219, v9, v219
    v_add_f32 v8, 0xf3c00000, v6
    v_min_f32 v220, v8, v220
    v_add_f32 v9, 0xf3c80000, v6
    v_min_f32 v221, v9, v221
    v_add_f32 v8, 0xf3d00000, v6
    v_min_f32 v222, v8, v222
    v_add_f32 v9, 0xf3d80000, v6
    v_min_f32 v223, v9, v223
    s_mov_b32 s44, 1
    s_mov_b32 s45, 1
    s_branch L_mn_back1_l1
L_mn_resc_l1:
    s_nop 15
    v_mov_b32 v8, v7
    s_nop 1
    v_permlane32_swap_b32 v8, v7
    s_nop 1
    v_max_f32 v7, v8, v7
    v_max_f32 v7, 0, v7
    v_exp_f32 v9, -v7
    v_sub_f32 v192, v192, v7
    v_sub_f32 v208, v208, v7
    v_sub_f32 v193, v193, v7
    v_sub_f32 v209, v209, v7
    v_sub_f32 v194, v194, v7
    v_sub_f32 v210, v210, v7
    v_sub_f32 v195, v195, v7
    v_sub_f32 v211, v211, v7
    v_sub_f32 v196, v196, v7
    v_sub_f32 v212, v212, v7
    v_sub_f32 v197, v197, v7
    v_sub_f32 v213, v213, v7
    v_sub_f32 v198, v198, v7
    v_sub_f32 v214, v214, v7
    v_sub_f32 v199, v199, v7
    v_sub_f32 v215, v215, v7
    v_sub_f32 v200, v200, v7
    v_sub_f32 v216, v216, v7
    v_sub_f32 v201, v201, v7
    v_sub_f32 v217, v217, v7
    v_sub_f32 v202, v202, v7
    v_sub_f32 v218, v218, v7
    v_sub_f32 v203, v203, v7
    v_sub_f32 v219, v219, v7
    v_sub_f32 v204, v204, v7
    v_sub_f32 v220, v220, v7
    v_sub_f32 v205, v205, v7
    v_sub_f32 v221, v221, v7
    v_sub_f32 v206, v206, v7
    v_sub_f32 v222, v222, v7
    v_sub_f32 v207, v207, v7
    v_sub_f32 v223, v223, v7
    v_mul_f32 v48, v9, v48
    v_mul_f32 v49, v9, v49
    v_mul_f32 v50, v9, v50
    v_mul_f32 v51, v9, v51
    v_mul_f32 v52, v9, v52
    v_mul_f32 v53, v9, v53
    v_mul_f32 v54, v9, v54
    v_mul_f32 v55, v9, v55
    v_mul_f32 v56, v9, v56
    v_mul_f32 v57, v9, v57
    v_mul_f32 v58, v9, v58
    v_mul_f32 v59, v9, v59
    v_mul_f32 v60, v9, v60
    v_mul_f32 v61, v9, v61
    v_mul_f32 v62, v9, v62
    v_mul_f32 v63, v9, v63
    v_mul_f32 v64, v9, v64
    v_mul_f32 v65, v9, v65
    v_mul_f32 v66, v9, v66
    v_mul_f32 v67, v9, v67
    v_mul_f32 v68, v9, v68
    v_mul_f32 v69, v9, v69
    v_mul_f32 v70, v9, v70
    v_mul_f32 v71, v9, v71
    v_mul_f32 v72, v9, v72
    v_mul_f32 v73, v9, v73
    v_mul_f32 v74, v9, v74
    v_mul_f32 v75, v9, v75
    v_mul_f32 v76, v9, v76
    v_mul_f32 v77, v9, v77
    v_mul_f32 v78, v9, v78
    v_mul_f32 v79, v9, v79
    v_mul_f32 v80, v9, v80
    v_mul_f32 v81, v9, v81
    v_mul_f32 v82, v9, v82
    v_mul_f32 v83, v9, v83
    v_mul_f32 v84, v9, v84
    v_mul_f32 v85, v9, v85
    v_mul_f32 v86, v9, v86
    v_mul_f32 v87, v9, v87
    v_mul_f32 v88, v9, v88
    v_mul_f32 v89, v9, v89
    v_mul_f32 v90, v9, v90
    v_mul_f32 v91, v9, v91
    v_mul_f32 v92, v9, v92
    v_mul_f32 v93, v9, v93
    v_mul_f32 v94, v9, v94
    v_mul_f32 v95, v9, v95
    v_mul_f32 v96, v9, v96
    v_mul_f32 v97, v9, v97
    v_mul_f32 v98, v9, v98
    v_mul_f32 v99, v9, v99
    v_mul_f32 v100, v9, v100
    v_mul_f32 v101, v9, v101
    v_mul_f32 v102, v9, v102
    v_mul_f32 v103, v9, v103
    v_mul_f32 v104, v9, v104
    v_mul_f32 v105, v9, v105
    v_mul_f32 v106, v9, v106
    v_mul_f32 v107, v9, v107
    v_mul_f32 v108, v9, v108
    v_mul_f32 v109, v9, v109
    v_mul_f32 v110, v9, v110
    v_mul_f32 v111, v9, v111
    v_mul_f32 v2, v9, v2
    v_mul_f32 v3, v9, v3
    s_nop 1
    s_branch L_mn_back2_l1
L_mn_wait_l:
    s_cmp_eq_u32 s44, 0
    s_cselect_b32 s36, s45, 0
    s_cmp_gt_i32 s36, 0
    s_cbranch_scc1 L_mn_waited_l
    s_mov_b32 s48, 0
L_mn_wait_l_l:
    ds_read_b32 v12, v13 offset:2048
    s_waitcnt lgkmcnt(0)
    v_cmp_ge_u32 vcc, v11, v12
    s_add_u32 s48, s48, 1
    s_cbranch_vccz L_mn_waited_l
    s_sleep 1
    s_cmp_lt_u32 s48, 65536
    s_cbranch_scc1 L_mn_wait_l_l
    s_branch L_mn_waited_l
L_mn_spec_s0:
    s_cmp_gt_i32 s45, 0
    s_cbranch_scc1 L_mn_exit
    v_min_f32 v208, v6, v208
    v_add_f32 v9, 0xf1800000, v6
    v_min_f32 v209, v9, v209
    v_add_f32 v8, 0xf2000000, v6
    v_min_f32 v210, v8, v210
    v_add_f32 v9, 0xf2400000, v6
    v_min_f32 v211, v9, v211
    v_add_f32 v8, 0xf3000000, v6
    v_min_f32 v212, v8, v212
    v_add_f32 v9, 0xf3100000, v6
    v_min_f32 v213, v9, v213
    v_add_f32 v8, 0xf3200000, v6
    v_min_f32 v214, v8, v214
    v_add_f32 v9, 0xf3300000, v6
    v_min_f32 v215, v9, v215
    v_add_f32 v8, 0xf3800000, v6
    v_min_f32 v216, v8, v216
    v_add_f32 v9, 0xf3880000, v6
    v_min_f32 v217, v9, v217
    v_add_f32 v8, 0xf3900000, v6
    v_min_f32 v218, v8, v218
    v_add_f32 v9, 0xf3980000, v6
    v_min_f32 v219, v9, v219
    v_add_f32 v8, 0xf3c00000, v6
    v_min_f32 v220, v8, v220
    v_add_f32 v9, 0xf3c80000, v6
    v_min_f32 v221, v9, v221
    v_add_f32 v8, 0xf3d00000, v6
    v_min_f32 v222, v8, v222
    v_add_f32 v9, 0xf3d80000, v6
    v_min_f32 v223, v9, v223
    s_mov_b32 s44, 1
    s_mov_b32 s45, 1
    s_branch L_mn_back1_s0
L_mn_resc_s0:
    s_nop 15
    v_mov_b32 v8, v7
    s_nop 1
    v_permlane32_swap_b32 v8, v7
    s_nop 1
    v_max_f32 v7, v8, v7
    v_max_f32 v7, 0, v7
    v_exp_f32 v9, -v7
    v_sub_f32 v176, v176, v7
    v_sub_f32 v208, v208, v7
    v_sub_f32 v177, v177, v7
    v_sub_f32 v209, v209, v7
    v_sub_f32 v178, v178, v7
    v_sub_f32 v210, v210, v7
    v_sub_f32 v179, v179, v7
    v_sub_f32 v211, v211, v7
    v_sub_f32 v180, v180, v7
    v_sub_f32 v212, v212, v7
    v_sub_f32 v181, v181, v7
    v_sub_f32 v213, v213, v7
    v_sub_f32 v182, v182, v7
    v_sub_f32 v214, v214, v7
    v_sub_f32 v183, v183, v7
    v_sub_f32 v215, v215, v7
    v_sub_f32 v184, v184, v7
    v_sub_f32 v216, v216, v7
    v_sub_f32 v185, v185, v7
    v_sub_f32 v217, v217, v7
    v_sub_f32 v186, v186, v7
    v_sub_f32 v218, v218, v7
    v_sub_f32 v187, v187, v7
    v_sub_f32 v219, v219, v7
    v_sub_f32 v188, v188, v7
    v_sub_f32 v220, v220, v7
    v_sub_f32 v189, v189, v7
    v_sub_f32 v221, v221, v7
    v_sub_f32 v190, v190, v7
    v_sub_f32 v222, v222, v7
    v_sub_f32 v191, v191, v7
    v_sub_f32 v223, v223, v7
    v_mul_f32 v48, v9, v48
    v_mul_f32 v49, v9, v49
    v_mul_f32 v50, v9, v50
    v_mul_f32 v51, v9, v51
    v_mul_f32 v52, v9, v52
    v_mul_f32 v53, v9, v53
    v_mul_f32 v54, v9, v54
    v_mul_f32 v55, v9, v55
    v_mul_f32 v56, v9, v56
    v_mul_f32 v57, v9, v57
    v_mul_f32 v58, v9, v58
    v_mul_f32 v59, v9, v59
    v_mul_f32 v60, v9, v60
    v_mul_f32 v61, v9, v61
    v_mul_f32 v62, v9, v62
    v_mul_f32 v63, v9, v63
    v_mul_f32 v64, v9, v64
    v_mul_f32 v65, v9, v65
    v_mul_f32 v66, v9, v66
    v_mul_f32 v67, v9, v67
    v_mul_f32 v68, v9, v68
    v_mul_f32 v69, v9, v69
    v_mul_f32 v70, v9, v70
    v_mul_f32 v71, v9, v71
    v_mul_f32 v72, v9, v72
    v_mul_f32 v73, v9, v73
    v_mul_f32 v74, v9, v74
    v_mul_f32 v75, v9, v75
    v_mul_f32 v76, v9, v76
    v_mul_f32 v77, v9, v77
    v_mul_f32 v78, v9, v78
    v_mul_f32 v79, v9, v79
    v_mul_f32 v80, v9, v80
    v_mul_f32 v81, v9, v81
    v_mul_f32 v82, v9, v82
    v_mul_f32 v83, v9, v83
    v_mul_f32 v84, v9, v84
    v_mul_f32 v85, v9, v85
    v_mul_f32 v86, v9, v86
    v_mul_f32 v87, v9, v87
    v_mul_f32 v88, v9, v88
    v_mul_f32 v89, v9, v89
    v_mul_f32 v90, v9, v90
    v_mul_f32 v91, v9, v91
    v_mul_f32 v92, v9, v92
    v_mul_f32 v93, v9, v93
    v_mul_f32 v94, v9, v94
    v_mul_f32 v95, v9, v95
    v_mul_f32 v96, v9, v96
    v_mul_f32 v97, v9, v97
    v_mul_f32 v98, v9, v98
    v_mul_f32 v99, v9, v99
    v_mul_f32 v100, v9, v100
    v_mul_f32 v101, v9, v101
    v_mul_f32 v102, v9, v102
    v_mul_f32 v103, v9, v103
    v_mul_f32 v104, v9, v104
    v_mul_f32 v105, v9, v105
    v_mul_f32 v106, v9, v106
    v_mul_f32 v107, v9, v107
    v_mul_f32 v108, v9, v108
    v_mul_f32 v109, v9, v109
    v_mul_f32 v110, v9, v110
    v_mul_f32 v111, v9, v111
    v_mul_f32 v2, v9, v2
    v_mul_f32 v3, v9, v3
    s_nop 1
    s_branch L_mn_back2_s0
L_mn_spec_s1:
    s_cmp_gt_i32 s45, 0
    s_cbranch_scc1 L_mn_exit
    v_min_f32 v208, v6, v208
    v_add_f32 v9, 0xf1800000, v6
    v_min_f32 v209, v9, v209
    v_add_f32 v8, 0xf2000000, v6
    v_min_f32 v210, v8, v210
    v_add_f32 v9, 0xf2400000, v6
    v_min_f32 v211, v9, v211
    v_add_f32 v8, 0xf3000000, v6
    v_min_f32 v212, v8, v212
    v_add_f32 v9, 0xf3100000, v6
    v_min_f32 v213, v9, v213
    v_add_f32 v8, 0xf3200000, v6
    v_min_f32 v214, v8, v214
    v_add_f32 v9, 0xf3300000, v6
    v_min_f32 v215, v9, v215
    v_add_f32 v8, 0xf3800000, v6
    v_min_f32 v216, v8, v216
    v_add_f32 v9, 0xf3880000, v6
    v_min_f32 v217, v9, v217
    v_add_f32 v8, 0xf3900000, v6
    v_min_f32 v218, v8, v218
    v_add_f32 v9, 0xf3980000, v6
    v_min_f32 v219, v9, v219
    v_add_f32 v8, 0xf3c00000, v6
    v_min_f32 v220, v8, v220
    v_add_f32 v9, 0xf3c80000, v6
    v_min_f32 v221, v9, v221
    v_add_f32 v8, 0xf3d00000, v6
    v_min_f32 v222, v8, v222
    v_add_f32 v9, 0xf3d80000, v6
    v_min_f32 v223, v9, v223
    s_mov_b32 s44, 1
    s_mov_b32 s45, 1
    s_branch L_mn_back1_s1
L_mn_resc_s1:
    s_nop 15
    v_mov_b32 v8, v7
    s_nop 1
    v_permlane32_swap_b32 v8, v7
    s_nop 1
    v_max_f32 v7, v8, v7
    v_max_f32 v7, 0, v7
    v_exp_f32 v9, -v7
    v_sub_f32 v192, v192, v7
    v_sub_f32 v208, v208, v7
    v_sub_f32 v193, v193, v7
    v_sub_f32 v209, v209, v7
    v_sub_f32 v194, v194, v7
    v_sub_f32 v210, v210, v7
    v_sub_f32 v195, v195, v7
    v_sub_f32 v211, v211, v7
    v_sub_f32 v196, v196, v7
    v_sub_f32 v212, v212, v7
    v_sub_f32 v197, v197, v7
    v_sub_f32 v213, v213, v7
    v_sub_f32 v198, v198, v7
    v_sub_f32 v214, v214, v7
    v_sub_f32 v199, v199, v7
    v_sub_f32 v215, v215, v7
    v_sub_f32 v200, v200, v7
    v_sub_f32 v216, v216, v7
    v_sub_f32 v201, v201, v7
    v_sub_f32 v217, v217, v7
    v_sub_f32 v202, v202, v7
    v_sub_f32 v218, v218, v7
    v_sub_f32 v203, v203, v7
    v_sub_f32 v219, v219, v7
    v_sub_f32 v204, v204, v7
    v_sub_f32 v220, v220, v7
    v_sub_f32 v205, v205, v7
    v_sub_f32 v221, v221, v7
    v_sub_f32 v206, v206, v7
    v_sub_f32 v222, v222, v7
    v_sub_f32 v207, v207, v7
    v_sub_f32 v223, v223, v7
    v_mul_f32 v48, v9, v48
    v_mul_f32 v49, v9, v49
    v_mul_f32 v50, v9, v50
    v_mul_f32 v51, v9, v51
    v_mul_f32 v52, v9, v52
    v_mul_f32 v53, v9, v53
    v_mul_f32 v54, v9, v54
    v_mul_f32 v55, v9, v55
    v_mul_f32 v56, v9, v56
    v_mul_f32 v57, v9, v57
    v_mul_f32 v58, v9, v58
    v_mul_f32 v59, v9, v59
    v_mul_f32 v60, v9, v60
    v_mul_f32 v61, v9, v61
    v_mul_f32 v62, v9, v62
    v_mul_f32 v63, v9, v63
    v_mul_f32 v64, v9, v64
    v_mul_f32 v65, v9, v65
    v_mul_f32 v66, v9, v66
    v_mul_f32 v67, v9, v67
    v_mul_f32 v68, v9, v68
    v_mul_f32 v69, v9, v69
    v_mul_f32 v70, v9, v70
    v_mul_f32 v71, v9, v71
    v_mul_f32 v72, v9, v72
    v_mul_f32 v73, v9, v73
    v_mul_f32 v74, v9, v74
    v_mul_f32 v75, v9, v75
    v_mul_f32 v76, v9, v76
    v_mul_f32 v77, v9, v77
    v_mul_f32 v78, v9, v78
    v_mul_f32 v79, v9, v79
    v_mul_f32 v80, v9, v80
    v_mul_f32 v81, v9, v81
    v_mul_f32 v82, v9, v82
    v_mul_f32 v83, v9, v83
    v_mul_f32 v84, v9, v84
    v_mul_f32 v85, v9, v85
    v_mul_f32 v86, v9, v86
    v_mul_f32 v87, v9, v87
    v_mul_f32 v88, v9, v88
    v_mul_f32 v89, v9, v89
    v_mul_f32 v90, v9, v90
    v_mul_f32 v91, v9, v91
    v_mul_f32 v92, v9, v92
    v_mul_f32 v93, v9, v93
    v_mul_f32 v94, v9, v94
    v_mul_f32 v95, v9, v95
    v_mul_f32 v96, v9, v96
    v_mul_f32 v97, v9, v97
    v_mul_f32 v98, v9, v98
    v_mul_f32 v99, v9, v99
    v_mul_f32 v100, v9, v100
    v_mul_f32 v101, v9, v101
    v_mul_f32 v102, v9, v102
    v_mul_f32 v103, v9, v103
    v_mul_f32 v104, v9, v104
    v_mul_f32 v105, v9, v105
    v_mul_f32 v106, v9, v106
    v_mul_f32 v107, v9, v107
    v_mul_f32 v108, v9, v108
    v_mul_f32 v109, v9, v109
    v_mul_f32 v110, v9, v110
    v_mul_f32 v111, v9, v111
    v_mul_f32 v2, v9, v2
    v_mul_f32 v3, v9, v3
    s_nop 1
    s_branch L_mn_back2_s1
L_mn_wait_s:
    s_cmp_eq_u32 s44, 0
    s_cselect_b32 s36, s45, 0
    s_cmp_gt_i32 s36, 0
    s_cbranch_scc1 L_mn_waited_s
    s_mov_b32 s48, 0
L_mn_wait_s_l:
    ds_read_b32 v12, v13 offset:2048
    s_waitcnt lgkmcnt(0)
    v_cmp_ge_u32 vcc, v11, v12
    s_add_u32 s48, s48, 1
    s_cbranch_vccz L_mn_waited_s
    s_sleep 1
    s_cmp_lt_u32 s48, 65536
    s_cbranch_scc1 L_mn_wait_s_l
    s_branch L_mn_waited_s
L_mn_pwait:
    s_mov_b32 s48, 0
L_mn_pwait_l:
    ds_read_b32 v18, v15 offset:0
    s_waitcnt lgkmcnt(0)
    v_cmp_gt_u32 vcc, s49, v18
    s_add_u32 s48, s48, 1
    s_cbranch_vccz L_mn_pwaited
    s_sleep 1
    s_cmp_lt_u32 s48, 65536
    s_cbranch_scc1 L_mn_pwait_l
    s_branch L_mn_pwaited
L_mn_spin_e:
    s_mov_b32 s48, 0
L_mn_spin_e_l:
    s_sleep 2
    buffer_load_dword v2, v19, s[28:31], 0 offen sc1
    s_waitcnt vmcnt(0)
    v_and_b32 v2, 0x0101, v2
    v_cmp_ne_u32 vcc, 0x0101, v2
    s_add_u32 s48, s48, 1
    s_cbranch_vccz L_mn_spun_e
    s_cmp_lt_u32 s48, 65536
    s_cbranch_scc1 L_mn_spin_e_l
    s_branch L_mn_spun_e
L_mn_spin_l:
    s_mov_b32 s48, 0
L_mn_spin_l_l:
    s_sleep 2
    buffer_load_dword v2, v19, s[28:31], 0 offen sc1
    s_waitcnt vmcnt(0)
    v_and_b32 v2, 0x0101, v2
    v_cmp_ne_u32 vcc, 0x0101, v2
    s_add_u32 s48, s48, 1
    s_cbranch_vccz L_mn_spun_l
    s_cmp_lt_u32 s48, 65536
    s_cbranch_scc1 L_mn_spin_l_l
    s_branch L_mn_spun_l
L_mn_all_c:
    s_cmp_lg_u32 s39, 3
    s_cbranch_scc1 L_mn_all_c_b
    buffer_load_dwordx2 v[24:25], v19, s[28:31], 0 offen sc1
    s_mov_b32 s39, 4
    s_branch L_mn_alld_c
L_mn_all_c_b:
    s_cmp_eq_u32 s39, 4
    s_cbranch_scc1 L_mn_all_c_a
    v_mov_b32 v24, 5
    s_mov_b64 exec, 1
    buffer_store_byte v24, v19, s[28:31], s34 offen sc1
    s_mov_b64 exec, -1
    s_branch L_mn_alld_c
L_mn_all_c_a:
    s_cmp_eq_u32 s32, 7
    s_cselect_b32 s39, -1, -1
    s_mov_b32 s48, 0
    s_branch L_mn_all_c_c
L_mn_all_c_l:
    buffer_load_dwordx2 v[24:25], v19, s[28:31], 0 offen sc1
    s_waitcnt vmcnt(0)
L_mn_all_c_c:
    v_and_b32 v24, v24, v25
    v_and_b32 v24, 0x01010101, v24
    v_cmp_ne_u32 vcc, 0x01010101, v24
    s_add_u32 s48, s48, 1
    s_cbranch_vccz L_mn_alld_c
    s_sleep 2
    s_cmp_lt_u32 s48, 65536
    s_cbranch_scc1 L_mn_all_c_l
    s_branch L_mn_alld_c
L_mn_all_q:
    s_cmp_lg_u32 s39, 3
    s_cbranch_scc1 L_mn_all_q_b
    buffer_load_dwordx2 v[24:25], v19, s[28:31], 0 offen sc1
    s_mov_b32 s39, 4
    s_branch L_mn_alld_q
L_mn_all_q_b:
    s_cmp_eq_u32 s39, 4
    s_cbranch_scc1 L_mn_all_q_a
    v_mov_b32 v24, 5
    s_mov_b64 exec, 1
    buffer_store_byte v24, v19, s[28:31], s34 offen sc1
    s_mov_b64 exec, -1
    s_branch L_mn_alld_q
L_mn_all_q_a:
    s_cmp_eq_u32 s32, 7
    s_cselect_b32 s39, -1, -1
    s_mov_b32 s48, 0
    s_branch L_mn_all_q_c
L_mn_all_q_l:
    buffer_load_dwordx2 v[24:25], v19, s[28:31], 0 offen sc1
    s_waitcnt vmcnt(0)
L_mn_all_q_c:
    v_and_b32 v24, v24, v25
    v_and_b32 v24, 0x01010101, v24
    v_cmp_ne_u32 vcc, 0x01010101, v24
    s_add_u32 s48, s48, 1
    s_cbranch_vccz L_mn_alld_q
    s_sleep 2
    s_cmp_lt_u32 s48, 65536
    s_cbranch_scc1 L_mn_all_q_l
    s_branch L_mn_alld_q
L_mn_all_h:
    s_cmp_lg_u32 s39, 3
    s_cbranch_scc1 L_mn_all_h_b
    buffer_load_dwordx2 v[24:25], v19, s[28:31], 0 offen sc1
    s_mov_b32 s39, 4
    s_branch L_mn_alld_h
L_mn_all_h_b:
    s_cmp_eq_u32 s39, 4
    s_cbranch_scc1 L_mn_all_h_a
    v_mov_b32 v24, 5
    s_mov_b64 exec, 1
    buffer_store_byte v24, v19, s[28:31], s34 offen sc1
    s_mov_b64 exec, -1
    s_branch L_mn_alld_h
L_mn_all_h_a:
    s_cmp_eq_u32 s32, 7
    s_cselect_b32 s39, -1, -1
    s_mov_b32 s48, 0
    s_branch L_mn_all_h_c
L_mn_all_h_l:
    buffer_load_dwordx2 v[24:25], v19, s[28:31], 0 offen sc1
    s_waitcnt vmcnt(0)
L_mn_all_h_c:
    v_and_b32 v24, v24, v25
    v_and_b32 v24, 0x01010101, v24
    v_cmp_ne_u32 vcc, 0x01010101, v24
    s_add_u32 s48, s48, 1
    s_cbranch_vccz L_mn_alld_h
    s_sleep 2
    s_cmp_lt_u32 s48, 65536
    s_cbranch_scc1 L_mn_all_h_l
    s_branch L_mn_alld_h
L_mn_exit:
    s_setprio 3
    v_mov_b32 v11, 0x7fff
    ds_write_b32 v14, v11 offset:0
    s_cmp_ge_u32 s32, 4
    s_cbranch_scc1 L_mn_exit_s
    s_call_b64 s[62:63], L_mn_epi
    s_branch L_mn_conv
L_mn_epi:
    s_nop 12
    v_add_f32 v2, v2, v3
    v_mov_b32 v8, v2
    s_nop 1
    v_permlane32_swap_b32 v8, v2
    s_nop 1
    v_add_f32 v2, v8, v2
    v_rcp_f32 v9, v2
    s_lshr_b32 s37, s35, 1
    s_lshl_b32 s37, s37, 5
    s_add_u32 s37, s37, s33
    s_lshl_b32 s37, s37, 14
    s_and_b32 s36, s35, 1
    s_lshl_b32 s36, s36, 11
    s_add_u32 s37, s37, s36
    v_and_b32 v8, 15, v1
    v_lshlrev_b32 v8, 4, v8
    v_bfe_u32 v10, v1, 4, 1
    v_lshl_add_u32 v8, v10, 10, v8
    v_lshrrev_b32 v10, 5, v1
    v_lshl_add_u32 v8, v10, 8, v8
    v_mul_f32 v48, v9, v48
    v_mul_f32 v49, v9, v49
    v_mul_f32 v50, v9, v50
    v_mul_f32 v51, v9, v51
    v_mul_f32 v52, v9, v52
    v_mul_f32 v53, v9, v53
    v_mul_f32 v54, v9, v54
    v_mul_f32 v55, v9, v55
    v_cvt_pk_bf16_f32 v48, v48, v49
    v_cvt_pk_bf16_f32 v49, v50, v51
    v_cvt_pk_bf16_f32 v50, v52, v53
    v_cvt_pk_bf16_f32 v51, v54, v55
    buffer_store_dwordx4 v[48:51], v8, s[24:27], s37 offen offset:0 sc1
    v_mul_f32 v56, v9, v56
    v_mul_f32 v57, v9, v57
    v_mul_f32 v58, v9, v58
    v_mul_f32 v59, v9, v59
    v_mul_f32 v60, v9, v60
    v_mul_f32 v61, v9, v61
    v_mul_f32 v62, v9, v62
    v_mul_f32 v63, v9, v63
    v_cvt_pk_bf16_f32 v56, v56, v57
    v_cvt_pk_bf16_f32 v57, v58, v59
    v_cvt_pk_bf16_f32 v58, v60, v61
    v_cvt_pk_bf16_f32 v59, v62, v63
    buffer_store_dwordx4 v[56:59], v8, s[24:27], s37 offen offset:512 sc1
    s_add_u32 s37, s37, 4096
    v_mul_f32 v64, v9, v64
    v_mul_f32 v65, v9, v65
    v_mul_f32 v66, v9, v66
    v_mul_f32 v67, v9, v67
    v_mul_f32 v68, v9, v68
    v_mul_f32 v69, v9, v69
    v_mul_f32 v70, v9, v70
    v_mul_f32 v71, v9, v71
    v_cvt_pk_bf16_f32 v64, v64, v65
    v_cvt_pk_bf16_f32 v65, v66, v67
    v_cvt_pk_bf16_f32 v66, v68, v69
    v_cvt_pk_bf16_f32 v67, v70, v71
    buffer_store_dwordx4 v[64:67], v8, s[24:27], s37 offen offset:0 sc1
    v_mul_f32 v72, v9, v72
    v_mul_f32 v73, v9, v73
    v_mul_f32 v74, v9, v74
    v_mul_f32 v75, v9, v75
    v_mul_f32 v76, v9, v76
    v_mul_f32 v77, v9, v77
    v_mul_f32 v78, v9, v78
    v_mul_f32 v79, v9, v79
    v_cvt_pk_bf16_f32 v72, v72, v73
    v_cvt_pk_bf16_f32 v73, v74, v75
    v_cvt_pk_bf16_f32 v74, v76, v77
    v_cvt_pk_bf16_f32 v75, v78, v79
    buffer_store_dwordx4 v[72:75], v8, s[24:27], s37 offen offset:512 sc1
    s_add_u32 s37, s37, 4096
    v_mul_f32 v80, v9, v80
    v_mul_f32 v81, v9, v81
    v_mul_f32 v82, v9, v82
    v_mul_f32 v83, v9, v83
    v_mul_f32 v84, v9, v84
    v_mul_f32 v85, v9, v85
    v_mul_f32 v86, v9, v86
    v_mul_f32 v87, v9, v87
    v_cvt_pk_bf16_f32 v80, v80, v81
    v_cvt_pk_bf16_f32 v81, v82, v83
    v_cvt_pk_bf16_f32 v82, v84, v85
    v_cvt_pk_bf16_f32 v83, v86, v87
    buffer_store_dwordx4 v[80:83], v8, s[24:27], s37 offen offset:0 sc1
    v_mul_f32 v88, v9, v88
    v_mul_f32 v89, v9, v89
    v_mul_f32 v90, v9, v90
    v_mul_f32 v91, v9, v91
    v_mul_f32 v92, v9, v92
    v_mul_f32 v93, v9, v93
    v_mul_f32 v94, v9, v94
    v_mul_f32 v95, v9, v95
    v_cvt_pk_bf16_f32 v88, v88, v89
    v_cvt_pk_bf16_f32 v89, v90, v91
    v_cvt_pk_bf16_f32 v90, v92, v93
    v_cvt_pk_bf16_f32 v91, v94, v95
    buffer_store_dwordx4 v[88:91], v8, s[24:27], s37 offen offset:512 sc1
    s_add_u32 s37, s37, 4096
    v_mul_f32 v96, v9, v96
    v_mul_f32 v97, v9, v97
    v_mul_f32 v98, v9, v98
    v_mul_f32 v99, v9, v99
    v_mul_f32 v100, v9, v100
    v_mul_f32 v101, v9, v101
    v_mul_f32 v102, v9, v102
    v_mul_f32 v103, v9, v103
    v_cvt_pk_bf16_f32 v96, v96, v97
    v_cvt_pk_bf16_f32 v97, v98, v99
    v_cvt_pk_bf16_f32 v98, v100, v101
    v_cvt_pk_bf16_f32 v99, v102, v103
    buffer_store_dwordx4 v[96:99], v8, s[24:27], s37 offen offset:0 sc1
    v_mul_f32 v104, v9, v104
    v_mul_f32 v105, v9, v105
    v_mul_f32 v106, v9, v106
    v_mul_f32 v107, v9, v107
    v_mul_f32 v108, v9, v108
    v_mul_f32 v109, v9, v109
    v_mul_f32 v110, v9, v110
    v_mul_f32 v111, v9, v111
    v_cvt_pk_bf16_f32 v104, v104, v105
    v_cvt_pk_bf16_f32 v105, v106, v107
    v_cvt_pk_bf16_f32 v106, v108, v109
    v_cvt_pk_bf16_f32 v107, v110, v111
    buffer_store_dwordx4 v[104:107], v8, s[24:27], s37 offen offset:512 sc1
    s_add_u32 s37, s37, 4096
    s_setpc_b64 s[62:63]
L_mn_exit_s:
    s_setprio 0
    s_lshl_b32 s45, s34, 1
    s_add_u32 s45, s45, 2
    s_sub_u32 s36, s34, 0
    s_cmp_gt_u32 s36, 4
    s_cselect_b32 s45, -2, s45
    s_cmp_lt_u32 s101, 320
    s_cselect_b32 s41, 1, 5
L_mn_ldq:
    s_add_u32 s36, s49, 2
    v_max_u32 v17, s36, v17
    s_waitcnt vmcnt(8)
    ds_write_b32 v16, v17 offset:2048
    s_cmp_eq_u32 s49, s45
    s_cbranch_scc1 L_mn_switch
L_mn_ldq_in:
    s_cmp_lt_i32 s46, 2
    s_cbranch_scc1 L_mn_lddone
    s_mov_b32 s48, 0
L_mn_ldq_poll:
    ds_read_b32 v18, v15 offset:0
    s_waitcnt lgkmcnt(0)
    v_cmp_gt_u32 vcc, s49, v18
    s_add_u32 s48, s48, 1
    s_cbranch_vccz L_mn_ldq_go
    s_sleep 1
    s_cmp_lt_u32 s48, 65536
    s_cbranch_scc1 L_mn_ldq_poll
L_mn_ldq_go:
    s_cmp_eq_u32 s49, s39
    s_cbranch_scc1 L_mn_all_q
L_mn_alld_q:
    s_add_u32 m0, s42, 32768
    s_add_u32 s50, s43, 0
    buffer_load_dwordx4 v4, s[20:23], s50 offen offset:0 sc1 lds
    buffer_load_dwordx4 v4, s[20:23], s50 offen offset:1024 sc1 lds
    buffer_load_dwordx4 v4, s[20:23], s50 offen offset:2048 sc1 lds
    buffer_load_dwordx4 v4, s[20:23], s50 offen offset:3072 sc1 lds
    s_add_u32 m0, s42, 36864
    s_add_u32 s50, s43, 4096
    buffer_load_dwordx4 v4, s[20:23], s50 offen offset:0 sc1 lds
    buffer_load_dwordx4 v4, s[20:23], s50 offen offset:1024 sc1 lds
    buffer_load_dwordx4 v4, s[20:23], s50 offen offset:2048 sc1 lds
    buffer_load_dwordx4 v4, s[20:23], s50 offen offset:3072 sc1 lds
    s_add_u32 s43, s43, 32768
    s_add_u32 s42, s42, 32768
    s_and_b32 s42, s42, 0x1ffff
    s_add_u32 s49, s49, 1
    s_sub_u32 s46, s46, 1
    s_cmp_eq_u32 s41, 2
    s_cbranch_scc1 L_mn_ldq_ok
    s_cmp_eq_u32 s41, 1
    s_cbranch_scc1 L_mn_ldq
    s_cmp_lt_u32 s48, 2
    s_cbranch_scc1 L_mn_ldq
    s_sub_u32 s41, s41, 1
    s_cmp_eq_u32 s41, 3
    s_cbranch_scc1 L_mn_ldq
    s_cmp_eq_u32 s41, 4
    s_cbranch_scc0 L_mn_ldq_su
    s_setprio 3
    s_call_b64 s[62:63], L_mn_epi
    s_setprio 0
    s_branch L_mn_ldq
L_mn_ldq_ok:
    s_cmp_eq_u32 s46, 4
    s_cbranch_scc0 L_mn_ldq
    buffer_load_dword v250, v251, s[28:31], 0 offen sc1
    s_branch L_mn_ldq
L_mn_ldq_su:
    s_setprio 3
    v_mov_b32 v8, 1
    v_mov_b32 v9, 0
    s_mov_b64 exec, 1
    buffer_store_byte v8, v9, s[96:99], s53 offen sc1
    s_mov_b64 exec, -1
    s_call_b64 s[62:63], L_gm_setup
    s_setprio 0
    s_branch L_mn_ldq
L_mn_switch:
    s_mov_b32 s45, -2
    s_cmp_lt_u32 s32, 6
    s_cbranch_scc1 L_mn_jobs
    s_mov_b32 s40, 0
    s_branch L_mn_ldh_in
L_mn_ldh:
    s_add_u32 s36, s49, 2
    v_max_u32 v17, s36, v17
    s_waitcnt vmcnt(16)
    ds_write_b32 v16, v17 offset:2048
    s_cmp_lg_u32 s40, 0
    s_cbranch_scc1 L_mn_ldq_in
L_mn_ldh_in:
    s_cmp_lt_i32 s46, 2
    s_cbranch_scc1 L_mn_lddone
    s_mov_b32 s48, 0
L_mn_ldh_poll:
    ds_read_b32 v18, v15 offset:0
    s_waitcnt lgkmcnt(0)
    v_cmp_gt_u32 vcc, s49, v18
    s_add_u32 s48, s48, 1
    s_cbranch_vccz L_mn_ldh_go
    s_sleep 1
    s_cmp_lt_u32 s48, 65536
    s_cbranch_scc1 L_mn_ldh_poll
L_mn_ldh_go:
    s_cmp_eq_u32 s49, s39
    s_cbranch_scc1 L_mn_all_h
L_mn_alld_h:
    s_add_u32 m0, s42, 32768
    s_add_u32 s50, s43, 0
    buffer_load_dwordx4 v4, s[20:23], s50 offen offset:0 sc1 lds
    buffer_load_dwordx4 v4, s[20:23], s50 offen offset:1024 sc1 lds
    buffer_load_dwordx4 v4, s[20:23], s50 offen offset:2048 sc1 lds
    buffer_load_dwordx4 v4, s[20:23], s50 offen offset:3072 sc1 lds
    s_add_u32 m0, s42, 36864
    s_add_u32 s50, s43, 4096
    buffer_load_dwordx4 v4, s[20:23], s50 offen offset:0 sc1 lds
    buffer_load_dwordx4 v4, s[20:23], s50 offen offset:1024 sc1 lds
    buffer_load_dwordx4 v4, s[20:23], s50 offen offset:2048 sc1 lds
    buffer_load_dwordx4 v4, s[20:23], s50 offen offset:3072 sc1 lds
    s_add_u32 m0, s42, 16384
    s_add_u32 s50, s43, -16384
    buffer_load_dwordx4 v4, s[20:23], s50 offen offset:0 sc1 lds
    buffer_load_dwordx4 v4, s[20:23], s50 offen offset:1024 sc1 lds
    buffer_load_dwordx4 v4, s[20:23], s50 offen offset:2048 sc1 lds
    buffer_load_dwordx4 v4, s[20:23], s50 offen offset:3072 sc1 lds
    s_add_u32 m0, s42, 20480
    s_add_u32 s50, s43, -12288
    buffer_load_dwordx4 v4, s[20:23], s50 offen offset:0 sc1 lds
    buffer_load_dwordx4 v4, s[20:23], s50 offen offset:1024 sc1 lds
    buffer_load_dwordx4 v4, s[20:23], s50 offen offset:2048 sc1 lds
    buffer_load_dwordx4 v4, s[20:23], s50 offen offset:3072 sc1 lds
    s_add_u32 s43, s43, 32768
    s_add_u32 s42, s42, 32768
    s_and_b32 s42, s42, 0x1ffff
    s_add_u32 s49, s49, 1
    s_sub_u32 s46, s46, 1
    s_cmp_eq_u32 s41, 2
    s_cbranch_scc1 L_mn_ldh_ok
    s_cmp_eq_u32 s41, 1
    s_cbranch_scc1 L_mn_ldh
    s_cmp_lt_u32 s48, 2
    s_cbranch_scc1 L_mn_ldh
    s_sub_u32 s41, s41, 1
    s_cmp_eq_u32 s41, 3
    s_cbranch_scc1 L_mn_ldh
    s_cmp_eq_u32 s41, 4
    s_cbranch_scc0 L_mn_ldh_su
    s_setprio 3
    s_call_b64 s[62:63], L_mn_epi
    s_setprio 0
    s_branch L_mn_ldh
L_mn_ldh_ok:
    s_cmp_eq_u32 s46, 4
    s_cbranch_scc0 L_mn_ldh
    buffer_load_dword v250, v251, s[28:31], 0 offen sc1
    s_branch L_mn_ldh
L_mn_ldh_su:
    s_setprio 3
    v_mov_b32 v8, 1
    v_mov_b32 v9, 0
    s_mov_b64 exec, 1
    buffer_store_byte v8, v9, s[96:99], s53 offen sc1
    s_mov_b64 exec, -1
    s_call_b64 s[62:63], L_gm_setup
    s_setprio 0
    s_branch L_mn_ldh
L_mn_jobs:
    s_setprio 0
    s_waitcnt vmcnt(0)
    ds_write_b32 v16, v11 offset:2048
    s_call_b64 s[62:63], L_mn_epi
    s_nop 1
    s_waitcnt lgkmcnt(0)
    s_mov_b32 s41, 0
    s_mov_b32 s56, s20
    s_mov_b32 s57, s21
    s_mov_b32 s58, s22
    s_mov_b32 s36, s101
    s_and_b32 s36, s101, 31
    s_mul_i32 s36, s36, 10
    s_lshr_b32 s37, s101, 5
    s_add_u32 s36, s36, s37
L_mn_j1:
    s_load_dwordx4 s[20:23], s[0:1], 8
    s_load_dwordx2 s[24:25], s[0:1], 24
    s_load_dwordx2 s[16:17], s[0:1], 120
    s_mul_hi_u32 s26, s36, 429496730
    s_mul_i32 s27, s26, 10
    s_sub_u32 s27, s36, s27
    v_lshrrev_b32 v28, 5, v1
    s_lshl_b32 s26, s26, 1
    v_add_u32 v28, s26, v28
    v_and_b32 v29, 31, v1
    s_lshl_b32 s27, s27, 5
    v_add_u32 v29, s27, v29
    v_lshlrev_b32 v31, 13, v29
    v_lshlrev_b32 v30, 4, v28
    v_sub_u32 v31, v31, v30
    v_add_u32 v31, 1008, v31
    v_mul_u32_u24 v28, 40960, v28
    v_lshl_add_u32 v28, v29, 2, v28
    v_lshlrev_b32 v30, 4, v29
    v_subrev_u32 v29, 3840, v28
    s_waitcnt lgkmcnt(0)
    s_mov_b32 s4, s20
    s_and_b32 s5, s21, 0xffff
    s_mov_b32 s6, 2621440
    s_mov_b32 s7, 0x00020000
    s_mov_b32 s8, s22
    s_and_b32 s9, s23, 0xffff
    s_mov_b32 s10, 2621440
    s_mov_b32 s11, 0x00020000
    s_mov_b32 s12, s24
    s_and_b32 s13, s25, 0xffff
    s_mov_b32 s14, 5120
    s_mov_b32 s15, 0x00020000
    s_add_u32 s16, s16, 65011712
    s_addc_u32 s17, s17, 0
    s_and_b32 s17, s17, 0xffff
    s_mov_b32 s18, 2621440
    s_mov_b32 s19, 0x00020000
    buffer_load_dwordx4 v[32:35], v30, s[12:15], 0 offen
    buffer_load_dword v44, v29, s[4:7], 0 offen offset:0
    buffer_load_dword v45, v29, s[4:7], 0 offen offset:1280
    buffer_load_dword v46, v29, s[4:7], 0 offen offset:2560
    s_mov_b32 s26, 0
    buffer_load_dword v47, v28, s[4:7], s26 offen offset:0
    buffer_load_dword v48, v28, s[4:7], s26 offen offset:1280
    buffer_load_dword v49, v28, s[4:7], s26 offen offset:2560
    buffer_load_dword v50, v28, s[4:7], s26 offen offset:3840
    s_mov_b32 s26, 5120
    buffer_load_dword v51, v28, s[4:7], s26 offen offset:0
    buffer_load_dword v52, v28, s[4:7], s26 offen offset:1280
    buffer_load_dword v53, v28, s[4:7], s26 offen offset:2560
    buffer_load_dword v54, v28, s[4:7], s26 offen offset:3840
    s_mov_b32 s26, 10240
    buffer_load_dword v55, v28, s[4:7], s26 offen offset:0
    buffer_load_dword v56, v28, s[4:7], s26 offen offset:1280
    buffer_load_dword v57, v28, s[4:7], s26 offen offset:2560
    buffer_load_dword v58, v28, s[4:7], s26 offen offset:3840
    s_mov_b32 s26, 15360
    buffer_load_dword v59, v28, s[4:7], s26 offen offset:0
    buffer_load_dword v60, v28, s[4:7], s26 offen offset:1280
    buffer_load_dword v61, v28, s[4:7], s26 offen offset:2560
    buffer_load_dword v62, v28, s[4:7], s26 offen offset:3840
    s_mov_b32 s26, 20480
    buffer_load_dword v63, v28, s[4:7], s26 offen offset:0
    buffer_load_dword v64, v28, s[4:7], s26 offen offset:1280
    buffer_load_dword v65, v28, s[4:7], s26 offen offset:2560
    buffer_load_dword v66, v28, s[4:7], s26 offen offset:3840
    s_mov_b32 s26, 25600
    buffer_load_dword v67, v28, s[4:7], s26 offen offset:0
    buffer_load_dword v68, v28, s[4:7], s26 offen offset:1280
    buffer_load_dword v69, v28, s[4:7], s26 offen offset:2560
    buffer_load_dword v70, v28, s[4:7], s26 offen offset:3840
    s_mov_b32 s26, 30720
    buffer_load_dword v71, v28, s[4:7], s26 offen offset:0
    buffer_load_dword v72, v28, s[4:7], s26 offen offset:1280
    buffer_load_dword v73, v28, s[4:7], s26 offen offset:2560
    buffer_load_dword v74, v28, s[4:7], s26 offen offset:3840
    s_mov_b32 s26, 35840
    buffer_load_dword v75, v28, s[4:7], s26 offen offset:0
    buffer_load_dword v76, v28, s[4:7], s26 offen offset:1280
    buffer_load_dword v77, v28, s[4:7], s26 offen offset:2560
    buffer_load_dword v78, v28, s[4:7], s26 offen offset:3840
    s_mov_b32 s26, 0
    buffer_load_dword v80, v28, s[8:11], s26 offen offset:0
    buffer_load_dword v81, v28, s[8:11], s26 offen offset:1280
    buffer_load_dword v82, v28, s[8:11], s26 offen offset:2560
    buffer_load_dword v83, v28, s[8:11], s26 offen offset:3840
    s_mov_b32 s26, 5120
    buffer_load_dword v84, v28, s[8:11], s26 offen offset:0
    buffer_load_dword v85, v28, s[8:11], s26 offen offset:1280
    buffer_load_dword v86, v28, s[8:11], s26 offen offset:2560
    buffer_load_dword v87, v28, s[8:11], s26 offen offset:3840
    s_mov_b32 s26, 10240
    buffer_load_dword v88, v28, s[8:11], s26 offen offset:0
    buffer_load_dword v89, v28, s[8:11], s26 offen offset:1280
    buffer_load_dword v90, v28, s[8:11], s26 offen offset:2560
    buffer_load_dword v91, v28, s[8:11], s26 offen offset:3840
    s_mov_b32 s26, 15360
    buffer_load_dword v92, v28, s[8:11], s26 offen offset:0
    buffer_load_dword v93, v28, s[8:11], s26 offen offset:1280
    buffer_load_dword v94, v28, s[8:11], s26 offen offset:2560
    buffer_load_dword v95, v28, s[8:11], s26 offen offset:3840
    s_mov_b32 s26, 20480
    buffer_load_dword v96, v28, s[8:11], s26 offen offset:0
    buffer_load_dword v97, v28, s[8:11], s26 offen offset:1280
    buffer_load_dword v98, v28, s[8:11], s26 offen offset:2560
    buffer_load_dword v99, v28, s[8:11], s26 offen offset:3840
    s_mov_b32 s26, 25600
    buffer_load_dword v100, v28, s[8:11], s26 offen offset:0
    buffer_load_dword v101, v28, s[8:11], s26 offen offset:1280
    buffer_load_dword v102, v28, s[8:11], s26 offen offset:2560
    buffer_load_dword v103, v28, s[8:11], s26 offen offset:3840
    s_mov_b32 s26, 30720
    buffer_load_dword v104, v28, s[8:11], s26 offen offset:0
    buffer_load_dword v105, v28, s[8:11], s26 offen offset:1280
    buffer_load_dword v106, v28, s[8:11], s26 offen offset:2560
    buffer_load_dword v107, v28, s[8:11], s26 offen offset:3840
    s_mov_b32 s26, 35840
    buffer_load_dword v108, v28, s[8:11], s26 offen offset:0
    buffer_load_dword v109, v28, s[8:11], s26 offen offset:1280
    buffer_load_dword v110, v28, s[8:11], s26 offen offset:2560
    buffer_load_dword v111, v28, s[8:11], s26 offen offset:3840
    s_waitcnt vmcnt(32)
    v_lshlrev_b32 v36, 16, v32
    v_and_b32 v37, 0xffff0000, v32
    v_lshlrev_b32 v38, 16, v33
    v_and_b32 v39, 0xffff0000, v33
    v_lshlrev_b32 v40, 16, v34
    v_and_b32 v41, 0xffff0000, v34
    v_lshlrev_b32 v42, 16, v35
    v_and_b32 v43, 0xffff0000, v35
    v_lshlrev_b32 v112, 16, v44
    v_and_b32 v113, 0xffff0000, v44
    v_lshlrev_b32 v114, 16, v45
    v_and_b32 v115, 0xffff0000, v45
    v_lshlrev_b32 v116, 16, v46
    v_and_b32 v117, 0xffff0000, v46
    v_lshlrev_b32 v118, 16, v47
    v_and_b32 v119, 0xffff0000, v47
    v_lshlrev_b32 v120, 16, v48
    v_and_b32 v121, 0xffff0000, v48
    v_lshlrev_b32 v122, 16, v49
    v_and_b32 v123, 0xffff0000, v49
    v_lshlrev_b32 v124, 16, v50
    v_and_b32 v125, 0xffff0000, v50
    v_lshlrev_b32 v126, 16, v51
    v_and_b32 v127, 0xffff0000, v51
    v_lshlrev_b32 v128, 16, v52
    v_and_b32 v129, 0xffff0000, v52
    v_lshlrev_b32 v130, 16, v53
    v_and_b32 v131, 0xffff0000, v53
    v_lshlrev_b32 v132, 16, v54
    v_and_b32 v133, 0xffff0000, v54
    v_lshlrev_b32 v134, 16, v55
    v_and_b32 v135, 0xffff0000, v55
    v_lshlrev_b32 v136, 16, v56
    v_and_b32 v137, 0xffff0000, v56
    v_lshlrev_b32 v138, 16, v57
    v_and_b32 v139, 0xffff0000, v57
    v_lshlrev_b32 v140, 16, v58
    v_and_b32 v141, 0xffff0000, v58
    v_lshlrev_b32 v142, 16, v59
    v_and_b32 v143, 0xffff0000, v59
    v_lshlrev_b32 v144, 16, v60
    v_and_b32 v145, 0xffff0000, v60
    v_lshlrev_b32 v146, 16, v61
    v_and_b32 v147, 0xffff0000, v61
    v_lshlrev_b32 v148, 16, v62
    v_and_b32 v149, 0xffff0000, v62
    v_lshlrev_b32 v150, 16, v63
    v_and_b32 v151, 0xffff0000, v63
    v_lshlrev_b32 v152, 16, v64
    v_and_b32 v153, 0xffff0000, v64
    v_lshlrev_b32 v154, 16, v65
    v_and_b32 v155, 0xffff0000, v65
    v_lshlrev_b32 v156, 16, v66
    v_and_b32 v157, 0xffff0000, v66
    v_lshlrev_b32 v158, 16, v67
    v_and_b32 v159, 0xffff0000, v67
    v_lshlrev_b32 v160, 16, v68
    v_and_b32 v161, 0xffff0000, v68
    v_lshlrev_b32 v162, 16, v69
    v_and_b32 v163, 0xffff0000, v69
    v_lshlrev_b32 v164, 16, v70
    v_and_b32 v165, 0xffff0000, v70
    v_lshlrev_b32 v166, 16, v71
    v_and_b32 v167, 0xffff0000, v71
    v_lshlrev_b32 v168, 16, v72
    v_and_b32 v169, 0xffff0000, v72
    v_lshlrev_b32 v170, 16, v73
    v_and_b32 v171, 0xffff0000, v73
    v_lshlrev_b32 v172, 16, v74
    v_and_b32 v173, 0xffff0000, v74
    v_lshlrev_b32 v174, 16, v75
    v_and_b32 v175, 0xffff0000, v75
    v_lshlrev_b32 v176, 16, v76
    v_and_b32 v177, 0xffff0000, v76
    v_lshlrev_b32 v178, 16, v77
    v_and_b32 v179, 0xffff0000, v77
    v_lshlrev_b32 v180, 16, v78
    v_and_b32 v181, 0xffff0000, v78
    v_mul_f32 v184, v39, v112
    v_fmac_f32 v184, v38, v114
    v_fmac_f32 v184, v37, v116
    v_fmac_f32 v184, v36, v118
    v_mul_f32 v185, v43, v113
    v_fmac_f32 v185, v42, v115
    v_fmac_f32 v185, v41, v117
    v_fmac_f32 v185, v40, v119
    v_mul_f32 v186, v39, v114
    v_fmac_f32 v186, v38, v116
    v_fmac_f32 v186, v37, v118
    v_fmac_f32 v186, v36, v120
    v_mul_f32 v187, v43, v115
    v_fmac_f32 v187, v42, v117
    v_fmac_f32 v187, v41, v119
    v_fmac_f32 v187, v40, v121
    v_mul_f32 v188, v39, v116
    v_fmac_f32 v188, v38, v118
    v_fmac_f32 v188, v37, v120
    v_fmac_f32 v188, v36, v122
    v_mul_f32 v189, v43, v117
    v_fmac_f32 v189, v42, v119
    v_fmac_f32 v189, v41, v121
    v_fmac_f32 v189, v40, v123
    v_mul_f32 v190, v39, v118
    v_fmac_f32 v190, v38, v120
    v_fmac_f32 v190, v37, v122
    v_fmac_f32 v190, v36, v124
    v_mul_f32 v191, v43, v119
    v_fmac_f32 v191, v42, v121
    v_fmac_f32 v191, v41, v123
    v_fmac_f32 v191, v40, v125
    v_mul_f32 v192, v39, v120
    v_fmac_f32 v192, v38, v122
    v_fmac_f32 v192, v37, v124
    v_fmac_f32 v192, v36, v126
    v_mul_f32 v193, v43, v121
    v_fmac_f32 v193, v42, v123
    v_fmac_f32 v193, v41, v125
    v_fmac_f32 v193, v40, v127
    v_mul_f32 v194, v39, v122
    v_fmac_f32 v194, v38, v124
    v_fmac_f32 v194, v37, v126
    v_fmac_f32 v194, v36, v128
    v_mul_f32 v195, v43, v123
    v_fmac_f32 v195, v42, v125
    v_fmac_f32 v195, v41, v127
    v_fmac_f32 v195, v40, v129
    v_mul_f32 v196, v39, v124
    v_fmac_f32 v196, v38, v126
    v_fmac_f32 v196, v37, v128
    v_fmac_f32 v196, v36, v130
    v_mul_f32 v197, v43, v125
    v_fmac_f32 v197, v42, v127
    v_fmac_f32 v197, v41, v129
    v_fmac_f32 v197, v40, v131
    v_mul_f32 v198, v39, v126
    v_fmac_f32 v198, v38, v128
    v_fmac_f32 v198, v37, v130
    v_fmac_f32 v198, v36, v132
    v_mul_f32 v199, v43, v127
    v_fmac_f32 v199, v42, v129
    v_fmac_f32 v199, v41, v131
    v_fmac_f32 v199, v40, v133
    v_mul_f32 v200, v39, v128
    v_fmac_f32 v200, v38, v130
    v_fmac_f32 v200, v37, v132
    v_fmac_f32 v200, v36, v134
    v_mul_f32 v201, v43, v129
    v_fmac_f32 v201, v42, v131
    v_fmac_f32 v201, v41, v133
    v_fmac_f32 v201, v40, v135
    v_mul_f32 v202, v39, v130
    v_fmac_f32 v202, v38, v132
    v_fmac_f32 v202, v37, v134
    v_fmac_f32 v202, v36, v136
    v_mul_f32 v203, v43, v131
    v_fmac_f32 v203, v42, v133
    v_fmac_f32 v203, v41, v135
    v_fmac_f32 v203, v40, v137
    v_mul_f32 v204, v39, v132
    v_fmac_f32 v204, v38, v134
    v_fmac_f32 v204, v37, v136
    v_fmac_f32 v204, v36, v138
    v_mul_f32 v205, v43, v133
    v_fmac_f32 v205, v42, v135
    v_fmac_f32 v205, v41, v137
    v_fmac_f32 v205, v40, v139
    v_mul_f32 v206, v39, v134
    v_fmac_f32 v206, v38, v136
    v_fmac_f32 v206, v37, v138
    v_fmac_f32 v206, v36, v140
    v_mul_f32 v207, v43, v135
    v_fmac_f32 v207, v42, v137
    v_fmac_f32 v207, v41, v139
    v_fmac_f32 v207, v40, v141
    v_mul_f32 v208, v39, v136
    v_fmac_f32 v208, v38, v138
    v_fmac_f32 v208, v37, v140
    v_fmac_f32 v208, v36, v142
    v_mul_f32 v209, v43, v137
    v_fmac_f32 v209, v42, v139
    v_fmac_f32 v209, v41, v141
    v_fmac_f32 v209, v40, v143
    v_mul_f32 v210, v39, v138
    v_fmac_f32 v210, v38, v140
    v_fmac_f32 v210, v37, v142
    v_fmac_f32 v210, v36, v144
    v_mul_f32 v211, v43, v139
    v_fmac_f32 v211, v42, v141
    v_fmac_f32 v211, v41, v143
    v_fmac_f32 v211, v40, v145
    v_mul_f32 v212, v39, v140
    v_fmac_f32 v212, v38, v142
    v_fmac_f32 v212, v37, v144
    v_fmac_f32 v212, v36, v146
    v_mul_f32 v213, v43, v141
    v_fmac_f32 v213, v42, v143
    v_fmac_f32 v213, v41, v145
    v_fmac_f32 v213, v40, v147
    v_mul_f32 v214, v39, v142
    v_fmac_f32 v214, v38, v144
    v_fmac_f32 v214, v37, v146
    v_fmac_f32 v214, v36, v148
    v_mul_f32 v215, v43, v143
    v_fmac_f32 v215, v42, v145
    v_fmac_f32 v215, v41, v147
    v_fmac_f32 v215, v40, v149
    v_mul_f32 v216, v39, v144
    v_fmac_f32 v216, v38, v146
    v_fmac_f32 v216, v37, v148
    v_fmac_f32 v216, v36, v150
    v_mul_f32 v217, v43, v145
    v_fmac_f32 v217, v42, v147
    v_fmac_f32 v217, v41, v149
    v_fmac_f32 v217, v40, v151
    v_mul_f32 v218, v39, v146
    v_fmac_f32 v218, v38, v148
    v_fmac_f32 v218, v37, v150
    v_fmac_f32 v218, v36, v152
    v_mul_f32 v219, v43, v147
    v_fmac_f32 v219, v42, v149
    v_fmac_f32 v219, v41, v151
    v_fmac_f32 v219, v40, v153
    v_mul_f32 v220, v39, v148
    v_fmac_f32 v220, v38, v150
    v_fmac_f32 v220, v37, v152
    v_fmac_f32 v220, v36, v154
    v_mul_f32 v221, v43, v149
    v_fmac_f32 v221, v42, v151
    v_fmac_f32 v221, v41, v153
    v_fmac_f32 v221, v40, v155
    v_mul_f32 v222, v39, v150
    v_fmac_f32 v222, v38, v152
    v_fmac_f32 v222, v37, v154
    v_fmac_f32 v222, v36, v156
    v_mul_f32 v223, v43, v151
    v_fmac_f32 v223, v42, v153
    v_fmac_f32 v223, v41, v155
    v_fmac_f32 v223, v40, v157
    v_mul_f32 v224, v39, v152
    v_fmac_f32 v224, v38, v154
    v_fmac_f32 v224, v37, v156
    v_fmac_f32 v224, v36, v158
    v_mul_f32 v225, v43, v153
    v_fmac_f32 v225, v42, v155
    v_fmac_f32 v225, v41, v157
    v_fmac_f32 v225, v40, v159
    v_mul_f32 v226, v39, v154
    v_fmac_f32 v226, v38, v156
    v_fmac_f32 v226, v37, v158
    v_fmac_f32 v226, v36, v160
    v_mul_f32 v227, v43, v155
    v_fmac_f32 v227, v42, v157
    v_fmac_f32 v227, v41, v159
    v_fmac_f32 v227, v40, v161
    v_mul_f32 v228, v39, v156
    v_fmac_f32 v228, v38, v158
    v_fmac_f32 v228, v37, v160
    v_fmac_f32 v228, v36, v162
    v_mul_f32 v229, v43, v157
    v_fmac_f32 v229, v42, v159
    v_fmac_f32 v229, v41, v161
    v_fmac_f32 v229, v40, v163
    v_mul_f32 v230, v39, v158
    v_fmac_f32 v230, v38, v160
    v_fmac_f32 v230, v37, v162
    v_fmac_f32 v230, v36, v164
    v_mul_f32 v231, v43, v159
    v_fmac_f32 v231, v42, v161
    v_fmac_f32 v231, v41, v163
    v_fmac_f32 v231, v40, v165
    v_mul_f32 v232, v39, v160
    v_fmac_f32 v232, v38, v162
    v_fmac_f32 v232, v37, v164
    v_fmac_f32 v232, v36, v166
    v_mul_f32 v233, v43, v161
    v_fmac_f32 v233, v42, v163
    v_fmac_f32 v233, v41, v165
    v_fmac_f32 v233, v40, v167
    v_mul_f32 v234, v39, v162
    v_fmac_f32 v234, v38, v164
    v_fmac_f32 v234, v37, v166
    v_fmac_f32 v234, v36, v168
    v_mul_f32 v235, v43, v163
    v_fmac_f32 v235, v42, v165
    v_fmac_f32 v235, v41, v167
    v_fmac_f32 v235, v40, v169
    v_mul_f32 v236, v39, v164
    v_fmac_f32 v236, v38, v166
    v_fmac_f32 v236, v37, v168
    v_fmac_f32 v236, v36, v170
    v_mul_f32 v237, v43, v165
    v_fmac_f32 v237, v42, v167
    v_fmac_f32 v237, v41, v169
    v_fmac_f32 v237, v40, v171
    v_mul_f32 v238, v39, v166
    v_fmac_f32 v238, v38, v168
    v_fmac_f32 v238, v37, v170
    v_fmac_f32 v238, v36, v172
    v_mul_f32 v239, v43, v167
    v_fmac_f32 v239, v42, v169
    v_fmac_f32 v239, v41, v171
    v_fmac_f32 v239, v40, v173
    v_mul_f32 v240, v39, v168
    v_fmac_f32 v240, v38, v170
    v_fmac_f32 v240, v37, v172
    v_fmac_f32 v240, v36, v174
    v_mul_f32 v241, v43, v169
    v_fmac_f32 v241, v42, v171
    v_fmac_f32 v241, v41, v173
    v_fmac_f32 v241, v40, v175
    v_mul_f32 v242, v39, v170
    v_fmac_f32 v242, v38, v172
    v_fmac_f32 v242, v37, v174
    v_fmac_f32 v242, v36, v176
    v_mul_f32 v243, v43, v171
    v_fmac_f32 v243, v42, v173
    v_fmac_f32 v243, v41, v175
    v_fmac_f32 v243, v40, v177
    v_mul_f32 v244, v39, v172
    v_fmac_f32 v244, v38, v174
    v_fmac_f32 v244, v37, v176
    v_fmac_f32 v244, v36, v178
    v_mul_f32 v245, v43, v173
    v_fmac_f32 v245, v42, v175
    v_fmac_f32 v245, v41, v177
    v_fmac_f32 v245, v40, v179
    v_mul_f32 v246, v39, v174
    v_fmac_f32 v246, v38, v176
    v_fmac_f32 v246, v37, v178
    v_fmac_f32 v246, v36, v180
    v_mul_f32 v247, v43, v175
    v_fmac_f32 v247, v42, v177
    v_fmac_f32 v247, v41, v179
    v_fmac_f32 v247, v40, v181
    s_waitcnt vmcnt(0)
    v_cvt_pk_bf16_f32 v30, v184, v185
    v_lshlrev_b32 v28, 16, v80
    v_and_b32 v29, 0xffff0000, v80
    v_lshlrev_b32 v184, 16, v30
    v_and_b32 v185, 0xffff0000, v30
    v_mul_f32 v184, v184, v28
    v_mul_f32 v185, v185, v29
    v_cvt_pk_bf16_f32 v30, v186, v187
    v_lshlrev_b32 v28, 16, v81
    v_and_b32 v29, 0xffff0000, v81
    v_lshlrev_b32 v186, 16, v30
    v_and_b32 v187, 0xffff0000, v30
    v_mul_f32 v186, v186, v28
    v_mul_f32 v187, v187, v29
    v_cvt_pk_bf16_f32 v30, v188, v189
    v_lshlrev_b32 v28, 16, v82
    v_and_b32 v29, 0xffff0000, v82
    v_lshlrev_b32 v188, 16, v30
    v_and_b32 v189, 0xffff0000, v30
    v_mul_f32 v188, v188, v28
    v_mul_f32 v189, v189, v29
    v_cvt_pk_bf16_f32 v30, v190, v191
    v_lshlrev_b32 v28, 16, v83
    v_and_b32 v29, 0xffff0000, v83
    v_lshlrev_b32 v190, 16, v30
    v_and_b32 v191, 0xffff0000, v30
    v_mul_f32 v190, v190, v28
    v_mul_f32 v191, v191, v29
    v_cvt_pk_bf16_f32 v30, v192, v193
    v_lshlrev_b32 v28, 16, v84
    v_and_b32 v29, 0xffff0000, v84
    v_lshlrev_b32 v192, 16, v30
    v_and_b32 v193, 0xffff0000, v30
    v_mul_f32 v192, v192, v28
    v_mul_f32 v193, v193, v29
    v_cvt_pk_bf16_f32 v30, v194, v195
    v_lshlrev_b32 v28, 16, v85
    v_and_b32 v29, 0xffff0000, v85
    v_lshlrev_b32 v194, 16, v30
    v_and_b32 v195, 0xffff0000, v30
    v_mul_f32 v194, v194, v28
    v_mul_f32 v195, v195, v29
    v_cvt_pk_bf16_f32 v30, v196, v197
    v_lshlrev_b32 v28, 16, v86
    v_and_b32 v29, 0xffff0000, v86
    v_lshlrev_b32 v196, 16, v30
    v_and_b32 v197, 0xffff0000, v30
    v_mul_f32 v196, v196, v28
    v_mul_f32 v197, v197, v29
    v_cvt_pk_bf16_f32 v30, v198, v199
    v_lshlrev_b32 v28, 16, v87
    v_and_b32 v29, 0xffff0000, v87
    v_lshlrev_b32 v198, 16, v30
    v_and_b32 v199, 0xffff0000, v30
    v_mul_f32 v198, v198, v28
    v_mul_f32 v199, v199, v29
    v_cvt_pk_bf16_f32 v30, v200, v201
    v_lshlrev_b32 v28, 16, v88
    v_and_b32 v29, 0xffff0000, v88
    v_lshlrev_b32 v200, 16, v30
    v_and_b32 v201, 0xffff0000, v30
    v_mul_f32 v200, v200, v28
    v_mul_f32 v201, v201, v29
    v_cvt_pk_bf16_f32 v30, v202, v203
    v_lshlrev_b32 v28, 16, v89
    v_and_b32 v29, 0xffff0000, v89
    v_lshlrev_b32 v202, 16, v30
    v_and_b32 v203, 0xffff0000, v30
    v_mul_f32 v202, v202, v28
    v_mul_f32 v203, v203, v29
    v_cvt_pk_bf16_f32 v30, v204, v205
    v_lshlrev_b32 v28, 16, v90
    v_and_b32 v29, 0xffff0000, v90
    v_lshlrev_b32 v204, 16, v30
    v_and_b32 v205, 0xffff0000, v30
    v_mul_f32 v204, v204, v28
    v_mul_f32 v205, v205, v29
    v_cvt_pk_bf16_f32 v30, v206, v207
    v_lshlrev_b32 v28, 16, v91
    v_and_b32 v29, 0xffff0000, v91
    v_lshlrev_b32 v206, 16, v30
    v_and_b32 v207, 0xffff0000, v30
    v_mul_f32 v206, v206, v28
    v_mul_f32 v207, v207, v29
    v_cvt_pk_bf16_f32 v30, v208, v209
    v_lshlrev_b32 v28, 16, v92
    v_and_b32 v29, 0xffff0000, v92
    v_lshlrev_b32 v208, 16, v30
    v_and_b32 v209, 0xffff0000, v30
    v_mul_f32 v208, v208, v28
    v_mul_f32 v209, v209, v29
    v_cvt_pk_bf16_f32 v30, v210, v211
    v_lshlrev_b32 v28, 16, v93
    v_and_b32 v29, 0xffff0000, v93
    v_lshlrev_b32 v210, 16, v30
    v_and_b32 v211, 0xffff0000, v30
    v_mul_f32 v210, v210, v28
    v_mul_f32 v211, v211, v29
    v_cvt_pk_bf16_f32 v30, v212, v213
    v_lshlrev_b32 v28, 16, v94
    v_and_b32 v29, 0xffff0000, v94
    v_lshlrev_b32 v212, 16, v30
    v_and_b32 v213, 0xffff0000, v30
    v_mul_f32 v212, v212, v28
    v_mul_f32 v213, v213, v29
    v_cvt_pk_bf16_f32 v30, v214, v215
    v_lshlrev_b32 v28, 16, v95
    v_and_b32 v29, 0xffff0000, v95
    v_lshlrev_b32 v214, 16, v30
    v_and_b32 v215, 0xffff0000, v30
    v_mul_f32 v214, v214, v28
    v_mul_f32 v215, v215, v29
    v_cvt_pk_bf16_f32 v30, v216, v217
    v_lshlrev_b32 v28, 16, v96
    v_and_b32 v29, 0xffff0000, v96
    v_lshlrev_b32 v216, 16, v30
    v_and_b32 v217, 0xffff0000, v30
    v_mul_f32 v216, v216, v28
    v_mul_f32 v217, v217, v29
    v_cvt_pk_bf16_f32 v30, v218, v219
    v_lshlrev_b32 v28, 16, v97
    v_and_b32 v29, 0xffff0000, v97
    v_lshlrev_b32 v218, 16, v30
    v_and_b32 v219, 0xffff0000, v30
    v_mul_f32 v218, v218, v28
    v_mul_f32 v219, v219, v29
    v_cvt_pk_bf16_f32 v30, v220, v221
    v_lshlrev_b32 v28, 16, v98
    v_and_b32 v29, 0xffff0000, v98
    v_lshlrev_b32 v220, 16, v30
    v_and_b32 v221, 0xffff0000, v30
    v_mul_f32 v220, v220, v28
    v_mul_f32 v221, v221, v29
    v_cvt_pk_bf16_f32 v30, v222, v223
    v_lshlrev_b32 v28, 16, v99
    v_and_b32 v29, 0xffff0000, v99
    v_lshlrev_b32 v222, 16, v30
    v_and_b32 v223, 0xffff0000, v30
    v_mul_f32 v222, v222, v28
    v_mul_f32 v223, v223, v29
    v_cvt_pk_bf16_f32 v30, v224, v225
    v_lshlrev_b32 v28, 16, v100
    v_and_b32 v29, 0xffff0000, v100
    v_lshlrev_b32 v224, 16, v30
    v_and_b32 v225, 0xffff0000, v30
    v_mul_f32 v224, v224, v28
    v_mul_f32 v225, v225, v29
    v_cvt_pk_bf16_f32 v30, v226, v227
    v_lshlrev_b32 v28, 16, v101
    v_and_b32 v29, 0xffff0000, v101
    v_lshlrev_b32 v226, 16, v30
    v_and_b32 v227, 0xffff0000, v30
    v_mul_f32 v226, v226, v28
    v_mul_f32 v227, v227, v29
    v_cvt_pk_bf16_f32 v30, v228, v229
    v_lshlrev_b32 v28, 16, v102
    v_and_b32 v29, 0xffff0000, v102
    v_lshlrev_b32 v228, 16, v30
    v_and_b32 v229, 0xffff0000, v30
    v_mul_f32 v228, v228, v28
    v_mul_f32 v229, v229, v29
    v_cvt_pk_bf16_f32 v30, v230, v231
    v_lshlrev_b32 v28, 16, v103
    v_and_b32 v29, 0xffff0000, v103
    v_lshlrev_b32 v230, 16, v30
    v_and_b32 v231, 0xffff0000, v30
    v_mul_f32 v230, v230, v28
    v_mul_f32 v231, v231, v29
    v_cvt_pk_bf16_f32 v30, v232, v233
    v_lshlrev_b32 v28, 16, v104
    v_and_b32 v29, 0xffff0000, v104
    v_lshlrev_b32 v232, 16, v30
    v_and_b32 v233, 0xffff0000, v30
    v_mul_f32 v232, v232, v28
    v_mul_f32 v233, v233, v29
    v_cvt_pk_bf16_f32 v30, v234, v235
    v_lshlrev_b32 v28, 16, v105
    v_and_b32 v29, 0xffff0000, v105
    v_lshlrev_b32 v234, 16, v30
    v_and_b32 v235, 0xffff0000, v30
    v_mul_f32 v234, v234, v28
    v_mul_f32 v235, v235, v29
    v_cvt_pk_bf16_f32 v30, v236, v237
    v_lshlrev_b32 v28, 16, v106
    v_and_b32 v29, 0xffff0000, v106
    v_lshlrev_b32 v236, 16, v30
    v_and_b32 v237, 0xffff0000, v30
    v_mul_f32 v236, v236, v28
    v_mul_f32 v237, v237, v29
    v_cvt_pk_bf16_f32 v30, v238, v239
    v_lshlrev_b32 v28, 16, v107
    v_and_b32 v29, 0xffff0000, v107
    v_lshlrev_b32 v238, 16, v30
    v_and_b32 v239, 0xffff0000, v30
    v_mul_f32 v238, v238, v28
    v_mul_f32 v239, v239, v29
    v_cvt_pk_bf16_f32 v30, v240, v241
    v_lshlrev_b32 v28, 16, v108
    v_and_b32 v29, 0xffff0000, v108
    v_lshlrev_b32 v240, 16, v30
    v_and_b32 v241, 0xffff0000, v30
    v_mul_f32 v240, v240, v28
    v_mul_f32 v241, v241, v29
    v_cvt_pk_bf16_f32 v30, v242, v243
    v_lshlrev_b32 v28, 16, v109
    v_and_b32 v29, 0xffff0000, v109
    v_lshlrev_b32 v242, 16, v30
    v_and_b32 v243, 0xffff0000, v30
    v_mul_f32 v242, v242, v28
    v_mul_f32 v243, v243, v29
    v_cvt_pk_bf16_f32 v30, v244, v245
    v_lshlrev_b32 v28, 16, v110
    v_and_b32 v29, 0xffff0000, v110
    v_lshlrev_b32 v244, 16, v30
    v_and_b32 v245, 0xffff0000, v30
    v_mul_f32 v244, v244, v28
    v_mul_f32 v245, v245, v29
    v_cvt_pk_bf16_f32 v30, v246, v247
    v_lshlrev_b32 v28, 16, v111
    v_and_b32 v29, 0xffff0000, v111
    v_lshlrev_b32 v246, 16, v30
    v_and_b32 v247, 0xffff0000, v30
    v_mul_f32 v246, v246, v28
    v_mul_f32 v247, v247, v29
    s_mov_b32 s26, 4096
    v_cvt_pk_bf16_f32 v112, v240, v232
    v_cvt_pk_bf16_f32 v113, v224, v216
    v_cvt_pk_bf16_f32 v114, v208, v200
    v_cvt_pk_bf16_f32 v115, v192, v184
    buffer_store_dwordx4 v[112:115], v31, s[16:19], 0 offen offset:0 sc1
    v_cvt_pk_bf16_f32 v116, v242, v234
    v_cvt_pk_bf16_f32 v117, v226, v218
    v_cvt_pk_bf16_f32 v118, v210, v202
    v_cvt_pk_bf16_f32 v119, v194, v186
    buffer_store_dwordx4 v[116:119], v31, s[16:19], 0 offen offset:1024 sc1
    v_cvt_pk_bf16_f32 v120, v244, v236
    v_cvt_pk_bf16_f32 v121, v228, v220
    v_cvt_pk_bf16_f32 v122, v212, v204
    v_cvt_pk_bf16_f32 v123, v196, v188
    buffer_store_dwordx4 v[120:123], v31, s[16:19], 0 offen offset:2048 sc1
    v_cvt_pk_bf16_f32 v124, v246, v238
    v_cvt_pk_bf16_f32 v125, v230, v222
    v_cvt_pk_bf16_f32 v126, v214, v206
    v_cvt_pk_bf16_f32 v127, v198, v190
    buffer_store_dwordx4 v[124:127], v31, s[16:19], 0 offen offset:3072 sc1
    v_cvt_pk_bf16_f32 v128, v241, v233
    v_cvt_pk_bf16_f32 v129, v225, v217
    v_cvt_pk_bf16_f32 v130, v209, v201
    v_cvt_pk_bf16_f32 v131, v193, v185
    buffer_store_dwordx4 v[128:131], v31, s[16:19], s26 offen offset:0 sc1
    v_cvt_pk_bf16_f32 v132, v243, v235
    v_cvt_pk_bf16_f32 v133, v227, v219
    v_cvt_pk_bf16_f32 v134, v211, v203
    v_cvt_pk_bf16_f32 v135, v195, v187
    buffer_store_dwordx4 v[132:135], v31, s[16:19], s26 offen offset:1024 sc1
    v_cvt_pk_bf16_f32 v136, v245, v237
    v_cvt_pk_bf16_f32 v137, v229, v221
    v_cvt_pk_bf16_f32 v138, v213, v205
    v_cvt_pk_bf16_f32 v139, v197, v189
    buffer_store_dwordx4 v[136:139], v31, s[16:19], s26 offen offset:2048 sc1
    v_cvt_pk_bf16_f32 v140, v247, v239
    v_cvt_pk_bf16_f32 v141, v231, v223
    v_cvt_pk_bf16_f32 v142, v215, v207
    v_cvt_pk_bf16_f32 v143, v199, v191
    buffer_store_dwordx4 v[140:143], v31, s[16:19], s26 offen offset:3072 sc1
    s_add_u32 s36, s36, 320
    s_cmp_lt_u32 s36, 320
    s_cbranch_scc1 L_mn_j1
    s_waitcnt vmcnt(0)
    v_mov_b32 v8, 1
    v_mov_b32 v9, 0
    s_mov_b64 exec, 1
    buffer_store_byte v8, v9, s[96:99], s54 offen sc1
    s_mov_b64 exec, -1
    v_mov_b32 v8, 1
    v_mov_b32 v9, 0
    s_mov_b64 exec, 1
    buffer_store_byte v8, v9, s[96:99], s53 offen sc1
    s_mov_b64 exec, -1
    s_branch L_mn_gemm
L_mn_conv:
    s_waitcnt vmcnt(8)
    s_lshr_b32 s36, s55, 6
    s_lshl_b32 s36, s36, 9
    s_add_u32 s41, s36, 16384
    v_and_b32 v22, 3, v1
    v_lshlrev_b32 v22, 7, v22
    buffer_load_dwordx2 v[24:25], v22, s[96:99], s41 offen sc1
    s_waitcnt vmcnt(0)
    v_mov_b32 v8, 1
    v_mov_b32 v9, 0
    s_mov_b64 exec, 1
    buffer_store_byte v8, v9, s[96:99], s53 offen sc1
    s_mov_b64 exec, -1
    v_mov_b32 v11, 0xffff
    ds_write_b32 v14, v11 offset:0
    s_cmp_ge_u32 s55, 768
    s_cbranch_scc1 L_mn_gate
    s_cmp_ge_u32 s55, 640
    s_cbranch_scc1 L_mn_fin
    s_mul_i32 s40, s32, 9216
    s_add_u32 s40, s40, 4096
    s_cmp_lt_u32 s32, 3
    s_cbranch_scc1 L_mn_conv2
    v_min_u32 v8, 11, v1
    v_mul_u32_u24 v8, 260, v8
    s_mov_b32 s39, 0
L_cv_free:
    ds_read_b32 v9, v8 offset:0
    s_waitcnt lgkmcnt(0)
    v_not_b32 v9, v9
    v_and_b32 v9, 0x4000, v9
    v_cmp_ne_u32 vcc, 0, v9
    s_add_u32 s39, s39, 1
    s_cbranch_vccz L_cv_free_ok
    s_sleep 1
    s_cmp_lt_u32 s39, 65536
    s_cbranch_scc1 L_cv_free
L_cv_free_ok:
    s_mov_b32 s40, 114688
L_mn_conv2:
    v_lshrrev_b32 v20, 2, v20
    v_and_b32 v24, v24, v25
    v_and_b32 v8, v24, v20
    v_and_b32 v8, 0x01010101, v8
    v_cmp_ne_u32 vcc, 0x01010101, v8
    s_cbranch_vccz L_cv_j_ok
    v_lshlrev_b32 v8, 2, v1
    s_mov_b32 s39, 0
L_cv_a:
    buffer_load_dword v9, v8, s[28:31], 0 offen sc1
    s_waitcnt vmcnt(0)
    v_not_b32 v9, v9
    v_and_b32 v9, 0x04040404, v9
    v_cmp_ne_u32 vcc, 0, v9
    s_add_u32 s39, s39, 1
    s_cbranch_vccz L_cv_a_ok
    s_sleep 8
    s_cmp_lt_u32 s39, 65536
    s_cbranch_scc1 L_cv_a
L_cv_a_ok:
    s_mov_b32 s39, 0
L_cv_j:
    buffer_load_dwordx2 v[24:25], v22, s[96:99], s41 offen sc1
    s_waitcnt vmcnt(0)
    v_and_b32 v9, v24, v25
    v_xor_b32 v9, 0x01010101, v9
    v_cmp_ne_u32 vcc, 0, v9
    s_add_u32 s39, s39, 1
    s_cbranch_vccz L_cv_j_ok
    s_sleep 8
    s_cmp_lt_u32 s39, 65536
    s_cbranch_scc1 L_cv_j
L_cv_j_ok:
    s_setprio 3
    s_load_dwordx2 s[16:17], s[0:1], 120
    s_load_dwordx4 s[20:23], s[0:1], 32
    v_lshlrev_b32 v2, 4, v1
    v_mov_b32 v9, 0
    s_lshl_b32 s36, s55, 12
    s_waitcnt lgkmcnt(0)
    s_add_u32 s8, s20, s36
    s_addc_u32 s9, s21, 0
    s_and_b32 s9, s9, 0xffff
    s_mov_b32 s10, 4096
    s_mov_b32 s11, 0x00020000
    s_add_u32 s37, s36, 65011712
    s_add_u32 s4, s16, s37
    s_addc_u32 s5, s17, 0
    s_and_b32 s5, s5, 0xffff
    s_mov_b32 s6, 4096
    s_mov_b32 s7, 0x00020000
    s_add_u32 m0, s40, 4640
    s_add_u32 s37, s36, 54525952
    s_add_u32 s12, s16, s37
    s_addc_u32 s13, s17, 0
    s_and_b32 s13, s13, 0xffff
    s_mov_b32 s14, 4096
    s_mov_b32 s15, 0x00020000
    s_lshr_b32 s36, s55, 1
    s_lshl_b32 s36, s36, 2
    s_load_dword s38, s[22:23], s36
    buffer_load_dwordx4 v2, s[8:11], 0 offen offset:0 lds
    buffer_load_dwordx4 v2, s[8:11], 0 offen offset:1024 lds
    buffer_load_dwordx4 v2, s[8:11], 0 offen offset:2048 lds
    buffer_load_dwordx4 v2, s[8:11], 0 offen offset:3072 lds
    s_add_u32 m0, s40, 0
    s_nop 0
    buffer_load_dwordx4 v2, s[4:7], 0 offen offset:0 sc1 lds
    s_add_u32 m0, s40, 128
    s_nop 0
    buffer_load_dwordx4 v2, s[4:7], 0 offen offset:1024 sc1 lds
    s_add_u32 m0, s40, 256
    s_nop 0
    buffer_load_dwordx4 v2, s[4:7], 0 offen offset:2048 sc1 lds
    s_add_u32 m0, s40, 384
    s_nop 0
    buffer_load_dwordx4 v2, s[4:7], 0 offen offset:3072 sc1 lds
    s_setprio 3
    v_lshrrev_b32 v3, 5, v1
    v_mul_u32_u24 v3, 1152, v3
    v_and_b32 v4, 31, v1
    v_lshl_add_u32 v3, v4, 2, v3
    v_add_u32 v3, s40, v3
    ds_write_b32 v3, v9 offset:1024
    ds_write_b32 v3, v9 offset:3328
    v_and_b32 v4, 7, v1
    v_lshlrev_b32 v4, 2, v4
    v_add_u32 v4, s40, v4
    ds_write_b32 v4, v9 offset:4608
    v_lshrrev_b32 v2, 4, v1
    v_lshlrev_b32 v2, 3, v2
    v_bfe_u32 v3, v1, 2, 2
    v_and_b32 v5, 3, v1
    v_add3_u32 v2, v2, v3, v5
    v_lshlrev_b32 v2, 3, v2
    v_add_u32 v6, s40, v2
    v_and_b32 v3, 15, v1
    v_lshlrev_b32 v3, 3, v3
    v_lshrrev_b32 v5, 4, v1
    v_lshlrev_b32 v4, 4, v5
    v_sub_u32 v4, v4, v3
    s_add_u32 s36, s40, 120
    v_add_u32 v7, s36, v4
    v_lshl_add_u32 v3, v5, 1, v3
    s_add_u32 s36, s40, 126
    v_sub_u32 v8, s36, v3
    v_lshlrev_b32 v5, 2, v3
    v_mov_b32 v112, 0
    v_mov_b32 v113, 0
    v_mov_b32 v118, 0
    v_mov_b32 v119, 0
    v_mov_b32 v124, 0
    v_mov_b32 v125, 0
    v_mov_b32 v130, 0
    v_mov_b32 v131, 0
    v_mov_b32 v136, 0
    v_mov_b32 v137, 0
    v_mov_b32 v142, 0
    v_mov_b32 v143, 0
    v_mov_b32 v148, 0
    v_mov_b32 v149, 0
    v_mov_b32 v154, 0
    v_mov_b32 v155, 0
    v_mov_b32 v160, 0
    v_mov_b32 v161, 0
    v_mov_b32 v166, 0
    v_mov_b32 v167, 0
    v_mov_b32 v172, 0
    v_mov_b32 v173, 0
    v_mov_b32 v178, 0
    v_mov_b32 v179, 0
    v_mov_b32 v184, 0
    v_mov_b32 v185, 0
    v_mov_b32 v190, 0
    v_mov_b32 v191, 0
    v_mov_b32 v196, 0
    v_mov_b32 v197, 0
    v_mov_b32 v202, 0
    v_mov_b32 v203, 0
    s_waitcnt vmcnt(0) lgkmcnt(0)
    s_bitcmp1_b32 s55, 0
    s_cselect_b32 s36, 0, 16
    s_lshl_b32 s38, s38, s36
    s_and_b32 s38, s38, 0xffff0000
    ds_read_b64 v[76:77], v7 offset:960
    ds_read_b64 v[78:79], v7 offset:968
    ds_read_b64_tr_b16 v[16:17], v6 offset:4872
    ds_read_b64_tr_b16 v[18:19], v6 offset:4904
    ds_read_b64_tr_b16 v[24:25], v6 offset:5384
    ds_read_b64_tr_b16 v[26:27], v6 offset:5416
    ds_read_b64_tr_b16 v[32:33], v6 offset:5896
    ds_read_b64_tr_b16 v[34:35], v6 offset:5928
    ds_read_b64_tr_b16 v[40:41], v6 offset:6408
    ds_read_b64_tr_b16 v[42:43], v6 offset:6440
    ds_read_b64_tr_b16 v[48:49], v6 offset:6920
    ds_read_b64_tr_b16 v[50:51], v6 offset:6952
    ds_read_b64_tr_b16 v[56:57], v6 offset:7432
    ds_read_b64_tr_b16 v[58:59], v6 offset:7464
    ds_read_b64_tr_b16 v[64:65], v6 offset:7944
    ds_read_b64_tr_b16 v[66:67], v6 offset:7976
    ds_read_b64_tr_b16 v[72:73], v6 offset:8456
    ds_read_b64_tr_b16 v[74:75], v6 offset:8488
    ds_read_b64_tr_b16 v[12:13], v6 offset:4616
    ds_read_b64_tr_b16 v[14:15], v6 offset:4648
    ds_read_b64_tr_b16 v[20:21], v6 offset:5128
    ds_read_b64_tr_b16 v[22:23], v6 offset:5160
    ds_read_b64_tr_b16 v[28:29], v6 offset:5640
    ds_read_b64_tr_b16 v[30:31], v6 offset:5672
    ds_read_b64_tr_b16 v[36:37], v6 offset:6152
    ds_read_b64_tr_b16 v[38:39], v6 offset:6184
    ds_read_b64_tr_b16 v[44:45], v6 offset:6664
    ds_read_b64_tr_b16 v[46:47], v6 offset:6696
    ds_read_b64_tr_b16 v[52:53], v6 offset:7176
    ds_read_b64_tr_b16 v[54:55], v6 offset:7208
    ds_read_b64_tr_b16 v[60:61], v6 offset:7688
    ds_read_b64_tr_b16 v[62:63], v6 offset:7720
    ds_read_b64_tr_b16 v[68:69], v6 offset:8200
    ds_read_b64_tr_b16 v[70:71], v6 offset:8232
    ds_read_b64 v[80:81], v7 offset:896
    ds_read_b64 v[82:83], v7 offset:904
    ds_read_b64 v[84:85], v7 offset:832
    ds_read_b64 v[86:87], v7 offset:840
    ds_read_b64 v[88:89], v7 offset:768
    ds_read_b64 v[90:91], v7 offset:776
    ds_read_b64 v[92:93], v7 offset:704
    ds_read_b64 v[94:95], v7 offset:712
    ds_read_b64 v[96:97], v7 offset:640
    ds_read_b64 v[98:99], v7 offset:648
    ds_read_b64 v[100:101], v7 offset:576
    ds_read_b64 v[102:103], v7 offset:584
    s_waitcnt lgkmcnt(15)
    v_mfma_f32_16x16x32_bf16 v[108:111], v[16:19], v[76:79], 0
    ds_read_b64 v[104:105], v7 offset:512
    ds_read_b64 v[106:107], v7 offset:520
    v_mfma_f32_16x16x32_bf16 v[114:117], v[24:27], v[76:79], 0
    v_mfma_f32_16x16x32_bf16 v[120:123], v[32:35], v[76:79], 0
    v_mfma_f32_16x16x32_bf16 v[126:129], v[40:43], v[76:79], 0
    v_mfma_f32_16x16x32_bf16 v[132:135], v[48:51], v[76:79], 0
    v_mfma_f32_16x16x32_bf16 v[138:141], v[56:59], v[76:79], 0
    v_mfma_f32_16x16x32_bf16 v[144:147], v[64:67], v[76:79], 0
    v_mfma_f32_16x16x32_bf16 v[150:153], v[72:75], v[76:79], 0
    s_waitcnt lgkmcnt(12)
    v_mfma_f32_16x16x32_bf16 v[108:111], v[12:15], v[80:83], v[108:111]
    ds_read_b64 v[76:77], v7 offset:448
    ds_read_b64 v[78:79], v7 offset:456
    v_mfma_f32_16x16x32_bf16 v[114:117], v[20:23], v[80:83], v[114:117]
    v_mfma_f32_16x16x32_bf16 v[120:123], v[28:31], v[80:83], v[120:123]
    v_mfma_f32_16x16x32_bf16 v[126:129], v[36:39], v[80:83], v[126:129]
    v_mfma_f32_16x16x32_bf16 v[132:135], v[44:47], v[80:83], v[132:135]
    v_mfma_f32_16x16x32_bf16 v[138:141], v[52:55], v[80:83], v[138:141]
    v_mfma_f32_16x16x32_bf16 v[144:147], v[60:63], v[80:83], v[144:147]
    v_mfma_f32_16x16x32_bf16 v[150:153], v[68:71], v[80:83], v[150:153]
    s_waitcnt lgkmcnt(12)
    v_mfma_f32_16x16x32_bf16 v[114:117], v[16:19], v[84:87], v[114:117]
    ds_read_b64 v[80:81], v7 offset:384
    ds_read_b64 v[82:83], v7 offset:392
    v_mfma_f32_16x16x32_bf16 v[120:123], v[24:27], v[84:87], v[120:123]
    v_mfma_f32_16x16x32_bf16 v[126:129], v[32:35], v[84:87], v[126:129]
    v_mfma_f32_16x16x32_bf16 v[132:135], v[40:43], v[84:87], v[132:135]
    v_mfma_f32_16x16x32_bf16 v[138:141], v[48:51], v[84:87], v[138:141]
    v_mfma_f32_16x16x32_bf16 v[144:147], v[56:59], v[84:87], v[144:147]
    v_mfma_f32_16x16x32_bf16 v[150:153], v[64:67], v[84:87], v[150:153]
    s_waitcnt lgkmcnt(12)
    v_mfma_f32_16x16x32_bf16 v[114:117], v[12:15], v[88:91], v[114:117]
    ds_read_b64 v[84:85], v7 offset:320
    ds_read_b64 v[86:87], v7 offset:328
    v_mfma_f32_16x16x32_bf16 v[120:123], v[20:23], v[88:91], v[120:123]
    v_mfma_f32_16x16x32_bf16 v[126:129], v[28:31], v[88:91], v[126:129]
    v_mfma_f32_16x16x32_bf16 v[132:135], v[36:39], v[88:91], v[132:135]
    v_mfma_f32_16x16x32_bf16 v[138:141], v[44:47], v[88:91], v[138:141]
    v_mfma_f32_16x16x32_bf16 v[144:147], v[52:55], v[88:91], v[144:147]
    v_mfma_f32_16x16x32_bf16 v[150:153], v[60:63], v[88:91], v[150:153]
    s_waitcnt lgkmcnt(12)
    v_mfma_f32_16x16x32_bf16 v[120:123], v[16:19], v[92:95], v[120:123]
    ds_read_b64 v[88:89], v7 offset:256
    ds_read_b64 v[90:91], v7 offset:264
    v_mfma_f32_16x16x32_bf16 v[126:129], v[24:27], v[92:95], v[126:129]
    v_mfma_f32_16x16x32_bf16 v[132:135], v[32:35], v[92:95], v[132:135]
    v_mfma_f32_16x16x32_bf16 v[138:141], v[40:43], v[92:95], v[138:141]
    v_mfma_f32_16x16x32_bf16 v[144:147], v[48:51], v[92:95], v[144:147]
    v_mfma_f32_16x16x32_bf16 v[150:153], v[56:59], v[92:95], v[150:153]
    s_waitcnt lgkmcnt(12)
    v_mfma_f32_16x16x32_bf16 v[120:123], v[12:15], v[96:99], v[120:123]
    ds_read_b64 v[92:93], v7 offset:192
    ds_read_b64 v[94:95], v7 offset:200
    v_mfma_f32_16x16x32_bf16 v[126:129], v[20:23], v[96:99], v[126:129]
    v_mfma_f32_16x16x32_bf16 v[132:135], v[28:31], v[96:99], v[132:135]
    v_mfma_f32_16x16x32_bf16 v[138:141], v[36:39], v[96:99], v[138:141]
    v_mfma_f32_16x16x32_bf16 v[144:147], v[44:47], v[96:99], v[144:147]
    v_mfma_f32_16x16x32_bf16 v[150:153], v[52:55], v[96:99], v[150:153]
    s_waitcnt lgkmcnt(12)
    v_mfma_f32_16x16x32_bf16 v[126:129], v[16:19], v[100:103], v[126:129]
    ds_read_b64 v[96:97], v7 offset:128
    ds_read_b64 v[98:99], v7 offset:136
    v_mfma_f32_16x16x32_bf16 v[132:135], v[24:27], v[100:103], v[132:135]
    v_mfma_f32_16x16x32_bf16 v[138:141], v[32:35], v[100:103], v[138:141]
    v_mfma_f32_16x16x32_bf16 v[144:147], v[40:43], v[100:103], v[144:147]
    v_mfma_f32_16x16x32_bf16 v[150:153], v[48:51], v[100:103], v[150:153]
    s_waitcnt lgkmcnt(12)
    v_mfma_f32_16x16x32_bf16 v[126:129], v[12:15], v[104:107], v[126:129]
    ds_read_b64 v[100:101], v7 offset:64
    ds_read_b64 v[102:103], v7 offset:72
    v_mfma_f32_16x16x32_bf16 v[132:135], v[20:23], v[104:107], v[132:135]
    v_mfma_f32_16x16x32_bf16 v[138:141], v[28:31], v[104:107], v[138:141]
    v_mfma_f32_16x16x32_bf16 v[144:147], v[36:39], v[104:107], v[144:147]
    v_mfma_f32_16x16x32_bf16 v[150:153], v[44:47], v[104:107], v[150:153]
    s_waitcnt lgkmcnt(12)
    v_mfma_f32_16x16x32_bf16 v[132:135], v[16:19], v[76:79], v[132:135]
    ds_read_b64 v[104:105], v7 offset:0
    ds_read_b64 v[106:107], v7 offset:8
    v_mfma_f32_16x16x32_bf16 v[138:141], v[24:27], v[76:79], v[138:141]
    v_mfma_f32_16x16x32_bf16 v[144:147], v[32:35], v[76:79], v[144:147]
    v_mfma_f32_16x16x32_bf16 v[150:153], v[40:43], v[76:79], v[150:153]
    s_waitcnt lgkmcnt(12)
    v_mfma_f32_16x16x32_bf16 v[132:135], v[12:15], v[80:83], v[132:135]
    ds_read_b64 v[76:77], v7 offset:2112
    ds_read_b64 v[78:79], v7 offset:2120
    v_mfma_f32_16x16x32_bf16 v[138:141], v[20:23], v[80:83], v[138:141]
    v_mfma_f32_16x16x32_bf16 v[144:147], v[28:31], v[80:83], v[144:147]
    v_mfma_f32_16x16x32_bf16 v[150:153], v[36:39], v[80:83], v[150:153]
    s_waitcnt lgkmcnt(12)
    v_mfma_f32_16x16x32_bf16 v[138:141], v[16:19], v[84:87], v[138:141]
    ds_read_b64 v[80:81], v7 offset:2048
    ds_read_b64 v[82:83], v7 offset:2056
    v_mfma_f32_16x16x32_bf16 v[144:147], v[24:27], v[84:87], v[144:147]
    v_mfma_f32_16x16x32_bf16 v[150:153], v[32:35], v[84:87], v[150:153]
    s_waitcnt lgkmcnt(12)
    v_mfma_f32_16x16x32_bf16 v[138:141], v[12:15], v[88:91], v[138:141]
    ds_read_b64 v[84:85], v7 offset:1984
    ds_read_b64 v[86:87], v7 offset:1992
    v_mfma_f32_16x16x32_bf16 v[144:147], v[20:23], v[88:91], v[144:147]
    v_mfma_f32_16x16x32_bf16 v[150:153], v[28:31], v[88:91], v[150:153]
    s_waitcnt lgkmcnt(12)
    v_mfma_f32_16x16x32_bf16 v[144:147], v[16:19], v[92:95], v[144:147]
    ds_read_b64 v[88:89], v7 offset:1920
    ds_read_b64 v[90:91], v7 offset:1928
    v_mfma_f32_16x16x32_bf16 v[150:153], v[24:27], v[92:95], v[150:153]
    s_waitcnt lgkmcnt(12)
    v_mfma_f32_16x16x32_bf16 v[144:147], v[12:15], v[96:99], v[144:147]
    ds_read_b64 v[92:93], v7 offset:1856
    ds_read_b64 v[94:95], v7 offset:1864
    v_mfma_f32_16x16x32_bf16 v[150:153], v[20:23], v[96:99], v[150:153]
    s_waitcnt lgkmcnt(12)
    v_mfma_f32_16x16x32_bf16 v[150:153], v[16:19], v[100:103], v[150:153]
    ds_read_b64 v[96:97], v7 offset:1792
    ds_read_b64 v[98:99], v7 offset:1800
    s_waitcnt lgkmcnt(12)
    v_mfma_f32_16x16x32_bf16 v[150:153], v[12:15], v[104:107], v[150:153]
    ds_read_b64 v[100:101], v7 offset:1728
    ds_read_b64 v[102:103], v7 offset:1736
    s_waitcnt lgkmcnt(12)
    v_mfma_f32_16x16x32_bf16 v[156:159], v[16:19], v[76:79], 0
    ds_read_b64 v[104:105], v7 offset:1664
    ds_read_b64 v[106:107], v7 offset:1672
    v_mfma_f32_16x16x32_bf16 v[162:165], v[24:27], v[76:79], 0
    ds_read_u16 v204, v8 offset:896
    v_mfma_f32_16x16x32_bf16 v[168:171], v[32:35], v[76:79], 0
    ds_read_u16 v205, v8 offset:2048
    v_mfma_f32_16x16x32_bf16 v[174:177], v[40:43], v[76:79], 0
    ds_read_u16 v206, v8 offset:3200
    v_mfma_f32_16x16x32_bf16 v[180:183], v[48:51], v[76:79], 0
    ds_read_u16 v207, v8 offset:4352
    v_mfma_f32_16x16x32_bf16 v[186:189], v[56:59], v[76:79], 0
    ds_read_u16 v208, v8 offset:768
    v_mfma_f32_16x16x32_bf16 v[192:195], v[64:67], v[76:79], 0
    ds_read_u16 v209, v8 offset:1920
    v_mfma_f32_16x16x32_bf16 v[198:201], v[72:75], v[76:79], 0
    ds_read_u16 v210, v8 offset:3072
    s_waitcnt lgkmcnt(15)
    v_mfma_f32_16x16x32_bf16 v[156:159], v[12:15], v[80:83], v[156:159]
    ds_read_b64 v[76:77], v7 offset:1600
    ds_read_b64 v[78:79], v7 offset:1608
    v_mfma_f32_16x16x32_bf16 v[162:165], v[20:23], v[80:83], v[162:165]
    ds_read_u16 v211, v8 offset:4224
    v_mfma_f32_16x16x32_bf16 v[168:171], v[28:31], v[80:83], v[168:171]
    ds_read_u16 v212, v8 offset:640
    v_mfma_f32_16x16x32_bf16 v[174:177], v[36:39], v[80:83], v[174:177]
    ds_read_u16 v213, v8 offset:1792
    v_mfma_f32_16x16x32_bf16 v[180:183], v[44:47], v[80:83], v[180:183]
    ds_read_u16 v214, v8 offset:2944
    v_mfma_f32_16x16x32_bf16 v[186:189], v[52:55], v[80:83], v[186:189]
    ds_read_u16 v215, v8 offset:4096
    v_mfma_f32_16x16x32_bf16 v[192:195], v[60:63], v[80:83], v[192:195]
    ds_read_u16 v216, v8 offset:512
    v_mfma_f32_16x16x32_bf16 v[198:201], v[68:71], v[80:83], v[198:201]
    ds_read_u16 v217, v8 offset:1664
    v_mfma_f32_16x16x32_bf16 v[162:165], v[16:19], v[84:87], v[162:165]
    ds_read_b64 v[80:81], v7 offset:1536
    ds_read_b64 v[82:83], v7 offset:1544
    v_mfma_f32_16x16x32_bf16 v[168:171], v[24:27], v[84:87], v[168:171]
    ds_read_u16 v218, v8 offset:2816
    v_mfma_f32_16x16x32_bf16 v[174:177], v[32:35], v[84:87], v[174:177]
    ds_read_u16 v219, v8 offset:3968
    v_mfma_f32_16x16x32_bf16 v[180:183], v[40:43], v[84:87], v[180:183]
    ds_read_u16 v220, v8 offset:384
    v_mfma_f32_16x16x32_bf16 v[186:189], v[48:51], v[84:87], v[186:189]
    ds_read_u16 v221, v8 offset:1536
    v_mfma_f32_16x16x32_bf16 v[192:195], v[56:59], v[84:87], v[192:195]
    ds_read_u16 v222, v8 offset:2688
    v_mfma_f32_16x16x32_bf16 v[198:201], v[64:67], v[84:87], v[198:201]
    ds_read_u16 v223, v8 offset:3840
    v_mfma_f32_16x16x32_bf16 v[162:165], v[12:15], v[88:91], v[162:165]
    ds_read_b64 v[84:85], v7 offset:1472
    ds_read_b64 v[86:87], v7 offset:1480
    v_mfma_f32_16x16x32_bf16 v[168:171], v[20:23], v[88:91], v[168:171]
    ds_read_u16 v224, v8 offset:256
    v_mfma_f32_16x16x32_bf16 v[174:177], v[28:31], v[88:91], v[174:177]
    ds_read_u16 v225, v8 offset:1408
    v_mfma_f32_16x16x32_bf16 v[180:183], v[36:39], v[88:91], v[180:183]
    ds_read_u16 v226, v8 offset:2560
    v_mfma_f32_16x16x32_bf16 v[186:189], v[44:47], v[88:91], v[186:189]
    ds_read_u16 v227, v8 offset:3712
    v_mfma_f32_16x16x32_bf16 v[192:195], v[52:55], v[88:91], v[192:195]
    ds_read_u16 v228, v8 offset:128
    v_mfma_f32_16x16x32_bf16 v[198:201], v[60:63], v[88:91], v[198:201]
    ds_read_u16 v229, v8 offset:1280
    s_waitcnt lgkmcnt(15)
    v_mfma_f32_16x16x32_bf16 v[168:171], v[16:19], v[92:95], v[168:171]
    ds_read_b64 v[88:89], v7 offset:1408
    ds_read_b64 v[90:91], v7 offset:1416
    v_mfma_f32_16x16x32_bf16 v[174:177], v[24:27], v[92:95], v[174:177]
    ds_read_u16 v230, v8 offset:2432
    v_mfma_f32_16x16x32_bf16 v[180:183], v[32:35], v[92:95], v[180:183]
    ds_read_u16 v231, v8 offset:3584
    v_mfma_f32_16x16x32_bf16 v[186:189], v[40:43], v[92:95], v[186:189]
    ds_read_u16 v232, v8 offset:0
    v_mfma_f32_16x16x32_bf16 v[192:195], v[48:51], v[92:95], v[192:195]
    ds_read_u16 v233, v8 offset:1152
    v_mfma_f32_16x16x32_bf16 v[198:201], v[56:59], v[92:95], v[198:201]
    ds_read_u16 v234, v8 offset:2304
    v_mfma_f32_16x16x32_bf16 v[168:171], v[12:15], v[96:99], v[168:171]
    ds_read_b64 v[92:93], v7 offset:1344
    ds_read_b64 v[94:95], v7 offset:1352
    v_mfma_f32_16x16x32_bf16 v[174:177], v[20:23], v[96:99], v[174:177]
    ds_read_u16 v235, v8 offset:3456
    v_mfma_f32_16x16x32_bf16 v[180:183], v[28:31], v[96:99], v[180:183]
    v_mfma_f32_16x16x32_bf16 v[186:189], v[36:39], v[96:99], v[186:189]
    v_mfma_f32_16x16x32_bf16 v[192:195], v[44:47], v[96:99], v[192:195]
    v_mfma_f32_16x16x32_bf16 v[198:201], v[52:55], v[96:99], v[198:201]
    v_mfma_f32_16x16x32_bf16 v[174:177], v[16:19], v[100:103], v[174:177]
    ds_read_b64 v[96:97], v7 offset:1280
    ds_read_b64 v[98:99], v7 offset:1288
    v_mfma_f32_16x16x32_bf16 v[180:183], v[24:27], v[100:103], v[180:183]
    v_mfma_f32_16x16x32_bf16 v[186:189], v[32:35], v[100:103], v[186:189]
    v_mfma_f32_16x16x32_bf16 v[192:195], v[40:43], v[100:103], v[192:195]
    v_mfma_f32_16x16x32_bf16 v[198:201], v[48:51], v[100:103], v[198:201]
    v_mfma_f32_16x16x32_bf16 v[174:177], v[12:15], v[104:107], v[174:177]
    ds_read_b64 v[100:101], v7 offset:1216
    ds_read_b64 v[102:103], v7 offset:1224
    v_mfma_f32_16x16x32_bf16 v[180:183], v[20:23], v[104:107], v[180:183]
    v_mfma_f32_16x16x32_bf16 v[186:189], v[28:31], v[104:107], v[186:189]
    v_mfma_f32_16x16x32_bf16 v[192:195], v[36:39], v[104:107], v[192:195]
    v_mfma_f32_16x16x32_bf16 v[198:201], v[44:47], v[104:107], v[198:201]
    v_mfma_f32_16x16x32_bf16 v[180:183], v[16:19], v[76:79], v[180:183]
    ds_read_b64 v[104:105], v7 offset:1152
    ds_read_b64 v[106:107], v7 offset:1160
    v_mfma_f32_16x16x32_bf16 v[186:189], v[24:27], v[76:79], v[186:189]
    v_mfma_f32_16x16x32_bf16 v[192:195], v[32:35], v[76:79], v[192:195]
    v_mfma_f32_16x16x32_bf16 v[198:201], v[40:43], v[76:79], v[198:201]
    s_waitcnt lgkmcnt(15)
    v_mfma_f32_16x16x32_bf16 v[180:183], v[12:15], v[80:83], v[180:183]
    ds_read_b64 v[76:77], v7 offset:3264
    ds_read_b64 v[78:79], v7 offset:3272
    v_mfma_f32_16x16x32_bf16 v[186:189], v[20:23], v[80:83], v[186:189]
    v_mfma_f32_16x16x32_bf16 v[192:195], v[28:31], v[80:83], v[192:195]
    v_mfma_f32_16x16x32_bf16 v[198:201], v[36:39], v[80:83], v[198:201]
    v_mfma_f32_16x16x32_bf16 v[186:189], v[16:19], v[84:87], v[186:189]
    ds_read_b64 v[80:81], v7 offset:3200
    ds_read_b64 v[82:83], v7 offset:3208
    v_mfma_f32_16x16x32_bf16 v[192:195], v[24:27], v[84:87], v[192:195]
    v_mfma_f32_16x16x32_bf16 v[198:201], v[32:35], v[84:87], v[198:201]
    s_waitcnt lgkmcnt(15)
    v_mfma_f32_16x16x32_bf16 v[186:189], v[12:15], v[88:91], v[186:189]
    ds_read_b64 v[84:85], v7 offset:3136
    ds_read_b64 v[86:87], v7 offset:3144
    v_mfma_f32_16x16x32_bf16 v[192:195], v[20:23], v[88:91], v[192:195]
    v_mfma_f32_16x16x32_bf16 v[198:201], v[28:31], v[88:91], v[198:201]
    s_waitcnt lgkmcnt(13)
    v_mfma_f32_16x16x32_bf16 v[192:195], v[16:19], v[92:95], v[192:195]
    ds_read_b64 v[88:89], v7 offset:3072
    ds_read_b64 v[90:91], v7 offset:3080
    v_mfma_f32_16x16x32_bf16 v[198:201], v[24:27], v[92:95], v[198:201]
    s_waitcnt lgkmcnt(12)
    v_mfma_f32_16x16x32_bf16 v[192:195], v[12:15], v[96:99], v[192:195]
    ds_read_b64 v[92:93], v7 offset:3008
    ds_read_b64 v[94:95], v7 offset:3016
    v_mfma_f32_16x16x32_bf16 v[198:201], v[20:23], v[96:99], v[198:201]
    s_waitcnt lgkmcnt(12)
    v_mfma_f32_16x16x32_bf16 v[198:201], v[16:19], v[100:103], v[198:201]
    ds_read_b64 v[96:97], v7 offset:2944
    ds_read_b64 v[98:99], v7 offset:2952
    s_waitcnt lgkmcnt(12)
    v_mfma_f32_16x16x32_bf16 v[198:201], v[12:15], v[104:107], v[198:201]
    ds_read_b64 v[100:101], v7 offset:2880
    ds_read_b64 v[102:103], v7 offset:2888
    s_waitcnt lgkmcnt(12)
    v_mfma_f32_16x16x32_bf16 v[110:113], v[16:19], v[76:79], v[110:113]
    ds_read_b64 v[104:105], v7 offset:2816
    ds_read_b64 v[106:107], v7 offset:2824
    v_mfma_f32_16x16x32_bf16 v[116:119], v[24:27], v[76:79], v[116:119]
    v_mfma_f32_16x16x32_bf16 v[122:125], v[32:35], v[76:79], v[122:125]
    v_mfma_f32_16x16x32_bf16 v[128:131], v[40:43], v[76:79], v[128:131]
    v_mfma_f32_16x16x32_bf16 v[134:137], v[48:51], v[76:79], v[134:137]
    v_mfma_f32_16x16x32_bf16 v[140:143], v[56:59], v[76:79], v[140:143]
    v_mfma_f32_16x16x32_bf16 v[146:149], v[64:67], v[76:79], v[146:149]
    v_mfma_f32_16x16x32_bf16 v[152:155], v[72:75], v[76:79], v[152:155]
    s_waitcnt lgkmcnt(12)
    v_mfma_f32_16x16x32_bf16 v[110:113], v[12:15], v[80:83], v[110:113]
    ds_read_b64 v[76:77], v7 offset:2752
    ds_read_b64 v[78:79], v7 offset:2760
    v_mfma_f32_16x16x32_bf16 v[116:119], v[20:23], v[80:83], v[116:119]
    v_mfma_f32_16x16x32_bf16 v[122:125], v[28:31], v[80:83], v[122:125]
    v_mfma_f32_16x16x32_bf16 v[128:131], v[36:39], v[80:83], v[128:131]
    v_mfma_f32_16x16x32_bf16 v[134:137], v[44:47], v[80:83], v[134:137]
    v_mfma_f32_16x16x32_bf16 v[140:143], v[52:55], v[80:83], v[140:143]
    v_mfma_f32_16x16x32_bf16 v[146:149], v[60:63], v[80:83], v[146:149]
    v_mfma_f32_16x16x32_bf16 v[152:155], v[68:71], v[80:83], v[152:155]
    s_waitcnt lgkmcnt(12)
    v_mfma_f32_16x16x32_bf16 v[116:119], v[16:19], v[84:87], v[116:119]
    ds_read_b64 v[80:81], v7 offset:2688
    ds_read_b64 v[82:83], v7 offset:2696
    v_mfma_f32_16x16x32_bf16 v[122:125], v[24:27], v[84:87], v[122:125]
    v_mfma_f32_16x16x32_bf16 v[128:131], v[32:35], v[84:87], v[128:131]
    v_mfma_f32_16x16x32_bf16 v[134:137], v[40:43], v[84:87], v[134:137]
    v_mfma_f32_16x16x32_bf16 v[140:143], v[48:51], v[84:87], v[140:143]
    v_mfma_f32_16x16x32_bf16 v[146:149], v[56:59], v[84:87], v[146:149]
    v_mfma_f32_16x16x32_bf16 v[152:155], v[64:67], v[84:87], v[152:155]
    s_waitcnt lgkmcnt(12)
    v_mfma_f32_16x16x32_bf16 v[116:119], v[12:15], v[88:91], v[116:119]
    ds_read_b64 v[84:85], v7 offset:2624
    ds_read_b64 v[86:87], v7 offset:2632
    v_mfma_f32_16x16x32_bf16 v[122:125], v[20:23], v[88:91], v[122:125]
    v_mfma_f32_16x16x32_bf16 v[128:131], v[28:31], v[88:91], v[128:131]
    v_mfma_f32_16x16x32_bf16 v[134:137], v[36:39], v[88:91], v[134:137]
    v_mfma_f32_16x16x32_bf16 v[140:143], v[44:47], v[88:91], v[140:143]
    v_mfma_f32_16x16x32_bf16 v[146:149], v[52:55], v[88:91], v[146:149]
    v_mfma_f32_16x16x32_bf16 v[152:155], v[60:63], v[88:91], v[152:155]
    s_waitcnt lgkmcnt(12)
    v_mfma_f32_16x16x32_bf16 v[122:125], v[16:19], v[92:95], v[122:125]
    ds_read_b64 v[88:89], v7 offset:2560
    ds_read_b64 v[90:91], v7 offset:2568
    v_mfma_f32_16x16x32_bf16 v[128:131], v[24:27], v[92:95], v[128:131]
    v_mfma_f32_16x16x32_bf16 v[134:137], v[32:35], v[92:95], v[134:137]
    v_mfma_f32_16x16x32_bf16 v[140:143], v[40:43], v[92:95], v[140:143]
    v_mfma_f32_16x16x32_bf16 v[146:149], v[48:51], v[92:95], v[146:149]
    v_mfma_f32_16x16x32_bf16 v[152:155], v[56:59], v[92:95], v[152:155]
    s_waitcnt lgkmcnt(12)
    v_mfma_f32_16x16x32_bf16 v[122:125], v[12:15], v[96:99], v[122:125]
    ds_read_b64 v[92:93], v7 offset:2496
    ds_read_b64 v[94:95], v7 offset:2504
    v_mfma_f32_16x16x32_bf16 v[128:131], v[20:23], v[96:99], v[128:131]
    v_mfma_f32_16x16x32_bf16 v[134:137], v[28:31], v[96:99], v[134:137]
    v_mfma_f32_16x16x32_bf16 v[140:143], v[36:39], v[96:99], v[140:143]
    v_mfma_f32_16x16x32_bf16 v[146:149], v[44:47], v[96:99], v[146:149]
    v_mfma_f32_16x16x32_bf16 v[152:155], v[52:55], v[96:99], v[152:155]
    s_waitcnt lgkmcnt(12)
    v_mfma_f32_16x16x32_bf16 v[128:131], v[16:19], v[100:103], v[128:131]
    ds_read_b64 v[96:97], v7 offset:2432
    ds_read_b64 v[98:99], v7 offset:2440
    v_mfma_f32_16x16x32_bf16 v[134:137], v[24:27], v[100:103], v[134:137]
    v_mfma_f32_16x16x32_bf16 v[140:143], v[32:35], v[100:103], v[140:143]
    v_mfma_f32_16x16x32_bf16 v[146:149], v[40:43], v[100:103], v[146:149]
    v_mfma_f32_16x16x32_bf16 v[152:155], v[48:51], v[100:103], v[152:155]
    s_waitcnt lgkmcnt(12)
    v_mfma_f32_16x16x32_bf16 v[128:131], v[12:15], v[104:107], v[128:131]
    ds_read_b64 v[100:101], v7 offset:2368
    ds_read_b64 v[102:103], v7 offset:2376
    v_mfma_f32_16x16x32_bf16 v[134:137], v[20:23], v[104:107], v[134:137]
    v_mfma_f32_16x16x32_bf16 v[140:143], v[28:31], v[104:107], v[140:143]
    v_mfma_f32_16x16x32_bf16 v[146:149], v[36:39], v[104:107], v[146:149]
    v_mfma_f32_16x16x32_bf16 v[152:155], v[44:47], v[104:107], v[152:155]
    s_waitcnt lgkmcnt(12)
    v_mfma_f32_16x16x32_bf16 v[134:137], v[16:19], v[76:79], v[134:137]
    ds_read_b64 v[104:105], v7 offset:2304
    ds_read_b64 v[106:107], v7 offset:2312
    v_mfma_f32_16x16x32_bf16 v[140:143], v[24:27], v[76:79], v[140:143]
    v_mfma_f32_16x16x32_bf16 v[146:149], v[32:35], v[76:79], v[146:149]
    v_mfma_f32_16x16x32_bf16 v[152:155], v[40:43], v[76:79], v[152:155]
    s_waitcnt lgkmcnt(12)
    v_mfma_f32_16x16x32_bf16 v[134:137], v[12:15], v[80:83], v[134:137]
    ds_read_b64 v[76:77], v7 offset:4416
    ds_read_b64 v[78:79], v7 offset:4424
    v_mfma_f32_16x16x32_bf16 v[140:143], v[20:23], v[80:83], v[140:143]
    v_mfma_f32_16x16x32_bf16 v[146:149], v[28:31], v[80:83], v[146:149]
    v_mfma_f32_16x16x32_bf16 v[152:155], v[36:39], v[80:83], v[152:155]
    s_waitcnt lgkmcnt(12)
    v_mfma_f32_16x16x32_bf16 v[140:143], v[16:19], v[84:87], v[140:143]
    ds_read_b64 v[80:81], v7 offset:4352
    ds_read_b64 v[82:83], v7 offset:4360
    v_mfma_f32_16x16x32_bf16 v[146:149], v[24:27], v[84:87], v[146:149]
    v_mfma_f32_16x16x32_bf16 v[152:155], v[32:35], v[84:87], v[152:155]
    s_waitcnt lgkmcnt(12)
    v_mfma_f32_16x16x32_bf16 v[140:143], v[12:15], v[88:91], v[140:143]
    ds_read_b64 v[84:85], v7 offset:4288
    ds_read_b64 v[86:87], v7 offset:4296
    v_mfma_f32_16x16x32_bf16 v[146:149], v[20:23], v[88:91], v[146:149]
    v_mfma_f32_16x16x32_bf16 v[152:155], v[28:31], v[88:91], v[152:155]
    s_waitcnt lgkmcnt(12)
    v_mfma_f32_16x16x32_bf16 v[146:149], v[16:19], v[92:95], v[146:149]
    ds_read_b64 v[88:89], v7 offset:4224
    ds_read_b64 v[90:91], v7 offset:4232
    v_mfma_f32_16x16x32_bf16 v[152:155], v[24:27], v[92:95], v[152:155]
    s_waitcnt lgkmcnt(12)
    v_mfma_f32_16x16x32_bf16 v[146:149], v[12:15], v[96:99], v[146:149]
    ds_read_b64 v[92:93], v7 offset:4160
    ds_read_b64 v[94:95], v7 offset:4168
    v_mfma_f32_16x16x32_bf16 v[152:155], v[20:23], v[96:99], v[152:155]
    s_waitcnt lgkmcnt(12)
    v_mfma_f32_16x16x32_bf16 v[152:155], v[16:19], v[100:103], v[152:155]
    ds_read_b64 v[96:97], v7 offset:4096
    ds_read_b64 v[98:99], v7 offset:4104
    s_waitcnt lgkmcnt(12)
    v_mfma_f32_16x16x32_bf16 v[152:155], v[12:15], v[104:107], v[152:155]
    ds_read_b64 v[100:101], v7 offset:4032
    ds_read_b64 v[102:103], v7 offset:4040
    s_waitcnt lgkmcnt(12)
    v_mfma_f32_16x16x32_bf16 v[158:161], v[16:19], v[76:79], v[158:161]
    ds_read_b64 v[104:105], v7 offset:3968
    ds_read_b64 v[106:107], v7 offset:3976
    v_mfma_f32_16x16x32_bf16 v[164:167], v[24:27], v[76:79], v[164:167]
    v_mfma_f32_16x16x32_bf16 v[170:173], v[32:35], v[76:79], v[170:173]
    v_mfma_f32_16x16x32_bf16 v[176:179], v[40:43], v[76:79], v[176:179]
    v_mfma_f32_16x16x32_bf16 v[182:185], v[48:51], v[76:79], v[182:185]
    v_mfma_f32_16x16x32_bf16 v[188:191], v[56:59], v[76:79], v[188:191]
    v_mfma_f32_16x16x32_bf16 v[194:197], v[64:67], v[76:79], v[194:197]
    v_mfma_f32_16x16x32_bf16 v[200:203], v[72:75], v[76:79], v[200:203]
    s_waitcnt lgkmcnt(12)
    v_mfma_f32_16x16x32_bf16 v[158:161], v[12:15], v[80:83], v[158:161]
    ds_read_b64 v[76:77], v7 offset:3904
    ds_read_b64 v[78:79], v7 offset:3912
    v_mfma_f32_16x16x32_bf16 v[164:167], v[20:23], v[80:83], v[164:167]
    v_mfma_f32_16x16x32_bf16 v[170:173], v[28:31], v[80:83], v[170:173]
    v_mfma_f32_16x16x32_bf16 v[176:179], v[36:39], v[80:83], v[176:179]
    v_mfma_f32_16x16x32_bf16 v[182:185], v[44:47], v[80:83], v[182:185]
    v_mfma_f32_16x16x32_bf16 v[188:191], v[52:55], v[80:83], v[188:191]
    v_mfma_f32_16x16x32_bf16 v[194:197], v[60:63], v[80:83], v[194:197]
    v_mfma_f32_16x16x32_bf16 v[200:203], v[68:71], v[80:83], v[200:203]
    s_waitcnt lgkmcnt(12)
    v_mfma_f32_16x16x32_bf16 v[164:167], v[16:19], v[84:87], v[164:167]
    ds_read_b64 v[80:81], v7 offset:3840
    ds_read_b64 v[82:83], v7 offset:3848
    v_mfma_f32_16x16x32_bf16 v[170:173], v[24:27], v[84:87], v[170:173]
    v_mfma_f32_16x16x32_bf16 v[176:179], v[32:35], v[84:87], v[176:179]
    v_mfma_f32_16x16x32_bf16 v[182:185], v[40:43], v[84:87], v[182:185]
    v_mfma_f32_16x16x32_bf16 v[188:191], v[48:51], v[84:87], v[188:191]
    v_mfma_f32_16x16x32_bf16 v[194:197], v[56:59], v[84:87], v[194:197]
    v_mfma_f32_16x16x32_bf16 v[200:203], v[64:67], v[84:87], v[200:203]
    s_waitcnt lgkmcnt(12)
    v_mfma_f32_16x16x32_bf16 v[164:167], v[12:15], v[88:91], v[164:167]
    ds_read_b64 v[84:85], v7 offset:3776
    ds_read_b64 v[86:87], v7 offset:3784
    v_mfma_f32_16x16x32_bf16 v[170:173], v[20:23], v[88:91], v[170:173]
    v_mfma_f32_16x16x32_bf16 v[176:179], v[28:31], v[88:91], v[176:179]
    v_mfma_f32_16x16x32_bf16 v[182:185], v[36:39], v[88:91], v[182:185]
    v_mfma_f32_16x16x32_bf16 v[188:191], v[44:47], v[88:91], v[188:191]
    v_mfma_f32_16x16x32_bf16 v[194:197], v[52:55], v[88:91], v[194:197]
    v_mfma_f32_16x16x32_bf16 v[200:203], v[60:63], v[88:91], v[200:203]
    s_waitcnt lgkmcnt(12)
    v_mfma_f32_16x16x32_bf16 v[170:173], v[16:19], v[92:95], v[170:173]
    ds_read_b64 v[88:89], v7 offset:3712
    ds_read_b64 v[90:91], v7 offset:3720
    v_mfma_f32_16x16x32_bf16 v[176:179], v[24:27], v[92:95], v[176:179]
    v_mfma_f32_16x16x32_bf16 v[182:185], v[32:35], v[92:95], v[182:185]
    v_mfma_f32_16x16x32_bf16 v[188:191], v[40:43], v[92:95], v[188:191]
    v_mfma_f32_16x16x32_bf16 v[194:197], v[48:51], v[92:95], v[194:197]
    v_mfma_f32_16x16x32_bf16 v[200:203], v[56:59], v[92:95], v[200:203]
    s_waitcnt lgkmcnt(12)
    v_mfma_f32_16x16x32_bf16 v[170:173], v[12:15], v[96:99], v[170:173]
    ds_read_b64 v[92:93], v7 offset:3648
    ds_read_b64 v[94:95], v7 offset:3656
    v_mfma_f32_16x16x32_bf16 v[176:179], v[20:23], v[96:99], v[176:179]
    v_mfma_f32_16x16x32_bf16 v[182:185], v[28:31], v[96:99], v[182:185]
    v_mfma_f32_16x16x32_bf16 v[188:191], v[36:39], v[96:99], v[188:191]
    v_mfma_f32_16x16x32_bf16 v[194:197], v[44:47], v[96:99], v[194:197]
    v_mfma_f32_16x16x32_bf16 v[200:203], v[52:55], v[96:99], v[200:203]
    s_waitcnt lgkmcnt(12)
    v_mfma_f32_16x16x32_bf16 v[176:179], v[16:19], v[100:103], v[176:179]
    ds_read_b64 v[96:97], v7 offset:3584
    ds_read_b64 v[98:99], v7 offset:3592
    v_mfma_f32_16x16x32_bf16 v[182:185], v[24:27], v[100:103], v[182:185]
    v_mfma_f32_16x16x32_bf16 v[188:191], v[32:35], v[100:103], v[188:191]
    v_mfma_f32_16x16x32_bf16 v[194:197], v[40:43], v[100:103], v[194:197]
    v_mfma_f32_16x16x32_bf16 v[200:203], v[48:51], v[100:103], v[200:203]
    s_waitcnt lgkmcnt(12)
    v_mfma_f32_16x16x32_bf16 v[176:179], v[12:15], v[104:107], v[176:179]
    ds_read_b64 v[100:101], v7 offset:3520
    ds_read_b64 v[102:103], v7 offset:3528
    v_mfma_f32_16x16x32_bf16 v[182:185], v[20:23], v[104:107], v[182:185]
    v_mfma_f32_16x16x32_bf16 v[188:191], v[28:31], v[104:107], v[188:191]
    v_mfma_f32_16x16x32_bf16 v[194:197], v[36:39], v[104:107], v[194:197]
    v_mfma_f32_16x16x32_bf16 v[200:203], v[44:47], v[104:107], v[200:203]
    s_waitcnt lgkmcnt(12)
    v_mfma_f32_16x16x32_bf16 v[182:185], v[16:19], v[76:79], v[182:185]
    ds_read_b64 v[104:105], v7 offset:3456
    ds_read_b64 v[106:107], v7 offset:3464
    v_mfma_f32_16x16x32_bf16 v[188:191], v[24:27], v[76:79], v[188:191]
    v_mfma_f32_16x16x32_bf16 v[194:197], v[32:35], v[76:79], v[194:197]
    v_mfma_f32_16x16x32_bf16 v[200:203], v[40:43], v[76:79], v[200:203]
    s_waitcnt lgkmcnt(12)
    v_mfma_f32_16x16x32_bf16 v[182:185], v[12:15], v[80:83], v[182:185]
    v_mfma_f32_16x16x32_bf16 v[188:191], v[20:23], v[80:83], v[188:191]
    v_mfma_f32_16x16x32_bf16 v[194:197], v[28:31], v[80:83], v[194:197]
    v_mfma_f32_16x16x32_bf16 v[200:203], v[36:39], v[80:83], v[200:203]
    s_waitcnt lgkmcnt(10)
    v_mfma_f32_16x16x32_bf16 v[188:191], v[16:19], v[84:87], v[188:191]
    v_mfma_f32_16x16x32_bf16 v[194:197], v[24:27], v[84:87], v[194:197]
    v_mfma_f32_16x16x32_bf16 v[200:203], v[32:35], v[84:87], v[200:203]
    s_waitcnt lgkmcnt(8)
    v_mfma_f32_16x16x32_bf16 v[188:191], v[12:15], v[88:91], v[188:191]
    v_mfma_f32_16x16x32_bf16 v[194:197], v[20:23], v[88:91], v[194:197]
    v_mfma_f32_16x16x32_bf16 v[200:203], v[28:31], v[88:91], v[200:203]
    s_waitcnt lgkmcnt(6)
    v_mfma_f32_16x16x32_bf16 v[194:197], v[16:19], v[92:95], v[194:197]
    v_mfma_f32_16x16x32_bf16 v[200:203], v[24:27], v[92:95], v[200:203]
    s_waitcnt lgkmcnt(4)
    v_mfma_f32_16x16x32_bf16 v[194:197], v[12:15], v[96:99], v[194:197]
    v_mfma_f32_16x16x32_bf16 v[200:203], v[20:23], v[96:99], v[200:203]
    s_waitcnt lgkmcnt(2)
    v_mfma_f32_16x16x32_bf16 v[200:203], v[16:19], v[100:103], v[200:203]
    s_waitcnt lgkmcnt(0)
    v_mfma_f32_16x16x32_bf16 v[200:203], v[12:15], v[104:107], v[200:203]
    v_add_u32 v2, -1, v1
    v_and_b32 v2, 15, v2
    v_add_u32 v2, 48, v2
    v_add_u32 v3, -16, v1
    v_cmp_gt_u32 vcc, 16, v1
    s_nop 1
    v_cndmask_b32 v2, v3, v2, vcc
    v_lshlrev_b32 v2, 2, v2
    v_cmp_eq_u32 vcc, 0, v1
    s_nop 4
    v_mov_b32 v12, 0
    v_mov_b32 v13, 0
    v_mov_b32 v14, 0
    v_add_f32 v109, v109, v156
    v_add_f32 v110, v110, v157
    v_add_f32 v111, v111, v158
    v_add_f32 v112, v112, v159
    v_add_f32 v113, v113, v160
    ds_bpermute_b32 v15, v2, v112
    ds_bpermute_b32 v16, v2, v113
    ds_bpermute_b32 v17, v2, v161
    v_add_f32 v115, v115, v162
    v_add_f32 v116, v116, v163
    v_add_f32 v117, v117, v164
    v_add_f32 v118, v118, v165
    v_add_f32 v119, v119, v166
    ds_bpermute_b32 v18, v2, v118
    ds_bpermute_b32 v19, v2, v119
    ds_bpermute_b32 v20, v2, v167
    v_add_f32 v121, v121, v168
    v_add_f32 v122, v122, v169
    v_add_f32 v123, v123, v170
    v_add_f32 v124, v124, v171
    v_add_f32 v125, v125, v172
    ds_bpermute_b32 v21, v2, v124
    ds_bpermute_b32 v22, v2, v125
    ds_bpermute_b32 v23, v2, v173
    v_add_f32 v127, v127, v174
    v_add_f32 v128, v128, v175
    v_add_f32 v129, v129, v176
    v_add_f32 v130, v130, v177
    v_add_f32 v131, v131, v178
    ds_bpermute_b32 v24, v2, v130
    ds_bpermute_b32 v25, v2, v131
    ds_bpermute_b32 v26, v2, v179
    v_add_f32 v133, v133, v180
    v_add_f32 v134, v134, v181
    v_add_f32 v135, v135, v182
    v_add_f32 v136, v136, v183
    v_add_f32 v137, v137, v184
    ds_bpermute_b32 v27, v2, v136
    ds_bpermute_b32 v28, v2, v137
    ds_bpermute_b32 v29, v2, v185
    v_add_f32 v139, v139, v186
    v_add_f32 v140, v140, v187
    v_add_f32 v141, v141, v188
    v_add_f32 v142, v142, v189
    v_add_f32 v143, v143, v190
    ds_bpermute_b32 v30, v2, v142
    ds_bpermute_b32 v31, v2, v143
    ds_bpermute_b32 v32, v2, v191
    v_add_f32 v145, v145, v192
    v_add_f32 v146, v146, v193
    v_add_f32 v147, v147, v194
    v_add_f32 v148, v148, v195
    v_add_f32 v149, v149, v196
    ds_bpermute_b32 v33, v2, v148
    ds_bpermute_b32 v34, v2, v149
    ds_bpermute_b32 v35, v2, v197
    v_add_f32 v151, v151, v198
    v_add_f32 v152, v152, v199
    v_add_f32 v153, v153, v200
    v_add_f32 v154, v154, v201
    v_add_f32 v155, v155, v202
    ds_bpermute_b32 v36, v2, v154
    ds_bpermute_b32 v37, v2, v155
    ds_bpermute_b32 v38, v2, v203
    v_lshlrev_b32 v204, 16, v204
    v_mul_f32 v204, s38, v204
    v_lshlrev_b32 v205, 16, v205
    v_mul_f32 v205, s38, v205
    v_lshlrev_b32 v206, 16, v206
    v_mul_f32 v206, s38, v206
    v_lshlrev_b32 v207, 16, v207
    v_mul_f32 v207, s38, v207
    v_lshlrev_b32 v208, 16, v208
    v_mul_f32 v208, s38, v208
    v_lshlrev_b32 v209, 16, v209
    v_mul_f32 v209, s38, v209
    v_lshlrev_b32 v210, 16, v210
    v_mul_f32 v210, s38, v210
    v_lshlrev_b32 v211, 16, v211
    v_mul_f32 v211, s38, v211
    v_lshlrev_b32 v212, 16, v212
    v_mul_f32 v212, s38, v212
    v_lshlrev_b32 v213, 16, v213
    v_mul_f32 v213, s38, v213
    v_lshlrev_b32 v214, 16, v214
    v_mul_f32 v214, s38, v214
    v_lshlrev_b32 v215, 16, v215
    v_mul_f32 v215, s38, v215
    v_lshlrev_b32 v216, 16, v216
    v_mul_f32 v216, s38, v216
    v_lshlrev_b32 v217, 16, v217
    v_mul_f32 v217, s38, v217
    v_lshlrev_b32 v218, 16, v218
    v_mul_f32 v218, s38, v218
    v_lshlrev_b32 v219, 16, v219
    v_mul_f32 v219, s38, v219
    v_lshlrev_b32 v220, 16, v220
    v_mul_f32 v220, s38, v220
    v_lshlrev_b32 v221, 16, v221
    v_mul_f32 v221, s38, v221
    v_lshlrev_b32 v222, 16, v222
    v_mul_f32 v222, s38, v222
    v_lshlrev_b32 v223, 16, v223
    v_mul_f32 v223, s38, v223
    v_lshlrev_b32 v224, 16, v224
    v_mul_f32 v224, s38, v224
    v_lshlrev_b32 v225, 16, v225
    v_mul_f32 v225, s38, v225
    v_lshlrev_b32 v226, 16, v226
    v_mul_f32 v226, s38, v226
    v_lshlrev_b32 v227, 16, v227
    v_mul_f32 v227, s38, v227
    v_lshlrev_b32 v228, 16, v228
    v_mul_f32 v228, s38, v228
    v_lshlrev_b32 v229, 16, v229
    v_mul_f32 v229, s38, v229
    v_lshlrev_b32 v230, 16, v230
    v_mul_f32 v230, s38, v230
    v_lshlrev_b32 v231, 16, v231
    v_mul_f32 v231, s38, v231
    v_lshlrev_b32 v232, 16, v232
    v_mul_f32 v232, s38, v232
    v_lshlrev_b32 v233, 16, v233
    v_mul_f32 v233, s38, v233
    v_lshlrev_b32 v234, 16, v234
    v_mul_f32 v234, s38, v234
    v_lshlrev_b32 v235, 16, v235
    v_mul_f32 v235, s38, v235
    s_waitcnt lgkmcnt(0)
    s_setprio 3
    v_cndmask_b32 v3, v15, v12, vcc
    v_add_f32 v108, v108, v3
    v_cndmask_b32 v3, v16, v13, vcc
    v_add_f32 v109, v109, v3
    v_cndmask_b32 v3, v17, v14, vcc
    v_add_f32 v110, v110, v3
    v_cvt_pk_bf16_f32 v3, v108, v109
    v_cvt_pk_bf16_f32 v4, v204, v205
    v_lshlrev_b32 v108, 16, v3
    v_and_b32 v109, 0xffff0000, v3
    v_lshlrev_b32 v204, 16, v4
    v_and_b32 v205, 0xffff0000, v4
    v_add_f32 v108, v108, v204
    v_add_f32 v109, v109, v205
    v_cvt_pk_bf16_f32 v76, v108, v109
    v_cvt_pk_bf16_f32 v3, v110, v111
    v_cvt_pk_bf16_f32 v4, v206, v207
    v_lshlrev_b32 v110, 16, v3
    v_and_b32 v111, 0xffff0000, v3
    v_lshlrev_b32 v206, 16, v4
    v_and_b32 v207, 0xffff0000, v4
    v_add_f32 v110, v110, v206
    v_add_f32 v111, v111, v207
    v_cvt_pk_bf16_f32 v77, v110, v111
    buffer_store_dwordx2 v[76:77], v5, s[12:15], 0 offen offset:0 sc1
    v_cndmask_b32 v3, v18, v15, vcc
    v_add_f32 v114, v114, v3
    v_cndmask_b32 v3, v19, v16, vcc
    v_add_f32 v115, v115, v3
    v_cndmask_b32 v3, v20, v17, vcc
    v_add_f32 v116, v116, v3
    v_cvt_pk_bf16_f32 v3, v114, v115
    v_cvt_pk_bf16_f32 v4, v208, v209
    v_lshlrev_b32 v114, 16, v3
    v_and_b32 v115, 0xffff0000, v3
    v_lshlrev_b32 v208, 16, v4
    v_and_b32 v209, 0xffff0000, v4
    v_add_f32 v114, v114, v208
    v_add_f32 v115, v115, v209
    v_cvt_pk_bf16_f32 v78, v114, v115
    v_cvt_pk_bf16_f32 v3, v116, v117
    v_cvt_pk_bf16_f32 v4, v210, v211
    v_lshlrev_b32 v116, 16, v3
    v_and_b32 v117, 0xffff0000, v3
    v_lshlrev_b32 v210, 16, v4
    v_and_b32 v211, 0xffff0000, v4
    v_add_f32 v116, v116, v210
    v_add_f32 v117, v117, v211
    v_cvt_pk_bf16_f32 v79, v116, v117
    buffer_store_dwordx2 v[78:79], v5, s[12:15], 0 offen offset:512 sc1
    v_cndmask_b32 v3, v21, v18, vcc
    v_add_f32 v120, v120, v3
    v_cndmask_b32 v3, v22, v19, vcc
    v_add_f32 v121, v121, v3
    v_cndmask_b32 v3, v23, v20, vcc
    v_add_f32 v122, v122, v3
    v_cvt_pk_bf16_f32 v3, v120, v121
    v_cvt_pk_bf16_f32 v4, v212, v213
    v_lshlrev_b32 v120, 16, v3
    v_and_b32 v121, 0xffff0000, v3
    v_lshlrev_b32 v212, 16, v4
    v_and_b32 v213, 0xffff0000, v4
    v_add_f32 v120, v120, v212
    v_add_f32 v121, v121, v213
    v_cvt_pk_bf16_f32 v80, v120, v121
    v_cvt_pk_bf16_f32 v3, v122, v123
    v_cvt_pk_bf16_f32 v4, v214, v215
    v_lshlrev_b32 v122, 16, v3
    v_and_b32 v123, 0xffff0000, v3
    v_lshlrev_b32 v214, 16, v4
    v_and_b32 v215, 0xffff0000, v4
    v_add_f32 v122, v122, v214
    v_add_f32 v123, v123, v215
    v_cvt_pk_bf16_f32 v81, v122, v123
    buffer_store_dwordx2 v[80:81], v5, s[12:15], 0 offen offset:1024 sc1
    v_cndmask_b32 v3, v24, v21, vcc
    v_add_f32 v126, v126, v3
    v_cndmask_b32 v3, v25, v22, vcc
    v_add_f32 v127, v127, v3
    v_cndmask_b32 v3, v26, v23, vcc
    v_add_f32 v128, v128, v3
    v_cvt_pk_bf16_f32 v3, v126, v127
    v_cvt_pk_bf16_f32 v4, v216, v217
    v_lshlrev_b32 v126, 16, v3
    v_and_b32 v127, 0xffff0000, v3
    v_lshlrev_b32 v216, 16, v4
    v_and_b32 v217, 0xffff0000, v4
    v_add_f32 v126, v126, v216
    v_add_f32 v127, v127, v217
    v_cvt_pk_bf16_f32 v82, v126, v127
    v_cvt_pk_bf16_f32 v3, v128, v129
    v_cvt_pk_bf16_f32 v4, v218, v219
    v_lshlrev_b32 v128, 16, v3
    v_and_b32 v129, 0xffff0000, v3
    v_lshlrev_b32 v218, 16, v4
    v_and_b32 v219, 0xffff0000, v4
    v_add_f32 v128, v128, v218
    v_add_f32 v129, v129, v219
    v_cvt_pk_bf16_f32 v83, v128, v129
    buffer_store_dwordx2 v[82:83], v5, s[12:15], 0 offen offset:1536 sc1
    v_cndmask_b32 v3, v27, v24, vcc
    v_add_f32 v132, v132, v3
    v_cndmask_b32 v3, v28, v25, vcc
    v_add_f32 v133, v133, v3
    v_cndmask_b32 v3, v29, v26, vcc
    v_add_f32 v134, v134, v3
    v_cvt_pk_bf16_f32 v3, v132, v133
    v_cvt_pk_bf16_f32 v4, v220, v221
    v_lshlrev_b32 v132, 16, v3
    v_and_b32 v133, 0xffff0000, v3
    v_lshlrev_b32 v220, 16, v4
    v_and_b32 v221, 0xffff0000, v4
    v_add_f32 v132, v132, v220
    v_add_f32 v133, v133, v221
    v_cvt_pk_bf16_f32 v84, v132, v133
    v_cvt_pk_bf16_f32 v3, v134, v135
    v_cvt_pk_bf16_f32 v4, v222, v223
    v_lshlrev_b32 v134, 16, v3
    v_and_b32 v135, 0xffff0000, v3
    v_lshlrev_b32 v222, 16, v4
    v_and_b32 v223, 0xffff0000, v4
    v_add_f32 v134, v134, v222
    v_add_f32 v135, v135, v223
    v_cvt_pk_bf16_f32 v85, v134, v135
    buffer_store_dwordx2 v[84:85], v5, s[12:15], 0 offen offset:2048 sc1
    v_cndmask_b32 v3, v30, v27, vcc
    v_add_f32 v138, v138, v3
    v_cndmask_b32 v3, v31, v28, vcc
    v_add_f32 v139, v139, v3
    v_cndmask_b32 v3, v32, v29, vcc
    v_add_f32 v140, v140, v3
    v_cvt_pk_bf16_f32 v3, v138, v139
    v_cvt_pk_bf16_f32 v4, v224, v225
    v_lshlrev_b32 v138, 16, v3
    v_and_b32 v139, 0xffff0000, v3
    v_lshlrev_b32 v224, 16, v4
    v_and_b32 v225, 0xffff0000, v4
    v_add_f32 v138, v138, v224
    v_add_f32 v139, v139, v225
    v_cvt_pk_bf16_f32 v86, v138, v139
    v_cvt_pk_bf16_f32 v3, v140, v141
    v_cvt_pk_bf16_f32 v4, v226, v227
    v_lshlrev_b32 v140, 16, v3
    v_and_b32 v141, 0xffff0000, v3
    v_lshlrev_b32 v226, 16, v4
    v_and_b32 v227, 0xffff0000, v4
    v_add_f32 v140, v140, v226
    v_add_f32 v141, v141, v227
    v_cvt_pk_bf16_f32 v87, v140, v141
    buffer_store_dwordx2 v[86:87], v5, s[12:15], 0 offen offset:2560 sc1
    v_cndmask_b32 v3, v33, v30, vcc
    v_add_f32 v144, v144, v3
    v_cndmask_b32 v3, v34, v31, vcc
    v_add_f32 v145, v145, v3
    v_cndmask_b32 v3, v35, v32, vcc
    v_add_f32 v146, v146, v3
    v_cvt_pk_bf16_f32 v3, v144, v145
    v_cvt_pk_bf16_f32 v4, v228, v229
    v_lshlrev_b32 v144, 16, v3
    v_and_b32 v145, 0xffff0000, v3
    v_lshlrev_b32 v228, 16, v4
    v_and_b32 v229, 0xffff0000, v4
    v_add_f32 v144, v144, v228
    v_add_f32 v145, v145, v229
    v_cvt_pk_bf16_f32 v88, v144, v145
    v_cvt_pk_bf16_f32 v3, v146, v147
    v_cvt_pk_bf16_f32 v4, v230, v231
    v_lshlrev_b32 v146, 16, v3
    v_and_b32 v147, 0xffff0000, v3
    v_lshlrev_b32 v230, 16, v4
    v_and_b32 v231, 0xffff0000, v4
    v_add_f32 v146, v146, v230
    v_add_f32 v147, v147, v231
    v_cvt_pk_bf16_f32 v89, v146, v147
    buffer_store_dwordx2 v[88:89], v5, s[12:15], 0 offen offset:3072 sc1
    v_cndmask_b32 v3, v36, v33, vcc
    v_add_f32 v150, v150, v3
    v_cndmask_b32 v3, v37, v34, vcc
    v_add_f32 v151, v151, v3
    v_cndmask_b32 v3, v38, v35, vcc
    v_add_f32 v152, v152, v3
    v_cvt_pk_bf16_f32 v3, v150, v151
    v_cvt_pk_bf16_f32 v4, v232, v233
    v_lshlrev_b32 v150, 16, v3
    v_and_b32 v151, 0xffff0000, v3
    v_lshlrev_b32 v232, 16, v4
    v_and_b32 v233, 0xffff0000, v4
    v_add_f32 v150, v150, v232
    v_add_f32 v151, v151, v233
    v_cvt_pk_bf16_f32 v90, v150, v151
    v_cvt_pk_bf16_f32 v3, v152, v153
    v_cvt_pk_bf16_f32 v4, v234, v235
    v_lshlrev_b32 v152, 16, v3
    v_and_b32 v153, 0xffff0000, v3
    v_lshlrev_b32 v234, 16, v4
    v_and_b32 v235, 0xffff0000, v4
    v_add_f32 v152, v152, v234
    v_add_f32 v153, v153, v235
    v_cvt_pk_bf16_f32 v91, v152, v153
    buffer_store_dwordx2 v[90:91], v5, s[12:15], 0 offen offset:3584 sc1
    s_waitcnt vmcnt(0)
    v_mov_b32 v3, 1
    v_mov_b32 v4, 0
    s_mov_b64 exec, 1
    buffer_store_byte v3, v4, s[96:99], s100 offen sc1
    s_mov_b64 exec, -1
    s_branch L_mn_fin
L_mn_gate:
    s_sub_u32 s55, s55, 768
    s_load_dwordx2 s[16:17], s[0:1], 0
    s_load_dwordx2 s[18:19], s[0:1], 96
    s_load_dwordx2 s[20:21], s[0:1], 120
    v_lshrrev_b32 v4, 3, v1
    s_lshl_b32 s22, s55, 3
    v_add_u32 v6, s22, v4
    v_and_b32 v5, 7, v1
    v_lshlrev_b32 v5, 4, v5
    v_mul_u32_u24 v4, 1280, v6
    v_add_u32 v4, v4, v5
    s_waitcnt lgkmcnt(0)
    s_mov_b32 s4, s16
    s_and_b32 s5, s17, 0xffff
    s_mov_b32 s6, 2621440
    s_mov_b32 s7, 0x00020000
    s_mov_b32 s8, s18
    s_and_b32 s9, s19, 0xffff
    s_mov_b32 s10, 1280
    s_mov_b32 s11, 0x00020000
    buffer_load_dwordx4 v[16:19], v4, s[4:7], 0 offen offset:0
    buffer_load_dwordx4 v[56:59], v5, s[8:11], 0 offen offset:0
    buffer_load_dwordx4 v[20:23], v4, s[4:7], 0 offen offset:128
    buffer_load_dwordx4 v[60:63], v5, s[8:11], 0 offen offset:128
    buffer_load_dwordx4 v[24:27], v4, s[4:7], 0 offen offset:256
    buffer_load_dwordx4 v[64:67], v5, s[8:11], 0 offen offset:256
    buffer_load_dwordx4 v[28:31], v4, s[4:7], 0 offen offset:384
    buffer_load_dwordx4 v[68:71], v5, s[8:11], 0 offen offset:384
    buffer_load_dwordx4 v[32:35], v4, s[4:7], 0 offen offset:512
    buffer_load_dwordx4 v[72:75], v5, s[8:11], 0 offen offset:512
    buffer_load_dwordx4 v[36:39], v4, s[4:7], 0 offen offset:640
    buffer_load_dwordx4 v[76:79], v5, s[8:11], 0 offen offset:640
    buffer_load_dwordx4 v[40:43], v4, s[4:7], 0 offen offset:768
    buffer_load_dwordx4 v[80:83], v5, s[8:11], 0 offen offset:768
    buffer_load_dwordx4 v[44:47], v4, s[4:7], 0 offen offset:896
    buffer_load_dwordx4 v[84:87], v5, s[8:11], 0 offen offset:896
    buffer_load_dwordx4 v[48:51], v4, s[4:7], 0 offen offset:1024
    buffer_load_dwordx4 v[88:91], v5, s[8:11], 0 offen offset:1024
    buffer_load_dwordx4 v[52:55], v4, s[4:7], 0 offen offset:1152
    buffer_load_dwordx4 v[92:95], v5, s[8:11], 0 offen offset:1152
    v_mov_b32 v8, 0
    v_mov_b32 v9, 0
    s_add_u32 s12, s20, 57671680
    s_addc_u32 s13, s21, 0
    s_and_b32 s13, s13, 0xffff
    s_mov_b32 s14, 8192
    s_mov_b32 s15, 0x00020000
    s_waitcnt vmcnt(0)
    v_lshlrev_b32 v12, 16, v16
    v_lshlrev_b32 v13, 16, v56
    v_and_b32 v14, 0xffff0000, v16
    v_and_b32 v15, 0xffff0000, v56
    v_fmac_f32 v8, v12, v13
    v_fmac_f32 v9, v14, v15
    v_lshlrev_b32 v12, 16, v17
    v_lshlrev_b32 v13, 16, v57
    v_and_b32 v14, 0xffff0000, v17
    v_and_b32 v15, 0xffff0000, v57
    v_fmac_f32 v8, v12, v13
    v_fmac_f32 v9, v14, v15
    v_lshlrev_b32 v12, 16, v18
    v_lshlrev_b32 v13, 16, v58
    v_and_b32 v14, 0xffff0000, v18
    v_and_b32 v15, 0xffff0000, v58
    v_fmac_f32 v8, v12, v13
    v_fmac_f32 v9, v14, v15
    v_lshlrev_b32 v12, 16, v19
    v_lshlrev_b32 v13, 16, v59
    v_and_b32 v14, 0xffff0000, v19
    v_and_b32 v15, 0xffff0000, v59
    v_fmac_f32 v8, v12, v13
    v_fmac_f32 v9, v14, v15
    v_lshlrev_b32 v12, 16, v20
    v_lshlrev_b32 v13, 16, v60
    v_and_b32 v14, 0xffff0000, v20
    v_and_b32 v15, 0xffff0000, v60
    v_fmac_f32 v8, v12, v13
    v_fmac_f32 v9, v14, v15
    v_lshlrev_b32 v12, 16, v21
    v_lshlrev_b32 v13, 16, v61
    v_and_b32 v14, 0xffff0000, v21
    v_and_b32 v15, 0xffff0000, v61
    v_fmac_f32 v8, v12, v13
    v_fmac_f32 v9, v14, v15
    v_lshlrev_b32 v12, 16, v22
    v_lshlrev_b32 v13, 16, v62
    v_and_b32 v14, 0xffff0000, v22
    v_and_b32 v15, 0xffff0000, v62
    v_fmac_f32 v8, v12, v13
    v_fmac_f32 v9, v14, v15
    v_lshlrev_b32 v12, 16, v23
    v_lshlrev_b32 v13, 16, v63
    v_and_b32 v14, 0xffff0000, v23
    v_and_b32 v15, 0xffff0000, v63
    v_fmac_f32 v8, v12, v13
    v_fmac_f32 v9, v14, v15
    v_lshlrev_b32 v12, 16, v24
    v_lshlrev_b32 v13, 16, v64
    v_and_b32 v14, 0xffff0000, v24
    v_and_b32 v15, 0xffff0000, v64
    v_fmac_f32 v8, v12, v13
    v_fmac_f32 v9, v14, v15
    v_lshlrev_b32 v12, 16, v25
    v_lshlrev_b32 v13, 16, v65
    v_and_b32 v14, 0xffff0000, v25
    v_and_b32 v15, 0xffff0000, v65
    v_fmac_f32 v8, v12, v13
    v_fmac_f32 v9, v14, v15
    v_lshlrev_b32 v12, 16, v26
    v_lshlrev_b32 v13, 16, v66
    v_and_b32 v14, 0xffff0000, v26
    v_and_b32 v15, 0xffff0000, v66
    v_fmac_f32 v8, v12, v13
    v_fmac_f32 v9, v14, v15
    v_lshlrev_b32 v12, 16, v27
    v_lshlrev_b32 v13, 16, v67
    v_and_b32 v14, 0xffff0000, v27
    v_and_b32 v15, 0xffff0000, v67
    v_fmac_f32 v8, v12, v13
    v_fmac_f32 v9, v14, v15
    v_lshlrev_b32 v12, 16, v28
    v_lshlrev_b32 v13, 16, v68
    v_and_b32 v14, 0xffff0000, v28
    v_and_b32 v15, 0xffff0000, v68
    v_fmac_f32 v8, v12, v13
    v_fmac_f32 v9, v14, v15
    v_lshlrev_b32 v12, 16, v29
    v_lshlrev_b32 v13, 16, v69
    v_and_b32 v14, 0xffff0000, v29
    v_and_b32 v15, 0xffff0000, v69
    v_fmac_f32 v8, v12, v13
    v_fmac_f32 v9, v14, v15
    v_lshlrev_b32 v12, 16, v30
    v_lshlrev_b32 v13, 16, v70
    v_and_b32 v14, 0xffff0000, v30
    v_and_b32 v15, 0xffff0000, v70
    v_fmac_f32 v8, v12, v13
    v_fmac_f32 v9, v14, v15
    v_lshlrev_b32 v12, 16, v31
    v_lshlrev_b32 v13, 16, v71
    v_and_b32 v14, 0xffff0000, v31
    v_and_b32 v15, 0xffff0000, v71
    v_fmac_f32 v8, v12, v13
    v_fmac_f32 v9, v14, v15
    v_lshlrev_b32 v12, 16, v32
    v_lshlrev_b32 v13, 16, v72
    v_and_b32 v14, 0xffff0000, v32
    v_and_b32 v15, 0xffff0000, v72
    v_fmac_f32 v8, v12, v13
    v_fmac_f32 v9, v14, v15
    v_lshlrev_b32 v12, 16, v33
    v_lshlrev_b32 v13, 16, v73
    v_and_b32 v14, 0xffff0000, v33
    v_and_b32 v15, 0xffff0000, v73
    v_fmac_f32 v8, v12, v13
    v_fmac_f32 v9, v14, v15
    v_lshlrev_b32 v12, 16, v34
    v_lshlrev_b32 v13, 16, v74
    v_and_b32 v14, 0xffff0000, v34
    v_and_b32 v15, 0xffff0000, v74
    v_fmac_f32 v8, v12, v13
    v_fmac_f32 v9, v14, v15
    v_lshlrev_b32 v12, 16, v35
    v_lshlrev_b32 v13, 16, v75
    v_and_b32 v14, 0xffff0000, v35
    v_and_b32 v15, 0xffff0000, v75
    v_fmac_f32 v8, v12, v13
    v_fmac_f32 v9, v14, v15
    v_lshlrev_b32 v12, 16, v36
    v_lshlrev_b32 v13, 16, v76
    v_and_b32 v14, 0xffff0000, v36
    v_and_b32 v15, 0xffff0000, v76
    v_fmac_f32 v8, v12, v13
    v_fmac_f32 v9, v14, v15
    v_lshlrev_b32 v12, 16, v37
    v_lshlrev_b32 v13, 16, v77
    v_and_b32 v14, 0xffff0000, v37
    v_and_b32 v15, 0xffff0000, v77
    v_fmac_f32 v8, v12, v13
    v_fmac_f32 v9, v14, v15
    v_lshlrev_b32 v12, 16, v38
    v_lshlrev_b32 v13, 16, v78
    v_and_b32 v14, 0xffff0000, v38
    v_and_b32 v15, 0xffff0000, v78
    v_fmac_f32 v8, v12, v13
    v_fmac_f32 v9, v14, v15
    v_lshlrev_b32 v12, 16, v39
    v_lshlrev_b32 v13, 16, v79
    v_and_b32 v14, 0xffff0000, v39
    v_and_b32 v15, 0xffff0000, v79
    v_fmac_f32 v8, v12, v13
    v_fmac_f32 v9, v14, v15
    v_lshlrev_b32 v12, 16, v40
    v_lshlrev_b32 v13, 16, v80
    v_and_b32 v14, 0xffff0000, v40
    v_and_b32 v15, 0xffff0000, v80
    v_fmac_f32 v8, v12, v13
    v_fmac_f32 v9, v14, v15
    v_lshlrev_b32 v12, 16, v41
    v_lshlrev_b32 v13, 16, v81
    v_and_b32 v14, 0xffff0000, v41
    v_and_b32 v15, 0xffff0000, v81
    v_fmac_f32 v8, v12, v13
    v_fmac_f32 v9, v14, v15
    v_lshlrev_b32 v12, 16, v42
    v_lshlrev_b32 v13, 16, v82
    v_and_b32 v14, 0xffff0000, v42
    v_and_b32 v15, 0xffff0000, v82
    v_fmac_f32 v8, v12, v13
    v_fmac_f32 v9, v14, v15
    v_lshlrev_b32 v12, 16, v43
    v_lshlrev_b32 v13, 16, v83
    v_and_b32 v14, 0xffff0000, v43
    v_and_b32 v15, 0xffff0000, v83
    v_fmac_f32 v8, v12, v13
    v_fmac_f32 v9, v14, v15
    v_lshlrev_b32 v12, 16, v44
    v_lshlrev_b32 v13, 16, v84
    v_and_b32 v14, 0xffff0000, v44
    v_and_b32 v15, 0xffff0000, v84
    v_fmac_f32 v8, v12, v13
    v_fmac_f32 v9, v14, v15
    v_lshlrev_b32 v12, 16, v45
    v_lshlrev_b32 v13, 16, v85
    v_and_b32 v14, 0xffff0000, v45
    v_and_b32 v15, 0xffff0000, v85
    v_fmac_f32 v8, v12, v13
    v_fmac_f32 v9, v14, v15
    v_lshlrev_b32 v12, 16, v46
    v_lshlrev_b32 v13, 16, v86
    v_and_b32 v14, 0xffff0000, v46
    v_and_b32 v15, 0xffff0000, v86
    v_fmac_f32 v8, v12, v13
    v_fmac_f32 v9, v14, v15
    v_lshlrev_b32 v12, 16, v47
    v_lshlrev_b32 v13, 16, v87
    v_and_b32 v14, 0xffff0000, v47
    v_and_b32 v15, 0xffff0000, v87
    v_fmac_f32 v8, v12, v13
    v_fmac_f32 v9, v14, v15
    v_lshlrev_b32 v12, 16, v48
    v_lshlrev_b32 v13, 16, v88
    v_and_b32 v14, 0xffff0000, v48
    v_and_b32 v15, 0xffff0000, v88
    v_fmac_f32 v8, v12, v13
    v_fmac_f32 v9, v14, v15
    v_lshlrev_b32 v12, 16, v49
    v_lshlrev_b32 v13, 16, v89
    v_and_b32 v14, 0xffff0000, v49
    v_and_b32 v15, 0xffff0000, v89
    v_fmac_f32 v8, v12, v13
    v_fmac_f32 v9, v14, v15
    v_lshlrev_b32 v12, 16, v50
    v_lshlrev_b32 v13, 16, v90
    v_and_b32 v14, 0xffff0000, v50
    v_and_b32 v15, 0xffff0000, v90
    v_fmac_f32 v8, v12, v13
    v_fmac_f32 v9, v14, v15
    v_lshlrev_b32 v12, 16, v51
    v_lshlrev_b32 v13, 16, v91
    v_and_b32 v14, 0xffff0000, v51
    v_and_b32 v15, 0xffff0000, v91
    v_fmac_f32 v8, v12, v13
    v_fmac_f32 v9, v14, v15
    v_lshlrev_b32 v12, 16, v52
    v_lshlrev_b32 v13, 16, v92
    v_and_b32 v14, 0xffff0000, v52
    v_and_b32 v15, 0xffff0000, v92
    v_fmac_f32 v8, v12, v13
    v_fmac_f32 v9, v14, v15
    v_lshlrev_b32 v12, 16, v53
    v_lshlrev_b32 v13, 16, v93
    v_and_b32 v14, 0xffff0000, v53
    v_and_b32 v15, 0xffff0000, v93
    v_fmac_f32 v8, v12, v13
    v_fmac_f32 v9, v14, v15
    v_lshlrev_b32 v12, 16, v54
    v_lshlrev_b32 v13, 16, v94
    v_and_b32 v14, 0xffff0000, v54
    v_and_b32 v15, 0xffff0000, v94
    v_fmac_f32 v8, v12, v13
    v_fmac_f32 v9, v14, v15
    v_lshlrev_b32 v12, 16, v55
    v_lshlrev_b32 v13, 16, v95
    v_and_b32 v14, 0xffff0000, v55
    v_and_b32 v15, 0xffff0000, v95
    v_fmac_f32 v8, v12, v13
    v_fmac_f32 v9, v14, v15
    v_add_f32 v8, v8, v9
    s_nop 1
    v_add_f32_dpp v8, v8, v8 quad_perm:[1,0,3,2] row_mask:0xf bank_mask:0xf
    s_nop 1
    v_add_f32_dpp v8, v8, v8 quad_perm:[2,3,0,1] row_mask:0xf bank_mask:0xf
    s_nop 1
    v_add_f32_dpp v8, v8, v8 row_half_mirror row_mask:0xf bank_mask:0xf
    v_cvt_pk_bf16_f32 v8, v8, v8
    v_lshlrev_b32 v8, 16, v8
    v_mul_f32 v8, 0xbfb8aa3b, v8
    v_exp_f32 v8, v8
    s_nop 0
    v_add_f32 v8, 1.0, v8
    v_rcp_f32 v8, v8
    s_nop 0
    v_cvt_pk_bf16_f32 v8, v8, v8
    v_lshlrev_b32 v8, 16, v8
    v_lshlrev_b32 v6, 2, v6
    buffer_store_dword v8, v6, s[12:15], 0 offen sc1
    s_waitcnt vmcnt(0)
    v_mov_b32 v2, 1
    v_mov_b32 v3, 0
    s_mov_b64 exec, 1
    buffer_store_byte v2, v3, s[96:99], s100 offen sc1
    s_mov_b64 exec, -1
    s_branch L_mn_fin
L_mn_lddone:
    s_waitcnt vmcnt(0)
    ds_write_b32 v16, v11 offset:2048
    s_cmp_eq_u32 s41, 2
    s_cbranch_scc1 L_mn_gemm
    s_cmp_lg_u32 s41, 5
    s_cbranch_scc1 L_mn_ldd2
    s_call_b64 s[62:63], L_mn_epi
    s_waitcnt vmcnt(0)
L_mn_ldd2:
    s_mov_b32 s41, 0
    v_mov_b32 v8, 1
    v_mov_b32 v9, 0
    s_mov_b64 exec, 1
    buffer_store_byte v8, v9, s[96:99], s53 offen sc1
    s_mov_b64 exec, -1
    s_waitcnt lgkmcnt(0)
    s_branch L_mn_gemm
L_gm_setup:
    s_lshr_b32 s51, s33, 3
    s_lshl_b32 s51, s51, 2
    s_add_u32 s51, s51, s34
    s_cmp_lt_u32 s34, 4
    s_cselect_b32 s36, 0, 12
    s_add_u32 s51, s51, s36
    s_and_b32 s52, s33, 7
    s_sub_u32 s35, s32, 4
    s_load_dwordx2 s[56:57], s[0:1], 120
    s_load_dwordx2 s[58:59], s[0:1], 0
    s_load_dwordx2 s[60:61], s[0:1], 104
    v_lshlrev_b32 v240, 4, v1
    s_waitcnt lgkmcnt(0)
    s_lshl_b32 s36, s51, 5
    s_add_u32 s36, s36, s35
    s_lshl_b32 s36, s36, 14
    s_add_u32 s36, s36, 37748736
    s_add_u32 s4, s56, s36
    s_addc_u32 s5, s57, 0
    s_and_b32 s5, s5, 0xffff
    s_mov_b32 s6, 475136
    s_mov_b32 s7, 0x00020000
    s_lshl_b32 s36, s52, 5
    s_add_u32 s36, s36, s35
    s_mul_i32 s36, s36, 20480
    s_add_u32 s36, s36, 58720256
    s_add_u32 s8, s56, s36
    s_addc_u32 s9, s57, 0
    s_and_b32 s9, s9, 0xffff
    s_mov_b32 s10, 593920
    s_mov_b32 s11, 0x00020000
    s_mov_b32 s12, s58
    s_and_b32 s13, s59, 0xffff
    s_mov_b32 s14, 2621440
    s_mov_b32 s15, 0x00020000
    s_mul_i32 s36, s52, 327680
    s_add_u32 s36, s36, 54525952
    s_add_u32 s16, s56, s36
    s_addc_u32 s17, s57, 0
    s_and_b32 s17, s17, 0xffff
    s_mov_b32 s18, 327680
    s_mov_b32 s19, 0x00020000
    s_mov_b32 s24, s60
    s_and_b32 s25, s61, 0xffff
    s_mov_b32 s26, 2621440
    s_mov_b32 s27, 0x00020000
    v_and_b32 v241, 15, v1
    s_lshl_b32 s36, s51, 2
    s_add_u32 s36, s36, s35
    s_lshl_b32 s36, s36, 4
    v_add_u32 v241, s36, v241
    v_lshrrev_b32 v242, 4, v1
    v_mul_u32_u24 v243, 1280, v241
    v_lshl_add_u32 v243, v242, 3, v243
    s_mul_i32 s37, s52, 160
    v_add_u32 v243, s37, v243
    v_lshlrev_b32 v244, 14, v242
    v_lshl_add_u32 v244, v241, 1, v244
    v_lshlrev_b32 v245, 2, v241
    buffer_load_dwordx2 v[228:229], v243, s[12:15], 0 offen offset:0
    buffer_load_dwordx2 v[230:231], v243, s[12:15], 0 offen offset:32
    buffer_load_dwordx2 v[232:233], v243, s[12:15], 0 offen offset:64
    buffer_load_dwordx2 v[234:235], v243, s[12:15], 0 offen offset:96
    buffer_load_dwordx2 v[236:237], v243, s[12:15], 0 offen offset:128
    s_add_u32 s12, s56, 57671680
    s_addc_u32 s13, s57, 0
    s_and_b32 s13, s13, 0xffff
    s_mov_b32 s14, 8192
    s_mov_b32 s15, 0x00020000
    v_mov_b32 v148, 0
    v_mov_b32 v149, 0
    v_mov_b32 v150, 0
    v_mov_b32 v151, 0
    v_mov_b32 v152, 0
    v_mov_b32 v153, 0
    v_mov_b32 v154, 0
    v_mov_b32 v155, 0
    v_mov_b32 v156, 0
    v_mov_b32 v157, 0
    v_mov_b32 v158, 0
    v_mov_b32 v159, 0
    v_mov_b32 v160, 0
    v_mov_b32 v161, 0
    v_mov_b32 v162, 0
    v_mov_b32 v163, 0
    v_mov_b32 v164, 0
    v_mov_b32 v165, 0
    v_mov_b32 v166, 0
    v_mov_b32 v167, 0
    v_mov_b32 v168, 0
    v_mov_b32 v169, 0
    v_mov_b32 v170, 0
    v_mov_b32 v171, 0
    v_mov_b32 v172, 0
    v_mov_b32 v173, 0
    v_mov_b32 v174, 0
    v_mov_b32 v175, 0
    v_mov_b32 v176, 0
    v_mov_b32 v177, 0
    v_mov_b32 v178, 0
    v_mov_b32 v179, 0
    v_mov_b32 v180, 0
    v_mov_b32 v181, 0
    v_mov_b32 v182, 0
    v_mov_b32 v183, 0
    v_mov_b32 v184, 0
    v_mov_b32 v185, 0
    v_mov_b32 v186, 0
    v_mov_b32 v187, 0
    v_mov_b32 v188, 0
    v_mov_b32 v189, 0
    v_mov_b32 v190, 0
    v_mov_b32 v191, 0
    v_mov_b32 v192, 0
    v_mov_b32 v193, 0
    v_mov_b32 v194, 0
    v_mov_b32 v195, 0
    v_mov_b32 v196, 0
    v_mov_b32 v197, 0
    v_mov_b32 v198, 0
    v_mov_b32 v199, 0
    v_mov_b32 v200, 0
    v_mov_b32 v201, 0
    v_mov_b32 v202, 0
    v_mov_b32 v203, 0
    v_mov_b32 v204, 0
    v_mov_b32 v205, 0
    v_mov_b32 v206, 0
    v_mov_b32 v207, 0
    v_mov_b32 v208, 0
    v_mov_b32 v209, 0
    v_mov_b32 v210, 0
    v_mov_b32 v211, 0
    v_mov_b32 v212, 0
    v_mov_b32 v213, 0
    v_mov_b32 v214, 0
    v_mov_b32 v215, 0
    v_mov_b32 v216, 0
    v_mov_b32 v217, 0
    v_mov_b32 v218, 0
    v_mov_b32 v219, 0
    v_mov_b32 v220, 0
    v_mov_b32 v221, 0
    v_mov_b32 v222, 0
    v_mov_b32 v223, 0
    v_mov_b32 v224, 0
    v_mov_b32 v225, 0
    v_mov_b32 v226, 0
    v_mov_b32 v227, 0
    v_and_b32 v246, 7, v1
    v_lshlrev_b32 v246, 1, v246
    s_lshl_b32 s36, s36, 3
    v_add_u32 v246, s36, v246
    v_and_b32 v241, 1, v1
    v_lshrrev_b32 v242, 1, v1
    s_mul_i32 s36, s52, 10
    v_add_u32 v242, s36, v242
    s_add_u32 s36, s51, 96
    v_mov_b32 v238, s36
    v_cmp_gt_u32 vcc, 20, v1
    s_nop 1
    v_cndmask_b32 v242, v238, v242, vcc
    v_lshlrev_b32 v242, 7, v242
    v_lshl_add_u32 v242, v241, 2, v242
    v_add_u32 v242, 24576, v242
    v_lshlrev_b32 v251, 2, v1
    buffer_load_dword v250, v251, s[28:31], 0 offen sc1
    s_mov_b32 s41, 2
    s_setpc_b64 s[62:63]
L_mn_gemm:
    s_cmp_lg_u32 s41, 0
    s_cbranch_scc1 L_gm_run
    s_call_b64 s[62:63], L_gm_setup
L_gm_run:
    s_setprio 3
    s_mov_b32 s48, 0xff
    s_lshl_b32 s42, s35, 8
    v_mov_b32 v241, s42
    s_lshl_b32 s49, s34, 1
    s_sub_u32 s49, 29, s49
    s_mov_b32 s42, 0
L_gm_pd1:
    ds_read_b32 v238, v241 offset:0
    s_waitcnt lgkmcnt(0)
    v_sub_u32 v238, v238, s49
    v_ashrrev_i32 v238, 31, v238
    v_cmp_ne_u32 vcc, 0, v238
    s_add_u32 s42, s42, 1
    s_cbranch_vccz L_gm_pd1_ok
    s_sleep 8
    s_cmp_lt_u32 s42, 65536
    s_cbranch_scc1 L_gm_pd1
L_gm_pd1_ok:
    s_waitcnt vmcnt(0)
    v_and_b32 v238, 0x04040404, v250
    v_cmp_ne_u32 vcc, 0x04040404, v238
    s_cbranch_vccz L_gm_p1_ok
    s_mov_b32 s42, 0
L_gm_p1:
    buffer_load_dword v238, v251, s[28:31], 0 offen sc1
    s_waitcnt vmcnt(0)
    v_not_b32 v238, v238
    v_and_b32 v238, 0x04040404, v238
    v_cmp_ne_u32 vcc, 0, v238
    s_add_u32 s42, s42, 1
    s_cbranch_vccz L_gm_p1_ok
    s_sleep 8
    s_cmp_lt_u32 s42, 65536
    s_cbranch_scc1 L_gm_p1
L_gm_p1_ok:
    buffer_load_ushort v239, v246, s[96:99], 0 offen sc1
    s_mov_b32 s38, 0
    s_mov_b32 s39, 4096
    buffer_load_dwordx4 v[20:23], v240, s[8:11], s38 offen offset:0 sc1
    buffer_load_dwordx4 v[24:27], v240, s[8:11], s38 offen offset:1024 sc1
    buffer_load_dwordx4 v[28:31], v240, s[8:11], s38 offen offset:2048 sc1
    buffer_load_dwordx4 v[32:35], v240, s[8:11], s38 offen offset:3072 sc1
    buffer_load_dwordx4 v[36:39], v240, s[8:11], s39 offen sc1
    s_add_u32 s38, s38, 5120
    s_add_u32 s39, s39, 5120
    buffer_load_dwordx4 v[56:59], v240, s[8:11], s38 offen offset:0 sc1
    buffer_load_dwordx4 v[60:63], v240, s[8:11], s38 offen offset:1024 sc1
    buffer_load_dwordx4 v[64:67], v240, s[8:11], s38 offen offset:2048 sc1
    buffer_load_dwordx4 v[68:71], v240, s[8:11], s38 offen offset:3072 sc1
    buffer_load_dwordx4 v[72:75], v240, s[8:11], s39 offen sc1
    s_add_u32 s38, s38, 5120
    s_add_u32 s39, s39, 5120
    buffer_load_dwordx4 v[92:95], v240, s[8:11], s38 offen offset:0 sc1
    buffer_load_dwordx4 v[96:99], v240, s[8:11], s38 offen offset:1024 sc1
    buffer_load_dwordx4 v[100:103], v240, s[8:11], s38 offen offset:2048 sc1
    buffer_load_dwordx4 v[104:107], v240, s[8:11], s38 offen offset:3072 sc1
    buffer_load_dwordx4 v[108:111], v240, s[8:11], s39 offen sc1
    s_add_u32 s38, s38, 5120
    s_add_u32 s39, s39, 5120
    s_waitcnt vmcnt(15)
    s_mov_b32 s42, 0
L_gm_k0:
    v_cmp_eq_u32 vcc, 0x0101, v239
    s_nop 0
    s_sub_u32 s36, 0, s48
    s_and_b32 s36, s36, s48
    s_and_b32 s36, vcc_lo, s36
    s_cbranch_scc1 L_gm_k0_ok
    s_sleep 3
    buffer_load_ushort v239, v246, s[96:99], 0 offen sc1
    s_waitcnt vmcnt(0)
    s_add_u32 s42, s42, 1
    s_cmp_lt_u32 s42, 65536
    s_cbranch_scc1 L_gm_k0
    s_mov_b32 s36, s48
L_gm_k0_ok:
    s_ff1_i32_b32 s36, s36
    s_bitset0_b32 s48, s36
    s_lshl_b32 s37, s36, 16
    s_mul_i32 s38, s36, 81920
    s_add_u32 s39, s38, 4096
    buffer_load_dwordx4 v[4:7], v240, s[4:7], s37 offen offset:0 sc1
    buffer_load_dwordx4 v[8:11], v240, s[4:7], s37 offen offset:1024 sc1
    buffer_load_dwordx4 v[12:15], v240, s[4:7], s37 offen offset:2048 sc1
    buffer_load_dwordx4 v[16:19], v240, s[4:7], s37 offen offset:3072 sc1
    s_add_u32 s37, s37, 4096
    s_add_u32 s38, s38, 5120
    s_add_u32 s39, s39, 5120
    buffer_load_dwordx4 v[40:43], v240, s[4:7], s37 offen offset:0 sc1
    buffer_load_dwordx4 v[44:47], v240, s[4:7], s37 offen offset:1024 sc1
    buffer_load_dwordx4 v[48:51], v240, s[4:7], s37 offen offset:2048 sc1
    buffer_load_dwordx4 v[52:55], v240, s[4:7], s37 offen offset:3072 sc1
    s_add_u32 s37, s37, 4096
    s_add_u32 s38, s38, 5120
    s_add_u32 s39, s39, 5120
    buffer_load_dwordx4 v[76:79], v240, s[4:7], s37 offen offset:0 sc1
    buffer_load_dwordx4 v[80:83], v240, s[4:7], s37 offen offset:1024 sc1
    buffer_load_dwordx4 v[84:87], v240, s[4:7], s37 offen offset:2048 sc1
    buffer_load_dwordx4 v[88:91], v240, s[4:7], s37 offen offset:3072 sc1
    s_add_u32 s37, s37, 4096
    s_add_u32 s38, s38, 5120
    s_add_u32 s39, s39, 5120
    v_and_b32 v241, 3, v1
    v_mul_u32_u24 v241, 260, v241
    s_lshl_b32 s49, s34, 1
    s_sub_u32 s49, 65535, s49
    s_mov_b32 s42, 0
L_gm_pd2:
    ds_read_b32 v238, v241 offset:0
    s_waitcnt lgkmcnt(0)
    v_sub_u32 v238, v238, s49
    v_ashrrev_i32 v238, 31, v238
    v_cmp_ne_u32 vcc, 0, v238
    s_add_u32 s42, s42, 1
    s_cbranch_vccz L_gm_pd2_ok
    s_sleep 1
    s_cmp_lt_u32 s42, 65536
    s_cbranch_scc1 L_gm_pd2
L_gm_pd2_ok:
    s_setprio 2
    s_mov_b32 s40, 0
    s_waitcnt vmcnt(8)
    v_mfma_f32_16x16x32_bf16 v[148:151], v[20:23], v[4:7], v[148:151]
    buffer_load_dwordx4 v[112:115], v240, s[4:7], s37 offen offset:0 sc1
    v_mfma_f32_16x16x32_bf16 v[152:155], v[20:23], v[8:11], v[152:155]
    v_mfma_f32_16x16x32_bf16 v[156:159], v[20:23], v[12:15], v[156:159]
    buffer_load_dwordx4 v[116:119], v240, s[4:7], s37 offen offset:1024 sc1
    v_mfma_f32_16x16x32_bf16 v[160:163], v[20:23], v[16:19], v[160:163]
    v_mfma_f32_16x16x32_bf16 v[164:167], v[24:27], v[4:7], v[164:167]
    buffer_load_dwordx4 v[120:123], v240, s[4:7], s37 offen offset:2048 sc1
    v_mfma_f32_16x16x32_bf16 v[168:171], v[24:27], v[8:11], v[168:171]
    v_mfma_f32_16x16x32_bf16 v[172:175], v[24:27], v[12:15], v[172:175]
    buffer_load_dwordx4 v[124:127], v240, s[4:7], s37 offen offset:3072 sc1
    v_mfma_f32_16x16x32_bf16 v[176:179], v[24:27], v[16:19], v[176:179]
    v_mfma_f32_16x16x32_bf16 v[180:183], v[28:31], v[4:7], v[180:183]
    buffer_load_dwordx4 v[128:131], v240, s[8:11], s38 offen offset:0 sc1
    v_mfma_f32_16x16x32_bf16 v[184:187], v[28:31], v[8:11], v[184:187]
    v_mfma_f32_16x16x32_bf16 v[188:191], v[28:31], v[12:15], v[188:191]
    v_mfma_f32_16x16x32_bf16 v[192:195], v[28:31], v[16:19], v[192:195]
    buffer_load_dwordx4 v[132:135], v240, s[8:11], s38 offen offset:1024 sc1
    v_mfma_f32_16x16x32_bf16 v[196:199], v[32:35], v[4:7], v[196:199]
    v_mfma_f32_16x16x32_bf16 v[200:203], v[32:35], v[8:11], v[200:203]
    buffer_load_dwordx4 v[136:139], v240, s[8:11], s38 offen offset:2048 sc1
    v_mfma_f32_16x16x32_bf16 v[204:207], v[32:35], v[12:15], v[204:207]
    v_mfma_f32_16x16x32_bf16 v[208:211], v[32:35], v[16:19], v[208:211]
    buffer_load_dwordx4 v[140:143], v240, s[8:11], s38 offen offset:3072 sc1
    v_mfma_f32_16x16x32_bf16 v[212:215], v[36:39], v[4:7], v[212:215]
    v_mfma_f32_16x16x32_bf16 v[216:219], v[36:39], v[8:11], v[216:219]
    buffer_load_dwordx4 v[144:147], v240, s[8:11], s39 offen sc1
    v_mfma_f32_16x16x32_bf16 v[220:223], v[36:39], v[12:15], v[220:223]
    v_mfma_f32_16x16x32_bf16 v[224:227], v[36:39], v[16:19], v[224:227]
    s_mov_b32 s42, 0
L_gm_k2:
    v_cmp_eq_u32 vcc, 0x0101, v239
    s_nop 0
    s_sub_u32 s36, 0, s48
    s_and_b32 s36, s36, s48
    s_and_b32 s36, vcc_lo, s36
    s_cbranch_scc1 L_gm_k2_ok
    s_sleep 3
    buffer_load_ushort v239, v246, s[96:99], 0 offen sc1
    s_waitcnt vmcnt(0)
    s_add_u32 s42, s42, 1
    s_cmp_lt_u32 s42, 65536
    s_cbranch_scc1 L_gm_k2
    s_mov_b32 s36, s48
L_gm_k2_ok:
    s_ff1_i32_b32 s36, s36
    s_bitset0_b32 s48, s36
    s_lshl_b32 s37, s36, 16
    s_mul_i32 s38, s36, 81920
    s_add_u32 s39, s38, 4096
    s_waitcnt vmcnt(13)
    v_mfma_f32_16x16x32_bf16 v[148:151], v[56:59], v[40:43], v[148:151]
    buffer_load_ushort v239, v246, s[96:99], 0 offen sc1
    v_mfma_f32_16x16x32_bf16 v[152:155], v[56:59], v[44:47], v[152:155]
    buffer_load_dwordx4 v[4:7], v240, s[4:7], s37 offen offset:0 sc1
    v_mfma_f32_16x16x32_bf16 v[156:159], v[56:59], v[48:51], v[156:159]
    v_mfma_f32_16x16x32_bf16 v[160:163], v[56:59], v[52:55], v[160:163]
    buffer_load_dwordx4 v[8:11], v240, s[4:7], s37 offen offset:1024 sc1
    v_mfma_f32_16x16x32_bf16 v[164:167], v[60:63], v[40:43], v[164:167]
    v_mfma_f32_16x16x32_bf16 v[168:171], v[60:63], v[44:47], v[168:171]
    buffer_load_dwordx4 v[12:15], v240, s[4:7], s37 offen offset:2048 sc1
    v_mfma_f32_16x16x32_bf16 v[172:175], v[60:63], v[48:51], v[172:175]
    v_mfma_f32_16x16x32_bf16 v[176:179], v[60:63], v[52:55], v[176:179]
    buffer_load_dwordx4 v[16:19], v240, s[4:7], s37 offen offset:3072 sc1
    v_mfma_f32_16x16x32_bf16 v[180:183], v[64:67], v[40:43], v[180:183]
    v_mfma_f32_16x16x32_bf16 v[184:187], v[64:67], v[44:47], v[184:187]
    buffer_load_dwordx4 v[20:23], v240, s[8:11], s38 offen offset:0 sc1
    v_mfma_f32_16x16x32_bf16 v[188:191], v[64:67], v[48:51], v[188:191]
    buffer_load_dwordx4 v[24:27], v240, s[8:11], s38 offen offset:1024 sc1
    v_mfma_f32_16x16x32_bf16 v[192:195], v[64:67], v[52:55], v[192:195]
    v_mfma_f32_16x16x32_bf16 v[196:199], v[68:71], v[40:43], v[196:199]
    buffer_load_dwordx4 v[28:31], v240, s[8:11], s38 offen offset:2048 sc1
    v_mfma_f32_16x16x32_bf16 v[200:203], v[68:71], v[44:47], v[200:203]
    v_mfma_f32_16x16x32_bf16 v[204:207], v[68:71], v[48:51], v[204:207]
    buffer_load_dwordx4 v[32:35], v240, s[8:11], s38 offen offset:3072 sc1
    v_mfma_f32_16x16x32_bf16 v[208:211], v[68:71], v[52:55], v[208:211]
    v_mfma_f32_16x16x32_bf16 v[212:215], v[72:75], v[40:43], v[212:215]
    buffer_load_dwordx4 v[36:39], v240, s[8:11], s39 offen sc1
    v_mfma_f32_16x16x32_bf16 v[216:219], v[72:75], v[44:47], v[216:219]
    v_mfma_f32_16x16x32_bf16 v[220:223], v[72:75], v[48:51], v[220:223]
    s_add_u32 s37, s37, 4096
    s_add_u32 s38, s38, 5120
    s_add_u32 s39, s39, 5120
    v_mfma_f32_16x16x32_bf16 v[224:227], v[72:75], v[52:55], v[224:227]
    s_branch L_gm_go
L_gm_loop:
    s_waitcnt vmcnt(18)
    v_mfma_f32_16x16x32_bf16 v[148:151], v[20:23], v[4:7], v[148:151]
    buffer_load_dwordx4 v[112:115], v240, s[4:7], s37 offen offset:0 sc1
    v_mfma_f32_16x16x32_bf16 v[152:155], v[20:23], v[8:11], v[152:155]
    v_mfma_f32_16x16x32_bf16 v[156:159], v[20:23], v[12:15], v[156:159]
    buffer_load_dwordx4 v[116:119], v240, s[4:7], s37 offen offset:1024 sc1
    v_mfma_f32_16x16x32_bf16 v[160:163], v[20:23], v[16:19], v[160:163]
    v_mfma_f32_16x16x32_bf16 v[164:167], v[24:27], v[4:7], v[164:167]
    buffer_load_dwordx4 v[120:123], v240, s[4:7], s37 offen offset:2048 sc1
    v_mfma_f32_16x16x32_bf16 v[168:171], v[24:27], v[8:11], v[168:171]
    v_mfma_f32_16x16x32_bf16 v[172:175], v[24:27], v[12:15], v[172:175]
    buffer_load_dwordx4 v[124:127], v240, s[4:7], s37 offen offset:3072 sc1
    v_mfma_f32_16x16x32_bf16 v[176:179], v[24:27], v[16:19], v[176:179]
    v_mfma_f32_16x16x32_bf16 v[180:183], v[28:31], v[4:7], v[180:183]
    buffer_load_dwordx4 v[128:131], v240, s[8:11], s38 offen offset:0 sc1
    v_mfma_f32_16x16x32_bf16 v[184:187], v[28:31], v[8:11], v[184:187]
    v_mfma_f32_16x16x32_bf16 v[188:191], v[28:31], v[12:15], v[188:191]
    v_mfma_f32_16x16x32_bf16 v[192:195], v[28:31], v[16:19], v[192:195]
    buffer_load_dwordx4 v[132:135], v240, s[8:11], s38 offen offset:1024 sc1
    v_mfma_f32_16x16x32_bf16 v[196:199], v[32:35], v[4:7], v[196:199]
    v_mfma_f32_16x16x32_bf16 v[200:203], v[32:35], v[8:11], v[200:203]
    buffer_load_dwordx4 v[136:139], v240, s[8:11], s38 offen offset:2048 sc1
    v_mfma_f32_16x16x32_bf16 v[204:207], v[32:35], v[12:15], v[204:207]
    v_mfma_f32_16x16x32_bf16 v[208:211], v[32:35], v[16:19], v[208:211]
    buffer_load_dwordx4 v[140:143], v240, s[8:11], s38 offen offset:3072 sc1
    v_mfma_f32_16x16x32_bf16 v[212:215], v[36:39], v[4:7], v[212:215]
    v_mfma_f32_16x16x32_bf16 v[216:219], v[36:39], v[8:11], v[216:219]
    buffer_load_dwordx4 v[144:147], v240, s[8:11], s39 offen sc1
    v_mfma_f32_16x16x32_bf16 v[220:223], v[36:39], v[12:15], v[220:223]
    v_mfma_f32_16x16x32_bf16 v[224:227], v[36:39], v[16:19], v[224:227]
    s_mov_b32 s42, 0
L_gm_k1:
    v_cmp_eq_u32 vcc, 0x0101, v239
    s_nop 0
    s_sub_u32 s36, 0, s48
    s_and_b32 s36, s36, s48
    s_and_b32 s36, vcc_lo, s36
    s_cbranch_scc1 L_gm_k1_ok
    s_sleep 3
    buffer_load_ushort v239, v246, s[96:99], 0 offen sc1
    s_waitcnt vmcnt(0)
    s_add_u32 s42, s42, 1
    s_cmp_lt_u32 s42, 65536
    s_cbranch_scc1 L_gm_k1
    s_mov_b32 s36, s48
L_gm_k1_ok:
    s_ff1_i32_b32 s36, s36
    s_bitset0_b32 s48, s36
    s_lshl_b32 s37, s36, 16
    s_mul_i32 s38, s36, 81920
    s_add_u32 s39, s38, 4096
    s_waitcnt vmcnt(18)
    v_mfma_f32_16x16x32_bf16 v[148:151], v[56:59], v[40:43], v[148:151]
    buffer_load_ushort v239, v246, s[96:99], 0 offen sc1
    v_mfma_f32_16x16x32_bf16 v[152:155], v[56:59], v[44:47], v[152:155]
    buffer_load_dwordx4 v[4:7], v240, s[4:7], s37 offen offset:0 sc1
    v_mfma_f32_16x16x32_bf16 v[156:159], v[56:59], v[48:51], v[156:159]
    v_mfma_f32_16x16x32_bf16 v[160:163], v[56:59], v[52:55], v[160:163]
    buffer_load_dwordx4 v[8:11], v240, s[4:7], s37 offen offset:1024 sc1
    v_mfma_f32_16x16x32_bf16 v[164:167], v[60:63], v[40:43], v[164:167]
    v_mfma_f32_16x16x32_bf16 v[168:171], v[60:63], v[44:47], v[168:171]
    buffer_load_dwordx4 v[12:15], v240, s[4:7], s37 offen offset:2048 sc1
    v_mfma_f32_16x16x32_bf16 v[172:175], v[60:63], v[48:51], v[172:175]
    v_mfma_f32_16x16x32_bf16 v[176:179], v[60:63], v[52:55], v[176:179]
    buffer_load_dwordx4 v[16:19], v240, s[4:7], s37 offen offset:3072 sc1
    v_mfma_f32_16x16x32_bf16 v[180:183], v[64:67], v[40:43], v[180:183]
    v_mfma_f32_16x16x32_bf16 v[184:187], v[64:67], v[44:47], v[184:187]
    buffer_load_dwordx4 v[20:23], v240, s[8:11], s38 offen offset:0 sc1
    v_mfma_f32_16x16x32_bf16 v[188:191], v[64:67], v[48:51], v[188:191]
    buffer_load_dwordx4 v[24:27], v240, s[8:11], s38 offen offset:1024 sc1
    v_mfma_f32_16x16x32_bf16 v[192:195], v[64:67], v[52:55], v[192:195]
    v_mfma_f32_16x16x32_bf16 v[196:199], v[68:71], v[40:43], v[196:199]
    buffer_load_dwordx4 v[28:31], v240, s[8:11], s38 offen offset:2048 sc1
    v_mfma_f32_16x16x32_bf16 v[200:203], v[68:71], v[44:47], v[200:203]
    v_mfma_f32_16x16x32_bf16 v[204:207], v[68:71], v[48:51], v[204:207]
    buffer_load_dwordx4 v[32:35], v240, s[8:11], s38 offen offset:3072 sc1
    v_mfma_f32_16x16x32_bf16 v[208:211], v[68:71], v[52:55], v[208:211]
    v_mfma_f32_16x16x32_bf16 v[212:215], v[72:75], v[40:43], v[212:215]
    buffer_load_dwordx4 v[36:39], v240, s[8:11], s39 offen sc1
    v_mfma_f32_16x16x32_bf16 v[216:219], v[72:75], v[44:47], v[216:219]
    v_mfma_f32_16x16x32_bf16 v[220:223], v[72:75], v[48:51], v[220:223]
    s_add_u32 s37, s37, 4096
    s_add_u32 s38, s38, 5120
    s_add_u32 s39, s39, 5120
    v_mfma_f32_16x16x32_bf16 v[224:227], v[72:75], v[52:55], v[224:227]
    s_cmp_eq_u32 s40, 6
    s_cbranch_scc1 L_gm_z1
L_gm_go:
    s_waitcnt vmcnt(18)
    v_mfma_f32_16x16x32_bf16 v[148:151], v[92:95], v[76:79], v[148:151]
    buffer_load_dwordx4 v[40:43], v240, s[4:7], s37 offen offset:0 sc1
    v_mfma_f32_16x16x32_bf16 v[152:155], v[92:95], v[80:83], v[152:155]
    v_mfma_f32_16x16x32_bf16 v[156:159], v[92:95], v[84:87], v[156:159]
    buffer_load_dwordx4 v[44:47], v240, s[4:7], s37 offen offset:1024 sc1
    v_mfma_f32_16x16x32_bf16 v[160:163], v[92:95], v[88:91], v[160:163]
    v_mfma_f32_16x16x32_bf16 v[164:167], v[96:99], v[76:79], v[164:167]
    buffer_load_dwordx4 v[48:51], v240, s[4:7], s37 offen offset:2048 sc1
    v_mfma_f32_16x16x32_bf16 v[168:171], v[96:99], v[80:83], v[168:171]
    v_mfma_f32_16x16x32_bf16 v[172:175], v[96:99], v[84:87], v[172:175]
    buffer_load_dwordx4 v[52:55], v240, s[4:7], s37 offen offset:3072 sc1
    v_mfma_f32_16x16x32_bf16 v[176:179], v[96:99], v[88:91], v[176:179]
    v_mfma_f32_16x16x32_bf16 v[180:183], v[100:103], v[76:79], v[180:183]
    buffer_load_dwordx4 v[56:59], v240, s[8:11], s38 offen offset:0 sc1
    v_mfma_f32_16x16x32_bf16 v[184:187], v[100:103], v[80:83], v[184:187]
    v_mfma_f32_16x16x32_bf16 v[188:191], v[100:103], v[84:87], v[188:191]
    buffer_load_dwordx4 v[60:63], v240, s[8:11], s38 offen offset:1024 sc1
    v_mfma_f32_16x16x32_bf16 v[192:195], v[100:103], v[88:91], v[192:195]
    v_mfma_f32_16x16x32_bf16 v[196:199], v[104:107], v[76:79], v[196:199]
    buffer_load_dwordx4 v[64:67], v240, s[8:11], s38 offen offset:2048 sc1
    v_mfma_f32_16x16x32_bf16 v[200:203], v[104:107], v[80:83], v[200:203]
    v_mfma_f32_16x16x32_bf16 v[204:207], v[104:107], v[84:87], v[204:207]
    buffer_load_dwordx4 v[68:71], v240, s[8:11], s38 offen offset:3072 sc1
    v_mfma_f32_16x16x32_bf16 v[208:211], v[104:107], v[88:91], v[208:211]
    v_mfma_f32_16x16x32_bf16 v[212:215], v[108:111], v[76:79], v[212:215]
    buffer_load_dwordx4 v[72:75], v240, s[8:11], s39 offen sc1
    v_mfma_f32_16x16x32_bf16 v[216:219], v[108:111], v[80:83], v[216:219]
    v_mfma_f32_16x16x32_bf16 v[220:223], v[108:111], v[84:87], v[220:223]
    s_add_u32 s37, s37, 4096
    s_add_u32 s38, s38, 5120
    s_add_u32 s39, s39, 5120
    v_mfma_f32_16x16x32_bf16 v[224:227], v[108:111], v[88:91], v[224:227]
    s_waitcnt vmcnt(18)
    v_mfma_f32_16x16x32_bf16 v[148:151], v[128:131], v[112:115], v[148:151]
    buffer_load_dwordx4 v[76:79], v240, s[4:7], s37 offen offset:0 sc1
    v_mfma_f32_16x16x32_bf16 v[152:155], v[128:131], v[116:119], v[152:155]
    v_mfma_f32_16x16x32_bf16 v[156:159], v[128:131], v[120:123], v[156:159]
    buffer_load_dwordx4 v[80:83], v240, s[4:7], s37 offen offset:1024 sc1
    v_mfma_f32_16x16x32_bf16 v[160:163], v[128:131], v[124:127], v[160:163]
    v_mfma_f32_16x16x32_bf16 v[164:167], v[132:135], v[112:115], v[164:167]
    buffer_load_dwordx4 v[84:87], v240, s[4:7], s37 offen offset:2048 sc1
    v_mfma_f32_16x16x32_bf16 v[168:171], v[132:135], v[116:119], v[168:171]
    v_mfma_f32_16x16x32_bf16 v[172:175], v[132:135], v[120:123], v[172:175]
    buffer_load_dwordx4 v[88:91], v240, s[4:7], s37 offen offset:3072 sc1
    v_mfma_f32_16x16x32_bf16 v[176:179], v[132:135], v[124:127], v[176:179]
    v_mfma_f32_16x16x32_bf16 v[180:183], v[136:139], v[112:115], v[180:183]
    buffer_load_dwordx4 v[92:95], v240, s[8:11], s38 offen offset:0 sc1
    v_mfma_f32_16x16x32_bf16 v[184:187], v[136:139], v[116:119], v[184:187]
    v_mfma_f32_16x16x32_bf16 v[188:191], v[136:139], v[120:123], v[188:191]
    buffer_load_dwordx4 v[96:99], v240, s[8:11], s38 offen offset:1024 sc1
    v_mfma_f32_16x16x32_bf16 v[192:195], v[136:139], v[124:127], v[192:195]
    v_mfma_f32_16x16x32_bf16 v[196:199], v[140:143], v[112:115], v[196:199]
    buffer_load_dwordx4 v[100:103], v240, s[8:11], s38 offen offset:2048 sc1
    v_mfma_f32_16x16x32_bf16 v[200:203], v[140:143], v[116:119], v[200:203]
    v_mfma_f32_16x16x32_bf16 v[204:207], v[140:143], v[120:123], v[204:207]
    buffer_load_dwordx4 v[104:107], v240, s[8:11], s38 offen offset:3072 sc1
    v_mfma_f32_16x16x32_bf16 v[208:211], v[140:143], v[124:127], v[208:211]
    v_mfma_f32_16x16x32_bf16 v[212:215], v[144:147], v[112:115], v[212:215]
    buffer_load_dwordx4 v[108:111], v240, s[8:11], s39 offen sc1
    v_mfma_f32_16x16x32_bf16 v[216:219], v[144:147], v[116:119], v[216:219]
    v_mfma_f32_16x16x32_bf16 v[220:223], v[144:147], v[120:123], v[220:223]
    s_add_u32 s37, s37, 4096
    s_add_u32 s38, s38, 5120
    s_add_u32 s39, s39, 5120
    v_mfma_f32_16x16x32_bf16 v[224:227], v[144:147], v[124:127], v[224:227]
    s_add_u32 s40, s40, 1
    s_cmp_lt_u32 s40, 7
    s_cbranch_scc1 L_gm_loop
    s_waitcnt vmcnt(18)
    v_mfma_f32_16x16x32_bf16 v[148:151], v[20:23], v[4:7], v[148:151]
    buffer_load_dwordx4 v[112:115], v240, s[4:7], s37 offen offset:0 sc1
    v_mfma_f32_16x16x32_bf16 v[152:155], v[20:23], v[8:11], v[152:155]
    v_mfma_f32_16x16x32_bf16 v[156:159], v[20:23], v[12:15], v[156:159]
    buffer_load_dwordx4 v[116:119], v240, s[4:7], s37 offen offset:1024 sc1
    v_mfma_f32_16x16x32_bf16 v[160:163], v[20:23], v[16:19], v[160:163]
    v_mfma_f32_16x16x32_bf16 v[164:167], v[24:27], v[4:7], v[164:167]
    buffer_load_dwordx4 v[120:123], v240, s[4:7], s37 offen offset:2048 sc1
    v_mfma_f32_16x16x32_bf16 v[168:171], v[24:27], v[8:11], v[168:171]
    v_mfma_f32_16x16x32_bf16 v[172:175], v[24:27], v[12:15], v[172:175]
    buffer_load_dwordx4 v[124:127], v240, s[4:7], s37 offen offset:3072 sc1
    v_mfma_f32_16x16x32_bf16 v[176:179], v[24:27], v[16:19], v[176:179]
    v_mfma_f32_16x16x32_bf16 v[180:183], v[28:31], v[4:7], v[180:183]
    buffer_load_dwordx4 v[128:131], v240, s[8:11], s38 offen offset:0 sc1
    v_mfma_f32_16x16x32_bf16 v[184:187], v[28:31], v[8:11], v[184:187]
    v_mfma_f32_16x16x32_bf16 v[188:191], v[28:31], v[12:15], v[188:191]
    v_mfma_f32_16x16x32_bf16 v[192:195], v[28:31], v[16:19], v[192:195]
    buffer_load_dwordx4 v[132:135], v240, s[8:11], s38 offen offset:1024 sc1
    v_mfma_f32_16x16x32_bf16 v[196:199], v[32:35], v[4:7], v[196:199]
    v_mfma_f32_16x16x32_bf16 v[200:203], v[32:35], v[8:11], v[200:203]
    buffer_load_dwordx4 v[136:139], v240, s[8:11], s38 offen offset:2048 sc1
    v_mfma_f32_16x16x32_bf16 v[204:207], v[32:35], v[12:15], v[204:207]
    v_mfma_f32_16x16x32_bf16 v[208:211], v[32:35], v[16:19], v[208:211]
    buffer_load_dwordx4 v[140:143], v240, s[8:11], s38 offen offset:3072 sc1
    v_mfma_f32_16x16x32_bf16 v[212:215], v[36:39], v[4:7], v[212:215]
    v_mfma_f32_16x16x32_bf16 v[216:219], v[36:39], v[8:11], v[216:219]
    buffer_load_dwordx4 v[144:147], v240, s[8:11], s39 offen sc1
    v_mfma_f32_16x16x32_bf16 v[220:223], v[36:39], v[12:15], v[220:223]
    v_mfma_f32_16x16x32_bf16 v[224:227], v[36:39], v[16:19], v[224:227]
    v_cmp_ne_u32 vcc, 0x01010101, v238
    s_cbranch_vccnz L_gm_z2
L_gm_z3:
    s_waitcnt vmcnt(18)
    v_mfma_f32_16x16x32_bf16 v[148:151], v[56:59], v[40:43], v[148:151]
    buffer_load_dword v245, v245, s[12:15], 0 offen sc1
    s_mov_b32 s36, 0
    buffer_load_ushort v4, v244, s[16:19], s36 offen sc1
    v_mfma_f32_16x16x32_bf16 v[152:155], v[56:59], v[44:47], v[152:155]
    s_mov_b32 s36, 4096
    buffer_load_ushort v5, v244, s[16:19], s36 offen sc1
    v_mfma_f32_16x16x32_bf16 v[156:159], v[56:59], v[48:51], v[156:159]
    s_mov_b32 s36, 8192
    buffer_load_ushort v6, v244, s[16:19], s36 offen sc1
    v_mfma_f32_16x16x32_bf16 v[160:163], v[56:59], v[52:55], v[160:163]
    s_mov_b32 s36, 12288
    buffer_load_ushort v7, v244, s[16:19], s36 offen sc1
    v_mfma_f32_16x16x32_bf16 v[164:167], v[60:63], v[40:43], v[164:167]
    s_mov_b32 s36, 65536
    buffer_load_ushort v8, v244, s[16:19], s36 offen sc1
    v_mfma_f32_16x16x32_bf16 v[168:171], v[60:63], v[44:47], v[168:171]
    s_mov_b32 s36, 69632
    buffer_load_ushort v9, v244, s[16:19], s36 offen sc1
    v_mfma_f32_16x16x32_bf16 v[172:175], v[60:63], v[48:51], v[172:175]
    s_mov_b32 s36, 73728
    buffer_load_ushort v10, v244, s[16:19], s36 offen sc1
    v_mfma_f32_16x16x32_bf16 v[176:179], v[60:63], v[52:55], v[176:179]
    s_mov_b32 s36, 77824
    buffer_load_ushort v11, v244, s[16:19], s36 offen sc1
    v_mfma_f32_16x16x32_bf16 v[180:183], v[64:67], v[40:43], v[180:183]
    s_mov_b32 s36, 131072
    buffer_load_ushort v12, v244, s[16:19], s36 offen sc1
    v_mfma_f32_16x16x32_bf16 v[184:187], v[64:67], v[44:47], v[184:187]
    s_mov_b32 s36, 135168
    buffer_load_ushort v13, v244, s[16:19], s36 offen sc1
    v_mfma_f32_16x16x32_bf16 v[188:191], v[64:67], v[48:51], v[188:191]
    s_mov_b32 s36, 139264
    buffer_load_ushort v14, v244, s[16:19], s36 offen sc1
    v_mfma_f32_16x16x32_bf16 v[192:195], v[64:67], v[52:55], v[192:195]
    s_mov_b32 s36, 143360
    buffer_load_ushort v15, v244, s[16:19], s36 offen sc1
    v_mfma_f32_16x16x32_bf16 v[196:199], v[68:71], v[40:43], v[196:199]
    s_mov_b32 s36, 196608
    buffer_load_ushort v16, v244, s[16:19], s36 offen sc1
    v_mfma_f32_16x16x32_bf16 v[200:203], v[68:71], v[44:47], v[200:203]
    s_mov_b32 s36, 200704
    buffer_load_ushort v17, v244, s[16:19], s36 offen sc1
    v_mfma_f32_16x16x32_bf16 v[204:207], v[68:71], v[48:51], v[204:207]
    s_mov_b32 s36, 204800
    buffer_load_ushort v18, v244, s[16:19], s36 offen sc1
    v_mfma_f32_16x16x32_bf16 v[208:211], v[68:71], v[52:55], v[208:211]
    s_mov_b32 s36, 208896
    buffer_load_ushort v19, v244, s[16:19], s36 offen sc1
    v_mfma_f32_16x16x32_bf16 v[212:215], v[72:75], v[40:43], v[212:215]
    s_mov_b32 s36, 262144
    buffer_load_ushort v20, v244, s[16:19], s36 offen sc1
    v_mfma_f32_16x16x32_bf16 v[216:219], v[72:75], v[44:47], v[216:219]
    s_mov_b32 s36, 266240
    buffer_load_ushort v21, v244, s[16:19], s36 offen sc1
    v_mfma_f32_16x16x32_bf16 v[220:223], v[72:75], v[48:51], v[220:223]
    s_mov_b32 s36, 270336
    buffer_load_ushort v22, v244, s[16:19], s36 offen sc1
    v_mfma_f32_16x16x32_bf16 v[224:227], v[72:75], v[52:55], v[224:227]
    s_mov_b32 s36, 274432
    buffer_load_ushort v23, v244, s[16:19], s36 offen sc1
    v_min_u32 v241, 11, v1
    v_mul_u32_u24 v241, 260, v241
    s_mov_b32 s42, 0
L_gm_free:
    ds_read_b32 v242, v241 offset:0
    s_waitcnt lgkmcnt(0)
    v_not_b32 v242, v242
    v_and_b32 v242, 0x4000, v242
    v_cmp_ne_u32 vcc, 0, v242
    s_add_u32 s42, s42, 1
    s_cbranch_vccz L_gm_free_ok
    s_sleep 1
    s_cmp_lt_u32 s42, 65536
    s_cbranch_scc1 L_gm_free
L_gm_free_ok:
    s_waitcnt vmcnt(30)
    v_mfma_f32_16x16x32_bf16 v[148:151], v[92:95], v[76:79], v[148:151]
    v_mfma_f32_16x16x32_bf16 v[152:155], v[92:95], v[80:83], v[152:155]
    v_mfma_f32_16x16x32_bf16 v[156:159], v[92:95], v[84:87], v[156:159]
    v_mfma_f32_16x16x32_bf16 v[160:163], v[92:95], v[88:91], v[160:163]
    v_mfma_f32_16x16x32_bf16 v[164:167], v[96:99], v[76:79], v[164:167]
    v_mfma_f32_16x16x32_bf16 v[168:171], v[96:99], v[80:83], v[168:171]
    v_mfma_f32_16x16x32_bf16 v[172:175], v[96:99], v[84:87], v[172:175]
    v_mfma_f32_16x16x32_bf16 v[176:179], v[96:99], v[88:91], v[176:179]
    v_mfma_f32_16x16x32_bf16 v[180:183], v[100:103], v[76:79], v[180:183]
    v_mfma_f32_16x16x32_bf16 v[184:187], v[100:103], v[80:83], v[184:187]
    v_mfma_f32_16x16x32_bf16 v[188:191], v[100:103], v[84:87], v[188:191]
    v_mfma_f32_16x16x32_bf16 v[192:195], v[100:103], v[88:91], v[192:195]
    v_mfma_f32_16x16x32_bf16 v[196:199], v[104:107], v[76:79], v[196:199]
    v_mfma_f32_16x16x32_bf16 v[200:203], v[104:107], v[80:83], v[200:203]
    v_mfma_f32_16x16x32_bf16 v[204:207], v[104:107], v[84:87], v[204:207]
    v_mfma_f32_16x16x32_bf16 v[208:211], v[104:107], v[88:91], v[208:211]
    v_mfma_f32_16x16x32_bf16 v[212:215], v[108:111], v[76:79], v[212:215]
    v_mfma_f32_16x16x32_bf16 v[216:219], v[108:111], v[80:83], v[216:219]
    v_mfma_f32_16x16x32_bf16 v[220:223], v[108:111], v[84:87], v[220:223]
    v_mfma_f32_16x16x32_bf16 v[224:227], v[108:111], v[88:91], v[224:227]
    s_waitcnt vmcnt(21)
    v_mfma_f32_16x16x32_bf16 v[148:151], v[128:131], v[112:115], v[148:151]
    v_mfma_f32_16x16x32_bf16 v[152:155], v[128:131], v[116:119], v[152:155]
    v_mfma_f32_16x16x32_bf16 v[156:159], v[128:131], v[120:123], v[156:159]
    v_mfma_f32_16x16x32_bf16 v[160:163], v[128:131], v[124:127], v[160:163]
    v_mfma_f32_16x16x32_bf16 v[164:167], v[132:135], v[112:115], v[164:167]
    v_mfma_f32_16x16x32_bf16 v[168:171], v[132:135], v[116:119], v[168:171]
    v_mfma_f32_16x16x32_bf16 v[172:175], v[132:135], v[120:123], v[172:175]
    v_mfma_f32_16x16x32_bf16 v[176:179], v[132:135], v[124:127], v[176:179]
    v_mfma_f32_16x16x32_bf16 v[180:183], v[136:139], v[112:115], v[180:183]
    v_mfma_f32_16x16x32_bf16 v[184:187], v[136:139], v[116:119], v[184:187]
    v_mfma_f32_16x16x32_bf16 v[188:191], v[136:139], v[120:123], v[188:191]
    v_mfma_f32_16x16x32_bf16 v[192:195], v[136:139], v[124:127], v[192:195]
    v_mfma_f32_16x16x32_bf16 v[196:199], v[140:143], v[112:115], v[196:199]
    v_mfma_f32_16x16x32_bf16 v[200:203], v[140:143], v[116:119], v[200:203]
    v_mfma_f32_16x16x32_bf16 v[204:207], v[140:143], v[120:123], v[204:207]
    v_mfma_f32_16x16x32_bf16 v[208:211], v[140:143], v[124:127], v[208:211]
    v_mfma_f32_16x16x32_bf16 v[212:215], v[144:147], v[112:115], v[212:215]
    v_mfma_f32_16x16x32_bf16 v[216:219], v[144:147], v[116:119], v[216:219]
    v_mfma_f32_16x16x32_bf16 v[220:223], v[144:147], v[120:123], v[220:223]
    v_mfma_f32_16x16x32_bf16 v[224:227], v[144:147], v[124:127], v[224:227]
    s_mul_i32 s36, s35, 20480
    v_add_u32 v241, s36, v240
    s_nop 3
    ds_write_b128 v241, v[148:151] offset:32768
    ds_write_b128 v241, v[152:155] offset:33792
    ds_write_b128 v241, v[156:159] offset:34816
    ds_write_b128 v241, v[160:163] offset:35840
    ds_write_b128 v241, v[164:167] offset:36864
    ds_write_b128 v241, v[168:171] offset:37888
    ds_write_b128 v241, v[172:175] offset:38912
    ds_write_b128 v241, v[176:179] offset:39936
    ds_write_b128 v241, v[180:183] offset:40960
    ds_write_b128 v241, v[184:187] offset:41984
    ds_write_b128 v241, v[188:191] offset:43008
    ds_write_b128 v241, v[192:195] offset:44032
    ds_write_b128 v241, v[196:199] offset:45056
    ds_write_b128 v241, v[200:203] offset:46080
    ds_write_b128 v241, v[204:207] offset:47104
    ds_write_b128 v241, v[208:211] offset:48128
    ds_write_b128 v241, v[212:215] offset:49152
    ds_write_b128 v241, v[216:219] offset:50176
    ds_write_b128 v241, v[220:223] offset:51200
    ds_write_b128 v241, v[224:227] offset:52224
    s_lshl_b32 s36, s35, 10
    s_add_u32 s36, s36, 32768
    v_add_u32 v241, s36, v240
    v_add_u32 v242, 40960, v241
    s_waitcnt vmcnt(0)
    v_sub_f32 v238, 1.0, v245
    v_cvt_pk_bf16_f32 v238, v238, v238
    v_lshlrev_b32 v238, 16, v238
    v_lshlrev_b32 v108, 16, v228
    v_and_b32 v109, 0xffff0000, v228
    v_lshlrev_b32 v110, 16, v229
    v_and_b32 v111, 0xffff0000, v229
    v_lshlrev_b32 v4, 16, v4
    v_mul_f32 v108, v108, v4
    v_lshlrev_b32 v5, 16, v5
    v_mul_f32 v109, v109, v5
    v_lshlrev_b32 v6, 16, v6
    v_mul_f32 v110, v110, v6
    v_lshlrev_b32 v7, 16, v7
    v_mul_f32 v111, v111, v7
    v_cvt_pk_bf16_f32 v239, v108, v109
    v_lshlrev_b32 v108, 16, v239
    v_and_b32 v109, 0xffff0000, v239
    v_cvt_pk_bf16_f32 v239, v110, v111
    v_lshlrev_b32 v110, 16, v239
    v_and_b32 v111, 0xffff0000, v239
    v_mul_f32 v108, v245, v108
    v_mul_f32 v109, v245, v109
    v_mul_f32 v110, v245, v110
    v_mul_f32 v111, v245, v111
    v_cvt_pk_bf16_f32 v239, v108, v109
    v_lshlrev_b32 v108, 16, v239
    v_and_b32 v109, 0xffff0000, v239
    v_cvt_pk_bf16_f32 v239, v110, v111
    v_lshlrev_b32 v110, 16, v239
    v_and_b32 v111, 0xffff0000, v239
    v_lshlrev_b32 v112, 16, v230
    v_and_b32 v113, 0xffff0000, v230
    v_lshlrev_b32 v114, 16, v231
    v_and_b32 v115, 0xffff0000, v231
    v_lshlrev_b32 v8, 16, v8
    v_mul_f32 v112, v112, v8
    v_lshlrev_b32 v9, 16, v9
    v_mul_f32 v113, v113, v9
    v_lshlrev_b32 v10, 16, v10
    v_mul_f32 v114, v114, v10
    v_lshlrev_b32 v11, 16, v11
    v_mul_f32 v115, v115, v11
    v_cvt_pk_bf16_f32 v239, v112, v113
    v_lshlrev_b32 v112, 16, v239
    v_and_b32 v113, 0xffff0000, v239
    v_cvt_pk_bf16_f32 v239, v114, v115
    v_lshlrev_b32 v114, 16, v239
    v_and_b32 v115, 0xffff0000, v239
    v_mul_f32 v112, v245, v112
    v_mul_f32 v113, v245, v113
    v_mul_f32 v114, v245, v114
    v_mul_f32 v115, v245, v115
    v_cvt_pk_bf16_f32 v239, v112, v113
    v_lshlrev_b32 v112, 16, v239
    v_and_b32 v113, 0xffff0000, v239
    v_cvt_pk_bf16_f32 v239, v114, v115
    v_lshlrev_b32 v114, 16, v239
    v_and_b32 v115, 0xffff0000, v239
    v_lshlrev_b32 v116, 16, v232
    v_and_b32 v117, 0xffff0000, v232
    v_lshlrev_b32 v118, 16, v233
    v_and_b32 v119, 0xffff0000, v233
    v_lshlrev_b32 v12, 16, v12
    v_mul_f32 v116, v116, v12
    v_lshlrev_b32 v13, 16, v13
    v_mul_f32 v117, v117, v13
    v_lshlrev_b32 v14, 16, v14
    v_mul_f32 v118, v118, v14
    v_lshlrev_b32 v15, 16, v15
    v_mul_f32 v119, v119, v15
    v_cvt_pk_bf16_f32 v239, v116, v117
    v_lshlrev_b32 v116, 16, v239
    v_and_b32 v117, 0xffff0000, v239
    v_cvt_pk_bf16_f32 v239, v118, v119
    v_lshlrev_b32 v118, 16, v239
    v_and_b32 v119, 0xffff0000, v239
    v_mul_f32 v116, v245, v116
    v_mul_f32 v117, v245, v117
    v_mul_f32 v118, v245, v118
    v_mul_f32 v119, v245, v119
    v_cvt_pk_bf16_f32 v239, v116, v117
    v_lshlrev_b32 v116, 16, v239
    v_and_b32 v117, 0xffff0000, v239
    v_cvt_pk_bf16_f32 v239, v118, v119
    v_lshlrev_b32 v118, 16, v239
    v_and_b32 v119, 0xffff0000, v239
    v_lshlrev_b32 v120, 16, v234
    v_and_b32 v121, 0xffff0000, v234
    v_lshlrev_b32 v122, 16, v235
    v_and_b32 v123, 0xffff0000, v235
    v_lshlrev_b32 v16, 16, v16
    v_mul_f32 v120, v120, v16
    v_lshlrev_b32 v17, 16, v17
    v_mul_f32 v121, v121, v17
    v_lshlrev_b32 v18, 16, v18
    v_mul_f32 v122, v122, v18
    v_lshlrev_b32 v19, 16, v19
    v_mul_f32 v123, v123, v19
    v_cvt_pk_bf16_f32 v239, v120, v121
    v_lshlrev_b32 v120, 16, v239
    v_and_b32 v121, 0xffff0000, v239
    v_cvt_pk_bf16_f32 v239, v122, v123
    v_lshlrev_b32 v122, 16, v239
    v_and_b32 v123, 0xffff0000, v239
    v_mul_f32 v120, v245, v120
    v_mul_f32 v121, v245, v121
    v_mul_f32 v122, v245, v122
    v_mul_f32 v123, v245, v123
    v_cvt_pk_bf16_f32 v239, v120, v121
    v_lshlrev_b32 v120, 16, v239
    v_and_b32 v121, 0xffff0000, v239
    v_cvt_pk_bf16_f32 v239, v122, v123
    v_lshlrev_b32 v122, 16, v239
    v_and_b32 v123, 0xffff0000, v239
    v_lshlrev_b32 v124, 16, v236
    v_and_b32 v125, 0xffff0000, v236
    v_lshlrev_b32 v126, 16, v237
    v_and_b32 v127, 0xffff0000, v237
    v_lshlrev_b32 v20, 16, v20
    v_mul_f32 v124, v124, v20
    v_lshlrev_b32 v21, 16, v21
    v_mul_f32 v125, v125, v21
    v_lshlrev_b32 v22, 16, v22
    v_mul_f32 v126, v126, v22
    v_lshlrev_b32 v23, 16, v23
    v_mul_f32 v127, v127, v23
    v_cvt_pk_bf16_f32 v239, v124, v125
    v_lshlrev_b32 v124, 16, v239
    v_and_b32 v125, 0xffff0000, v239
    v_cvt_pk_bf16_f32 v239, v126, v127
    v_lshlrev_b32 v126, 16, v239
    v_and_b32 v127, 0xffff0000, v239
    v_mul_f32 v124, v245, v124
    v_mul_f32 v125, v245, v125
    v_mul_f32 v126, v245, v126
    v_mul_f32 v127, v245, v127
    v_cvt_pk_bf16_f32 v239, v124, v125
    v_lshlrev_b32 v124, 16, v239
    v_and_b32 v125, 0xffff0000, v239
    v_cvt_pk_bf16_f32 v239, v126, v127
    v_lshlrev_b32 v126, 16, v239
    v_and_b32 v127, 0xffff0000, v239
    s_waitcnt lgkmcnt(0)
    s_barrier
    ds_read_b128 v[28:31], v241 offset:0
    ds_read_b128 v[32:35], v241 offset:20480
    ds_read_b128 v[36:39], v242 offset:0
    ds_read_b128 v[40:43], v242 offset:20480
    ds_read_b128 v[44:47], v241 offset:4096
    ds_read_b128 v[48:51], v241 offset:24576
    ds_read_b128 v[52:55], v242 offset:4096
    ds_read_b128 v[56:59], v242 offset:24576
    ds_read_b128 v[60:63], v241 offset:8192
    ds_read_b128 v[64:67], v241 offset:28672
    ds_read_b128 v[68:71], v242 offset:8192
    ds_read_b128 v[72:75], v242 offset:28672
    ds_read_b128 v[76:79], v241 offset:12288
    ds_read_b128 v[80:83], v241 offset:32768
    ds_read_b128 v[84:87], v242 offset:12288
    ds_read_b128 v[88:91], v242 offset:32768
    ds_read_b128 v[92:95], v241 offset:16384
    ds_read_b128 v[96:99], v241 offset:36864
    ds_read_b128 v[100:103], v242 offset:16384
    ds_read_b128 v[104:107], v242 offset:36864
    s_waitcnt lgkmcnt(15)
    v_add_f32 v28, v28, v32
    v_add_f32 v36, v36, v40
    v_add_f32 v28, v28, v36
    v_add_f32 v29, v29, v33
    v_add_f32 v37, v37, v41
    v_add_f32 v29, v29, v37
    v_add_f32 v30, v30, v34
    v_add_f32 v38, v38, v42
    v_add_f32 v30, v30, v38
    v_add_f32 v31, v31, v35
    v_add_f32 v39, v39, v43
    v_add_f32 v31, v31, v39
    v_cvt_pk_bf16_f32 v239, v28, v29
    v_lshlrev_b32 v28, 16, v239
    v_and_b32 v29, 0xffff0000, v239
    v_cvt_pk_bf16_f32 v239, v30, v31
    v_lshlrev_b32 v30, 16, v239
    v_and_b32 v31, 0xffff0000, v239
    v_mul_f32 v28, v238, v28
    v_mul_f32 v29, v238, v29
    v_mul_f32 v30, v238, v30
    v_mul_f32 v31, v238, v31
    v_cvt_pk_bf16_f32 v239, v28, v29
    v_lshlrev_b32 v28, 16, v239
    v_and_b32 v29, 0xffff0000, v239
    v_cvt_pk_bf16_f32 v239, v30, v31
    v_lshlrev_b32 v30, 16, v239
    v_and_b32 v31, 0xffff0000, v239
    v_add_f32 v108, v108, v28
    v_add_f32 v109, v109, v29
    v_add_f32 v110, v110, v30
    v_add_f32 v111, v111, v31
    v_cvt_pk_bf16_f32 v148, v108, v109
    v_cvt_pk_bf16_f32 v149, v110, v111
    buffer_store_dwordx2 v[148:149], v243, s[24:27], 0 offen offset:0
    s_waitcnt lgkmcnt(12)
    v_add_f32 v44, v44, v48
    v_add_f32 v52, v52, v56
    v_add_f32 v44, v44, v52
    v_add_f32 v45, v45, v49
    v_add_f32 v53, v53, v57
    v_add_f32 v45, v45, v53
    v_add_f32 v46, v46, v50
    v_add_f32 v54, v54, v58
    v_add_f32 v46, v46, v54
    v_add_f32 v47, v47, v51
    v_add_f32 v55, v55, v59
    v_add_f32 v47, v47, v55
    v_cvt_pk_bf16_f32 v239, v44, v45
    v_lshlrev_b32 v44, 16, v239
    v_and_b32 v45, 0xffff0000, v239
    v_cvt_pk_bf16_f32 v239, v46, v47
    v_lshlrev_b32 v46, 16, v239
    v_and_b32 v47, 0xffff0000, v239
    v_mul_f32 v44, v238, v44
    v_mul_f32 v45, v238, v45
    v_mul_f32 v46, v238, v46
    v_mul_f32 v47, v238, v47
    v_cvt_pk_bf16_f32 v239, v44, v45
    v_lshlrev_b32 v44, 16, v239
    v_and_b32 v45, 0xffff0000, v239
    v_cvt_pk_bf16_f32 v239, v46, v47
    v_lshlrev_b32 v46, 16, v239
    v_and_b32 v47, 0xffff0000, v239
    v_add_f32 v112, v112, v44
    v_add_f32 v113, v113, v45
    v_add_f32 v114, v114, v46
    v_add_f32 v115, v115, v47
    v_cvt_pk_bf16_f32 v150, v112, v113
    v_cvt_pk_bf16_f32 v151, v114, v115
    buffer_store_dwordx2 v[150:151], v243, s[24:27], 0 offen offset:32
    s_waitcnt lgkmcnt(8)
    v_add_f32 v60, v60, v64
    v_add_f32 v68, v68, v72
    v_add_f32 v60, v60, v68
    v_add_f32 v61, v61, v65
    v_add_f32 v69, v69, v73
    v_add_f32 v61, v61, v69
    v_add_f32 v62, v62, v66
    v_add_f32 v70, v70, v74
    v_add_f32 v62, v62, v70
    v_add_f32 v63, v63, v67
    v_add_f32 v71, v71, v75
    v_add_f32 v63, v63, v71
    v_cvt_pk_bf16_f32 v239, v60, v61
    v_lshlrev_b32 v60, 16, v239
    v_and_b32 v61, 0xffff0000, v239
    v_cvt_pk_bf16_f32 v239, v62, v63
    v_lshlrev_b32 v62, 16, v239
    v_and_b32 v63, 0xffff0000, v239
    v_mul_f32 v60, v238, v60
    v_mul_f32 v61, v238, v61
    v_mul_f32 v62, v238, v62
    v_mul_f32 v63, v238, v63
    v_cvt_pk_bf16_f32 v239, v60, v61
    v_lshlrev_b32 v60, 16, v239
    v_and_b32 v61, 0xffff0000, v239
    v_cvt_pk_bf16_f32 v239, v62, v63
    v_lshlrev_b32 v62, 16, v239
    v_and_b32 v63, 0xffff0000, v239
    v_add_f32 v116, v116, v60
    v_add_f32 v117, v117, v61
    v_add_f32 v118, v118, v62
    v_add_f32 v119, v119, v63
    v_cvt_pk_bf16_f32 v152, v116, v117
    v_cvt_pk_bf16_f32 v153, v118, v119
    buffer_store_dwordx2 v[152:153], v243, s[24:27], 0 offen offset:64
    s_waitcnt lgkmcnt(4)
    v_add_f32 v76, v76, v80
    v_add_f32 v84, v84, v88
    v_add_f32 v76, v76, v84
    v_add_f32 v77, v77, v81
    v_add_f32 v85, v85, v89
    v_add_f32 v77, v77, v85
    v_add_f32 v78, v78, v82
    v_add_f32 v86, v86, v90
    v_add_f32 v78, v78, v86
    v_add_f32 v79, v79, v83
    v_add_f32 v87, v87, v91
    v_add_f32 v79, v79, v87
    v_cvt_pk_bf16_f32 v239, v76, v77
    v_lshlrev_b32 v76, 16, v239
    v_and_b32 v77, 0xffff0000, v239
    v_cvt_pk_bf16_f32 v239, v78, v79
    v_lshlrev_b32 v78, 16, v239
    v_and_b32 v79, 0xffff0000, v239
    v_mul_f32 v76, v238, v76
    v_mul_f32 v77, v238, v77
    v_mul_f32 v78, v238, v78
    v_mul_f32 v79, v238, v79
    v_cvt_pk_bf16_f32 v239, v76, v77
    v_lshlrev_b32 v76, 16, v239
    v_and_b32 v77, 0xffff0000, v239
    v_cvt_pk_bf16_f32 v239, v78, v79
    v_lshlrev_b32 v78, 16, v239
    v_and_b32 v79, 0xffff0000, v239
    v_add_f32 v120, v120, v76
    v_add_f32 v121, v121, v77
    v_add_f32 v122, v122, v78
    v_add_f32 v123, v123, v79
    v_cvt_pk_bf16_f32 v154, v120, v121
    v_cvt_pk_bf16_f32 v155, v122, v123
    buffer_store_dwordx2 v[154:155], v243, s[24:27], 0 offen offset:96
    s_waitcnt lgkmcnt(0)
    v_add_f32 v92, v92, v96
    v_add_f32 v100, v100, v104
    v_add_f32 v92, v92, v100
    v_add_f32 v93, v93, v97
    v_add_f32 v101, v101, v105
    v_add_f32 v93, v93, v101
    v_add_f32 v94, v94, v98
    v_add_f32 v102, v102, v106
    v_add_f32 v94, v94, v102
    v_add_f32 v95, v95, v99
    v_add_f32 v103, v103, v107
    v_add_f32 v95, v95, v103
    v_cvt_pk_bf16_f32 v239, v92, v93
    v_lshlrev_b32 v92, 16, v239
    v_and_b32 v93, 0xffff0000, v239
    v_cvt_pk_bf16_f32 v239, v94, v95
    v_lshlrev_b32 v94, 16, v239
    v_and_b32 v95, 0xffff0000, v239
    v_mul_f32 v92, v238, v92
    v_mul_f32 v93, v238, v93
    v_mul_f32 v94, v238, v94
    v_mul_f32 v95, v238, v95
    v_cvt_pk_bf16_f32 v239, v92, v93
    v_lshlrev_b32 v92, 16, v239
    v_and_b32 v93, 0xffff0000, v239
    v_cvt_pk_bf16_f32 v239, v94, v95
    v_lshlrev_b32 v94, 16, v239
    v_and_b32 v95, 0xffff0000, v239
    v_add_f32 v124, v124, v92
    v_add_f32 v125, v125, v93
    v_add_f32 v126, v126, v94
    v_add_f32 v127, v127, v95
    v_cvt_pk_bf16_f32 v156, v124, v125
    v_cvt_pk_bf16_f32 v157, v126, v127
    buffer_store_dwordx2 v[156:157], v243, s[24:27], 0 offen offset:128
    s_branch L_mn_fin
L_gm_z1:
    buffer_load_dword v238, v242, s[96:99], 0 offen sc1
    s_branch L_gm_go
L_gm_z2:
    s_mov_b32 s42, 0
L_gm_p4:
    buffer_load_dword v238, v242, s[96:99], 0 offen sc1
    s_waitcnt vmcnt(0)
    v_xor_b32 v238, 0x01010101, v238
    v_cmp_ne_u32 vcc, 0, v238
    s_add_u32 s42, s42, 1
    s_cbranch_vccz L_gm_p4_ok
    s_sleep 2
    s_cmp_lt_u32 s42, 65536
    s_cbranch_scc1 L_gm_p4
L_gm_p4_ok:
    s_branch L_gm_z3
L_mn_fin:
L_mn_end:
    s_endpgm
.section .rodata,"a"
.p2align 6
.amdhsa_kernel gated_mix__ssm_conv_h3__compressed_kv_cla__prompt_kernel
  .amdhsa_next_free_vgpr 254
  .amdhsa_next_free_sgpr 102
  .amdhsa_accum_offset 256
  .amdhsa_group_segment_fixed_size 0
  .amdhsa_kernarg_size 128
  .amdhsa_user_sgpr_count 2
  .amdhsa_user_sgpr_kernarg_segment_ptr 1
  .amdhsa_system_sgpr_workgroup_id_x 1
.end_amdhsa_kernel
```
